```python
import torch

def _softmax(x, axis=-1):
    return torch.softmax(x, dim=axis)
def _gelu(x):
    return torch.nn.functional.gelu(x, approximate="tanh")
def _silu(x):
    return torch.nn.functional.silu(x)
def _sigmoid(x):
    return torch.sigmoid(x)
def _layernorm(x, axis=-1, eps=1e-5):
    m = x.mean(dim=axis, keepdim=True)
    v = x.var(dim=axis, keepdim=True, unbiased=False)
    return (x - m) / torch.sqrt(v + eps)
def _scatter_add(tgt, idx, src, axis=0):
    return tgt.clone().index_add_(axis, idx, src)
def _segment_sum(src, seg, n):
    out = torch.zeros((n,) + src.shape[1:], dtype=src.dtype)
    return out.index_add_(0, seg, src)
def _pad(x, pw):
    flat = tuple(v for pair in reversed(pw) for v in pair)
    return torch.nn.functional.pad(x, flat)

kernel_name = 'concat_heads__linear_kernel_hedgehog__grouped_kv_mqa__prompt'

def setup_inputs():

    _w = (lambda a: (lambda t: t.to(torch.bfloat16) if t.is_floating_point() else t)(torch.as_tensor(a)))
    def _A_setup():
        B, S, D, H = 1, 2048, 1024, 32
        Dh = D // H
        return {
            "x": _w((lambda *s: torch.randn(*s, dtype=torch.bfloat16) * 0.4)(B, S, D)),
            "wqkv": _w((lambda *s: torch.randn(*s, dtype=torch.bfloat16) * 0.4)(D, 3 * D)),
            "w_phi": _w((lambda *s: torch.randn(*s, dtype=torch.bfloat16) * 0.4)(H, Dh, Dh) * (Dh ** -0.5)),
            "wo": _w((lambda *s: torch.randn(*s, dtype=torch.bfloat16) * 0.05)(D, D)),
        }
    _A_in = _A_setup()

    def _B_setup():
        B, S, D, H = 1, 2048, 1024, 32
        Dh = D // H
        return {
            "x": _w((lambda *s: torch.randn(*s, dtype=torch.bfloat16) * 0.05)(B, S, D)),
            "wq": _w((lambda *s: torch.randn(*s, dtype=torch.bfloat16) * 0.8)(D, H * Dh)),
            "wk": _w((lambda *s: torch.randn(*s, dtype=torch.bfloat16) * 0.8)(D, Dh)),
            "wv": _w((lambda *s: torch.randn(*s, dtype=torch.bfloat16) * 0.1)(D, Dh)),
            "wo": _w((lambda *s: torch.randn(*s, dtype=torch.bfloat16) * 0.1)(H * Dh, D)),
        }
    _B_in = _B_setup()

    return {
        "A_x": _A_in["x"],
        "A_wqkv": _A_in["wqkv"],
        "A_w_phi": _A_in["w_phi"],
        "A_wo": _A_in["wo"],
        "B_x": _B_in["x"],
        "B_wq": _B_in["wq"],
        "B_wk": _B_in["wk"],
        "B_wv": _B_in["wv"],
        "B_wo": _B_in["wo"],
    }

def reference(A_x, A_wqkv, A_w_phi, A_wo, B_x, B_wq, B_wk, B_wv, B_wo):
    def _A_ref(x, wqkv, w_phi, wo):
        B, S, D = x.shape
        H = 32; Dh = D // H
        qkv = (lambda x, *d: x.permute(*d))((x @ wqkv).reshape(B, S, 3, H, Dh), 2, 0, 3, 1, 4)
        q, k, v = qkv[0], qkv[1], qkv[2]
        pq = torch.einsum("bhsd,hdf->bhsf", q, w_phi)
        pk = torch.einsum("bhsd,hdf->bhsf", k, w_phi)
        phi_q = torch.concatenate([_softmax(pq, axis=-1), _softmax(-pq, axis=-1)], axis=-1)
        phi_k = torch.concatenate([_softmax(pk, axis=-1), _softmax(-pk, axis=-1)], axis=-1)
        kv = torch.einsum("bhsf,bhsd->bhfd", phi_k, v)
        z  = torch.einsum("bhsf->bhf", phi_k)
        num = torch.einsum("bhqf,bhfd->bhqd", phi_q, kv)
        den = torch.einsum("bhqf,bhf->bhq", phi_q, z)[..., None] + 1e-6
        o = num / den
        return (lambda x, *d: x.permute(*d))(o, 0, 2, 1, 3).reshape(B, S, D) @ wo

    def _B_ref(x, wq, wk, wv, wo):
        B, S, D = x.shape
        H = 32
        Dh = D // H
        q = (lambda x, *d: x.permute(*d))((x @ wq).reshape(B, S, H, Dh), 0, 2, 1, 3)
        k = x @ wk
        v = x @ wv
        scores = torch.einsum("bhqd,bkd->bhqk", q, k) * (Dh ** -0.5)
        p = _softmax(scores, axis=-1)
        o = torch.einsum("bhqk,bkd->bhqd", p, v)
        return (lambda x, *d: x.permute(*d))(o, 0, 2, 1, 3).reshape(B, S, H * Dh) @ wo

    a = _A_ref(A_x, A_wqkv, A_w_phi, A_wo)
    b = _B_ref(B_x, B_wq, B_wk, B_wv, B_wo)
    return torch.concatenate([a, b], axis=-1)
```

```asm
; @launch kernel=k1_kernel grid=(256,1,1) block=(512,1,1) lds=159744
; @launch kernel=k2_kernel grid=(256,1,1) block=(512,1,1) lds=163840
.amdgcn_target "amdgcn-amd-amdhsa--gfx950"
.text
.globl k1_kernel
.p2align 8
.type k1_kernel,@function
k1_kernel:
  s_cmp_ge_u32 s2, 256
  s_cbranch_scc0 K1_go
  s_endpgm
K1_go:
  s_load_dwordx16 s[16:31], s[0:1], 0
  s_load_dwordx2 s[32:33], s[0:1], 88
  v_lshrrev_b32 v1, 6, v0
  v_and_b32 v2, 63, v0
  v_readfirstlane_b32 s5, v1
  s_and_b32 s3, s2, 7
  s_lshr_b32 s4, s2, 3
  s_and_b32 s9, s4, 3
  s_lshr_b32 s10, s4, 2
  s_and_b32 s6, s3, 1
  s_lshl_b32 s6, s6, 2
  s_add_u32 s6, s6, s9
  s_lshr_b32 s7, s3, 1
  s_lshl_b32 s7, s7, 3
  s_add_u32 s7, s7, s10
  s_mul_i32 s9, s7, 11
  s_lshr_b32 s9, s9, 5
  s_mul_i32 s10, s9, 3
  s_sub_u32 s10, s7, s10
  s_lshl_b32 s11, s9, 1
  s_add_u32 s11, s11, s10
  s_add_u32 s9, s9, 16
  s_cmp_eq_u32 s10, 2
  s_cselect_b32 s9, s9, s11
  s_cmp_lt_u32 s7, 24
  s_cselect_b32 s7, s9, s7
  s_bfe_u32 s12, s5, 0x10001
  s_and_b32 s13, s5, 1
  s_lshl_b32 s9, s7, 7
  s_add_u32 s9, s9, 2048
  s_and_b32 s10, s7, 7
  s_lshl_b32 s10, s10, 8
  s_cmp_lt_u32 s7, 16
  s_cselect_b32 s14, s9, s10
  s_cselect_b32 s15, 2048, 64
  s_cselect_b32 s34, 64, 128
  s_cselect_b32 s11, 12, 13
  s_lshl_b32 s46, 1, s11
  s_movk_i32 s35, 6144
  s_mov_b32 s42, 0x600000
  s_waitcnt lgkmcnt(0)
  s_cmp_ge_u32 s7, 24
  s_cselect_b32 s35, 2048, s35
  s_cselect_b32 s8, 4194304, 0
  s_cselect_b32 s36, s24, s16
  s_cselect_b32 s37, s25, s17
  s_cselect_b32 s40, s26, s18
  s_cselect_b32 s41, s27, s19
  s_cselect_b32 s42, 0x200000, s42
  s_cselect_b32 s46, 65536, s46
  s_lshl_b32 s9, s6, 19
  s_add_u32 s36, s36, s9
  s_addc_u32 s37, s37, 0
  s_and_b32 s37, s37, 0xffff
  s_mov_b32 s38, 0x80000
  s_mov_b32 s39, 0x00020000
  s_and_b32 s41, s41, 0xffff
  s_mov_b32 s43, 0x00020000
  s_and_b32 s9, s7, 15
  s_lshl_b32 s9, s9, s11
  s_add_u32 s20, s20, s9
  s_addc_u32 s21, s21, 0
  s_bitcmp1_b32 s7, 0
  s_cselect_b32 s28, s30, s28
  s_cselect_b32 s29, s31, s29
  s_cmp_ge_u32 s7, 24
  s_cselect_b32 s44, s28, s20
  s_cselect_b32 s45, s29, s21
  s_and_b32 s45, s45, 0xffff
  s_mov_b32 s47, 0x00020000
  s_mov_b32 s48, s32
  s_and_b32 s49, s33, 0xffff
  s_mov_b32 s50, 268435456
  s_mov_b32 s51, 0x00020000
  s_cmp_ge_u32 s5, 4
  s_cbranch_scc1 K1_loader
  s_lshl_b32 s9, s2, 2
  s_add_u32 s9, s9, s5
  s_lshr_b32 s21, s9, 7
  s_and_b32 s9, s9, 127
  s_add_u32 s10, s21, 5
  s_cmp_ge_u32 s9, 112
  s_cbranch_scc1 X2V_3
  s_cmp_ge_u32 s9, 64
  s_cbranch_scc1 X2W_2
  s_cmp_ge_u32 s9, 32
  s_cselect_b32 s16, s24, s16
  s_cselect_b32 s17, s25, s17
  s_mov_b32 s18, 0x400000
  s_and_b32 s9, s9, 31
  s_lshl_b32 s9, s9, 17
  s_lshl_b32 s20, s10, 7
  s_add_u32 s20, s20, s9
  s_movk_i32 s22, 1024
  v_lshlrev_b32 v1, 11, v2
  s_branch X2G_4
X2W_2:
  s_mov_b32 s16, s18
  s_mov_b32 s17, s19
  s_mov_b32 s18, 0x600000
  s_sub_u32 s9, s9, 64
  s_lshl_b32 s9, s9, 13
  s_mul_i32 s20, s10, 0x60000
  s_add_u32 s20, s20, s9
  s_mov_b32 s22, 0x300000
  v_lshlrev_b32 v1, 7, v2
  s_branch X2G_4
X2V_3:
  s_mov_b32 s16, s26
  s_mov_b32 s17, s27
  s_mov_b32 s18, 0x200000
  s_sub_u32 s9, s9, 112
  s_lshl_b32 s9, s9, 13
  s_lshl_b32 s20, s10, 17
  s_add_u32 s20, s20, s9
  s_mov_b32 s22, 0x100000
  v_lshlrev_b32 v1, 7, v2
X2G_4:
  s_and_b32 s17, s17, 0xffff
  s_mov_b32 s19, 0x00020000
  s_mov_b32 s23, 0
  s_cmp_lg_u32 s21, 4
  s_cbranch_scc1 X2E_6
  s_lshr_b32 s9, s22, 3
  s_mul_i32 s9, s9, 5
  s_sub_u32 s9, s20, s9
  buffer_load_dword v0, v1, s[16:19], s9 offen
X2E_6:
  s_cmp_lg_u32 s21, 5
  s_cbranch_scc1 X2E_7
  s_lshr_b32 s9, s22, 3
  s_mul_i32 s9, s9, 7
  s_sub_u32 s9, s20, s9
  buffer_load_dword v0, v1, s[16:19], s9 offen
X2E_7:
  s_cmp_lg_u32 s21, 6
  s_cbranch_scc1 X2E_8
  s_lshr_b32 s9, s22, 3
  s_mul_i32 s9, s9, 9
  s_sub_u32 s9, s20, s9
  buffer_load_dword v0, v1, s[16:19], s9 offen
X2E_8:
  s_cmp_lt_u32 s7, 16
  s_cbranch_scc1 K1_kv
  s_cmp_lt_u32 s7, 24
  s_cbranch_scc1 K1_q
  s_cmp_ge_u32 s5, 2
  s_cbranch_scc1 K1_q
  s_bitcmp1_b32 s7, 0
  s_cbranch_scc1 K1_qv
  v_mov_b32 v3, 0
  v_mov_b32 v4, 0
  v_mov_b32 v7, 0
  v_mov_b32 v9, 0
  v_mov_b32 v43, 0
  v_mov_b32 v44, 0
  s_mov_b32 s63, 0
  s_mov_b64 exec, 0
  s_and_b32 s9, s5, 1
  s_cmp_eq_u32 s9, 1
  s_cbranch_scc1 K1W_qk_1
  s_branch K1W_qk_0
K1W_qk_ret:
  s_mov_b64 exec, -1
  v_and_b32 v28, 15, v2
  v_lshrrev_b32 v29, 4, v2
  s_lshl_b32 s9, s12, 14
  v_lshlrev_b32 v24, 7, v28
  v_add_u32 v24, s9, v24
  v_lshrrev_b32 v25, 1, v28
  v_xor_b32 v25, v25, v29
  v_xor_b32 v26, 0, v25
  v_lshl_add_u32 v4, v26, 4, v24
  v_add_u32 v6, 0x8000, v4
  v_add_u32 v8, 0x10000, v4
  v_xor_b32 v26, 4, v25
  v_lshl_add_u32 v5, v26, 4, v24
  v_add_u32 v7, 0x8000, v5
  v_add_u32 v9, 0x10000, v5
  s_and_b32 s9, s7, 7
  s_lshr_b32 s9, s9, 1
  s_lshl_b32 s9, s9, 1
  s_add_u32 s9, s9, s5
  s_mov_b32 s63, s9
  s_lshl_b32 s9, s9, 12
  v_add_u32 v10, s9, v4
  v_add_u32 v11, s9, v5
  v_add_u32 v12, s9, v6
  v_add_u32 v13, s9, v7
  v_add_u32 v14, s9, v8
  v_add_u32 v15, s9, v9
  v_bfe_u32 v24, v2, 2, 2
  v_lshl_add_u32 v25, v29, 3, v24
  v_and_b32 v26, 1, v29
  v_lshl_add_u32 v24, v26, 2, v24
  v_and_b32 v27, 3, v2
  v_lshlrev_b32 v27, 3, v27
  v_lshl_add_u32 v20, v25, 6, v27
  v_add_u32 v20, 147456, v20
  v_lshl_add_u32 v20, v26, 5, v20
  v_xor_b32 v21, 32, v20
  v_lshl_add_u32 v25, v25, 8, v27
  v_add_u32 v25, 98304, v25
  s_lshl_b32 s9, s13, 2
  v_xor_b32 v24, s9, v24
  v_xor_b32 v26, 0, v24
  v_lshl_add_u32 v16, v26, 5, v25
  v_xor_b32 v26, 1, v24
  v_lshl_add_u32 v17, v26, 5, v25
  v_xor_b32 v26, 2, v24
  v_lshl_add_u32 v18, v26, 5, v25
  v_xor_b32 v26, 3, v24
  v_lshl_add_u32 v19, v26, 5, v25
  v_mov_b32 v112, 0
  v_mov_b32 v113, 0
  v_mov_b32 v114, 0
  v_mov_b32 v115, 0
  v_mov_b32 v116, 0
  v_mov_b32 v117, 0
  v_mov_b32 v118, 0
  v_mov_b32 v119, 0
  v_mov_b32 v120, 0
  v_mov_b32 v121, 0
  v_mov_b32 v122, 0
  v_mov_b32 v123, 0
  v_mov_b32 v124, 0
  v_mov_b32 v125, 0
  v_mov_b32 v126, 0
  v_mov_b32 v127, 0
  v_mov_b32 v128, 0
  v_mov_b32 v129, 0
  v_mov_b32 v130, 0
  v_mov_b32 v131, 0
  v_mov_b32 v132, 0
  v_mov_b32 v133, 0
  v_mov_b32 v134, 0
  v_mov_b32 v135, 0
  v_mov_b32 v136, 0
  v_mov_b32 v137, 0
  v_mov_b32 v138, 0
  v_mov_b32 v139, 0
  v_mov_b32 v140, 0
  v_mov_b32 v141, 0
  v_mov_b32 v142, 0
  v_mov_b32 v143, 0
  v_mov_b32 v144, 0
  v_mov_b32 v145, 0
  v_mov_b32 v146, 0
  v_mov_b32 v147, 0
  v_mov_b32 v148, 0
  v_mov_b32 v149, 0
  v_mov_b32 v150, 0
  v_mov_b32 v151, 0
  v_mov_b32 v152, 0
  v_mov_b32 v153, 0
  v_mov_b32 v154, 0
  v_mov_b32 v155, 0
  v_mov_b32 v156, 0
  v_mov_b32 v157, 0
  v_mov_b32 v158, 0
  v_mov_b32 v159, 0
  v_mov_b32 v160, 0
  v_mov_b32 v161, 0
  v_mov_b32 v162, 0
  v_mov_b32 v163, 0
  v_mov_b32 v164, 0
  v_mov_b32 v165, 0
  v_mov_b32 v166, 0
  v_mov_b32 v167, 0
  v_mov_b32 v168, 0
  v_mov_b32 v169, 0
  v_mov_b32 v170, 0
  v_mov_b32 v171, 0
  v_mov_b32 v172, 0
  v_mov_b32 v173, 0
  v_mov_b32 v174, 0
  v_mov_b32 v175, 0
  v_mov_b32 v176, 0
  v_mov_b32 v177, 0
  v_mov_b32 v178, 0
  v_mov_b32 v179, 0
  v_mov_b32 v180, 0
  v_mov_b32 v181, 0
  v_mov_b32 v182, 0
  v_mov_b32 v183, 0
  v_mov_b32 v184, 0
  v_mov_b32 v185, 0
  v_mov_b32 v186, 0
  v_mov_b32 v187, 0
  v_mov_b32 v188, 0
  v_mov_b32 v189, 0
  v_mov_b32 v190, 0
  v_mov_b32 v191, 0
  v_mov_b32 v192, 0
  v_mov_b32 v193, 0
  v_mov_b32 v194, 0
  v_mov_b32 v195, 0
  v_mov_b32 v196, 0
  v_mov_b32 v197, 0
  v_mov_b32 v198, 0
  v_mov_b32 v199, 0
  v_mov_b32 v200, 0
  v_mov_b32 v201, 0
  v_mov_b32 v202, 0
  v_mov_b32 v203, 0
  v_mov_b32 v204, 0
  v_mov_b32 v205, 0
  v_mov_b32 v206, 0
  v_mov_b32 v207, 0
  v_mov_b32 v208, 0
  v_mov_b32 v209, 0
  v_mov_b32 v210, 0
  v_mov_b32 v211, 0
  v_mov_b32 v212, 0
  v_mov_b32 v213, 0
  v_mov_b32 v214, 0
  v_mov_b32 v215, 0
  v_mov_b32 v216, 0
  v_mov_b32 v217, 0
  v_mov_b32 v218, 0
  v_mov_b32 v219, 0
  v_mov_b32 v220, 0
  v_mov_b32 v221, 0
  v_mov_b32 v222, 0
  v_mov_b32 v223, 0
  v_mov_b32 v224, 0
  v_mov_b32 v225, 0
  v_mov_b32 v226, 0
  v_mov_b32 v227, 0
  v_mov_b32 v228, 0
  v_mov_b32 v229, 0
  v_mov_b32 v230, 0
  v_mov_b32 v231, 0
  v_mov_b32 v232, 0
  v_mov_b32 v233, 0
  v_mov_b32 v234, 0
  v_mov_b32 v235, 0
  v_mov_b32 v236, 0
  v_mov_b32 v237, 0
  v_mov_b32 v238, 0
  v_mov_b32 v239, 0
  v_mov_b32 v240, 0
  v_mov_b32 v241, 0
  v_mov_b32 v242, 0
  v_mov_b32 v243, 0
  v_mov_b32 v244, 0
  v_mov_b32 v245, 0
  v_mov_b32 v246, 0
  v_mov_b32 v247, 0
  v_mov_b32 v248, 0
  v_mov_b32 v249, 0
  v_mov_b32 v250, 0
  v_mov_b32 v251, 0
  v_mov_b32 v252, 0
  v_mov_b32 v253, 0
  v_mov_b32 v254, 0
  v_mov_b32 v255, 0
  s_barrier
  ds_read_b128 v[24:27], v4 offset:0
  ds_read_b128 v[28:31], v4 offset:2048
  ds_read_b64_tr_b16 v[56:57], v16 offset:0
  ds_read_b64_tr_b16 v[58:59], v16 offset:1024
  ds_read_b64_tr_b16 v[60:61], v17 offset:0
  ds_read_b128 v[32:35], v4 offset:4096
  ds_read_b64_tr_b16 v[62:63], v17 offset:1024
  ds_read_b64_tr_b16 v[64:65], v18 offset:0
  ds_read_b64_tr_b16 v[66:67], v18 offset:1024
  ds_read_b128 v[36:39], v4 offset:6144
  ds_read_b64_tr_b16 v[68:69], v19 offset:0
  ds_read_b64_tr_b16 v[70:71], v19 offset:1024
  ds_read_b64_tr_b16 v[96:97], v20 offset:0
  ds_read_b128 v[40:43], v4 offset:8192
  ds_read_b64_tr_b16 v[98:99], v20 offset:256
  ds_read_b64_tr_b16 v[100:101], v21 offset:0
  ds_read_b64_tr_b16 v[102:103], v21 offset:256
  ds_read_b128 v[44:47], v4 offset:10240
  ds_read_b128 v[48:51], v4 offset:12288
  ds_read_b128 v[52:55], v4 offset:14336
  ds_read_b128 v[88:91], v10 offset:0
  ds_read_b128 v[92:95], v10 offset:2048
  s_mov_b32 s11, 5
.p2align 6
K1C_9:
  s_cmp_lg_u32 s23, s21
  s_cbranch_scc1 K1XS_10
  buffer_load_dword v0, v1, s[16:19], s20 offen
  s_add_u32 s20, s20, s22
  s_add_u32 s21, s21, 8
  s_cmp_ge_u32 s21, 11
  s_cselect_b32 s21, -1, s21
K1XS_10:
  s_add_u32 s23, s23, 1
  s_waitcnt lgkmcnt(15)
  v_mfma_f32_16x16x32_bf16 v[128:131], v[56:59], v[24:27], v[128:131]
  ds_read_b64_tr_b16 v[72:73], v16 offset:8192
  v_mfma_f32_16x16x32_bf16 v[132:135], v[60:63], v[24:27], v[132:135]
  ds_read_b64_tr_b16 v[74:75], v16 offset:9216
  s_waitcnt lgkmcnt(15)
  v_mfma_f32_16x16x32_bf16 v[136:139], v[64:67], v[24:27], v[136:139]
  ds_read_b64_tr_b16 v[76:77], v17 offset:8192
  s_waitcnt lgkmcnt(13)
  v_mfma_f32_16x16x32_bf16 v[140:143], v[68:71], v[24:27], v[140:143]
  ds_read_b128 v[24:27], v5 offset:0
  v_mfma_f32_16x16x32_bf16 v[144:147], v[56:59], v[28:31], v[144:147]
  ds_read_b64_tr_b16 v[78:79], v17 offset:9216
  v_mfma_f32_16x16x32_bf16 v[148:151], v[60:63], v[28:31], v[148:151]
  ds_read_b64_tr_b16 v[80:81], v18 offset:8192
  v_mfma_f32_16x16x32_bf16 v[152:155], v[64:67], v[28:31], v[152:155]
  ds_read_b64_tr_b16 v[82:83], v18 offset:9216
  v_mfma_f32_16x16x32_bf16 v[156:159], v[68:71], v[28:31], v[156:159]
  ds_read_b128 v[28:31], v5 offset:2048
  v_mfma_f32_16x16x32_bf16 v[160:163], v[56:59], v[32:35], v[160:163]
  ds_read_b64_tr_b16 v[84:85], v19 offset:8192
  v_mfma_f32_16x16x32_bf16 v[164:167], v[60:63], v[32:35], v[164:167]
  ds_read_b64_tr_b16 v[86:87], v19 offset:9216
  v_mfma_f32_16x16x32_bf16 v[168:171], v[64:67], v[32:35], v[168:171]
  ds_read_b64_tr_b16 v[104:105], v20 offset:2048
  v_mfma_f32_16x16x32_bf16 v[172:175], v[68:71], v[32:35], v[172:175]
  ds_read_b128 v[32:35], v5 offset:4096
  v_mfma_f32_16x16x32_bf16 v[176:179], v[56:59], v[36:39], v[176:179]
  ds_read_b64_tr_b16 v[106:107], v20 offset:2304
  v_mfma_f32_16x16x32_bf16 v[180:183], v[60:63], v[36:39], v[180:183]
  ds_read_b64_tr_b16 v[108:109], v21 offset:2048
  v_mfma_f32_16x16x32_bf16 v[184:187], v[64:67], v[36:39], v[184:187]
  ds_read_b64_tr_b16 v[110:111], v21 offset:2304
  v_mfma_f32_16x16x32_bf16 v[188:191], v[68:71], v[36:39], v[188:191]
  ds_read_b128 v[36:39], v5 offset:6144
  s_waitcnt lgkmcnt(15)
  v_mfma_f32_16x16x32_bf16 v[192:195], v[56:59], v[40:43], v[192:195]
  v_mfma_f32_16x16x32_bf16 v[196:199], v[60:63], v[40:43], v[196:199]
  v_mfma_f32_16x16x32_bf16 v[200:203], v[64:67], v[40:43], v[200:203]
  v_mfma_f32_16x16x32_bf16 v[204:207], v[68:71], v[40:43], v[204:207]
  ds_read_b128 v[40:43], v5 offset:8192
  v_mfma_f32_16x16x32_bf16 v[208:211], v[56:59], v[44:47], v[208:211]
  v_mfma_f32_16x16x32_bf16 v[212:215], v[60:63], v[44:47], v[212:215]
  v_mfma_f32_16x16x32_bf16 v[216:219], v[64:67], v[44:47], v[216:219]
  v_mfma_f32_16x16x32_bf16 v[220:223], v[68:71], v[44:47], v[220:223]
  ds_read_b128 v[44:47], v5 offset:10240
  v_mfma_f32_16x16x32_bf16 v[224:227], v[56:59], v[48:51], v[224:227]
  v_mfma_f32_16x16x32_bf16 v[228:231], v[60:63], v[48:51], v[228:231]
  v_mfma_f32_16x16x32_bf16 v[232:235], v[64:67], v[48:51], v[232:235]
  v_mfma_f32_16x16x32_bf16 v[236:239], v[68:71], v[48:51], v[236:239]
  ds_read_b128 v[48:51], v5 offset:12288
  v_mfma_f32_16x16x32_bf16 v[240:243], v[56:59], v[52:55], v[240:243]
  v_mfma_f32_16x16x32_bf16 v[244:247], v[60:63], v[52:55], v[244:247]
  v_mfma_f32_16x16x32_bf16 v[248:251], v[64:67], v[52:55], v[248:251]
  v_mfma_f32_16x16x32_bf16 v[252:255], v[68:71], v[52:55], v[252:255]
  ds_read_b128 v[52:55], v5 offset:14336
  v_mfma_f32_16x16x32_bf16 v[112:115], v[96:99], v[88:91], v[112:115]
  v_mfma_f32_16x16x32_bf16 v[116:119], v[100:103], v[88:91], v[116:119]
  ds_read_b128 v[88:91], v11 offset:0
  v_mfma_f32_16x16x32_bf16 v[120:123], v[96:99], v[92:95], v[120:123]
  v_mfma_f32_16x16x32_bf16 v[124:127], v[100:103], v[92:95], v[124:127]
  ds_read_b128 v[92:95], v11 offset:2048
  s_waitcnt lgkmcnt(15)
  v_mfma_f32_16x16x32_bf16 v[128:131], v[72:75], v[24:27], v[128:131]
  v_mfma_f32_16x16x32_bf16 v[132:135], v[76:79], v[24:27], v[132:135]
  v_mfma_f32_16x16x32_bf16 v[136:139], v[80:83], v[24:27], v[136:139]
  s_waitcnt lgkmcnt(12)
  v_mfma_f32_16x16x32_bf16 v[140:143], v[84:87], v[24:27], v[140:143]
  v_mfma_f32_16x16x32_bf16 v[144:147], v[72:75], v[28:31], v[144:147]
  v_mfma_f32_16x16x32_bf16 v[148:151], v[76:79], v[28:31], v[148:151]
  s_waitcnt lgkmcnt(0)
  s_barrier
  v_mfma_f32_16x16x32_bf16 v[152:155], v[80:83], v[28:31], v[152:155]
  ds_read_b128 v[24:27], v6 offset:0
  v_mfma_f32_16x16x32_bf16 v[156:159], v[84:87], v[28:31], v[156:159]
  ds_read_b128 v[28:31], v6 offset:2048
  v_mfma_f32_16x16x32_bf16 v[160:163], v[72:75], v[32:35], v[160:163]
  ds_read_b64_tr_b16 v[56:57], v16 offset:16384
  v_mfma_f32_16x16x32_bf16 v[164:167], v[76:79], v[32:35], v[164:167]
  ds_read_b64_tr_b16 v[58:59], v16 offset:17408
  v_mfma_f32_16x16x32_bf16 v[168:171], v[80:83], v[32:35], v[168:171]
  ds_read_b64_tr_b16 v[60:61], v17 offset:16384
  v_mfma_f32_16x16x32_bf16 v[172:175], v[84:87], v[32:35], v[172:175]
  ds_read_b128 v[32:35], v6 offset:4096
  v_mfma_f32_16x16x32_bf16 v[176:179], v[72:75], v[36:39], v[176:179]
  ds_read_b64_tr_b16 v[62:63], v17 offset:17408
  v_mfma_f32_16x16x32_bf16 v[180:183], v[76:79], v[36:39], v[180:183]
  ds_read_b64_tr_b16 v[64:65], v18 offset:16384
  v_mfma_f32_16x16x32_bf16 v[184:187], v[80:83], v[36:39], v[184:187]
  ds_read_b64_tr_b16 v[66:67], v18 offset:17408
  v_mfma_f32_16x16x32_bf16 v[188:191], v[84:87], v[36:39], v[188:191]
  ds_read_b128 v[36:39], v6 offset:6144
  v_mfma_f32_16x16x32_bf16 v[192:195], v[72:75], v[40:43], v[192:195]
  ds_read_b64_tr_b16 v[68:69], v19 offset:16384
  v_mfma_f32_16x16x32_bf16 v[196:199], v[76:79], v[40:43], v[196:199]
  ds_read_b64_tr_b16 v[70:71], v19 offset:17408
  v_mfma_f32_16x16x32_bf16 v[200:203], v[80:83], v[40:43], v[200:203]
  ds_read_b64_tr_b16 v[96:97], v20 offset:4096
  v_mfma_f32_16x16x32_bf16 v[204:207], v[84:87], v[40:43], v[204:207]
  ds_read_b128 v[40:43], v6 offset:8192
  v_mfma_f32_16x16x32_bf16 v[208:211], v[72:75], v[44:47], v[208:211]
  ds_read_b64_tr_b16 v[98:99], v20 offset:4352
  v_mfma_f32_16x16x32_bf16 v[212:215], v[76:79], v[44:47], v[212:215]
  ds_read_b64_tr_b16 v[100:101], v21 offset:4096
  v_mfma_f32_16x16x32_bf16 v[216:219], v[80:83], v[44:47], v[216:219]
  ds_read_b64_tr_b16 v[102:103], v21 offset:4352
  v_mfma_f32_16x16x32_bf16 v[220:223], v[84:87], v[44:47], v[220:223]
  ds_read_b128 v[44:47], v6 offset:10240
  v_mfma_f32_16x16x32_bf16 v[224:227], v[72:75], v[48:51], v[224:227]
  v_mfma_f32_16x16x32_bf16 v[228:231], v[76:79], v[48:51], v[228:231]
  v_mfma_f32_16x16x32_bf16 v[232:235], v[80:83], v[48:51], v[232:235]
  v_mfma_f32_16x16x32_bf16 v[236:239], v[84:87], v[48:51], v[236:239]
  ds_read_b128 v[48:51], v6 offset:12288
  v_mfma_f32_16x16x32_bf16 v[240:243], v[72:75], v[52:55], v[240:243]
  v_mfma_f32_16x16x32_bf16 v[244:247], v[76:79], v[52:55], v[244:247]
  v_mfma_f32_16x16x32_bf16 v[248:251], v[80:83], v[52:55], v[248:251]
  v_mfma_f32_16x16x32_bf16 v[252:255], v[84:87], v[52:55], v[252:255]
  ds_read_b128 v[52:55], v6 offset:14336
  v_mfma_f32_16x16x32_bf16 v[112:115], v[104:107], v[88:91], v[112:115]
  v_mfma_f32_16x16x32_bf16 v[116:119], v[108:111], v[88:91], v[116:119]
  ds_read_b128 v[88:91], v12 offset:0
  v_mfma_f32_16x16x32_bf16 v[120:123], v[104:107], v[92:95], v[120:123]
  v_mfma_f32_16x16x32_bf16 v[124:127], v[108:111], v[92:95], v[124:127]
  ds_read_b128 v[92:95], v12 offset:2048
  s_cmp_lg_u32 s23, s21
  s_cbranch_scc1 K1XS_11
  buffer_load_dword v0, v1, s[16:19], s20 offen
  s_add_u32 s20, s20, s22
  s_add_u32 s21, s21, 8
  s_cmp_ge_u32 s21, 11
  s_cselect_b32 s21, -1, s21
K1XS_11:
  s_add_u32 s23, s23, 1
  s_waitcnt lgkmcnt(15)
  v_mfma_f32_16x16x32_bf16 v[128:131], v[56:59], v[24:27], v[128:131]
  ds_read_b64_tr_b16 v[72:73], v16 offset:24576
  v_mfma_f32_16x16x32_bf16 v[132:135], v[60:63], v[24:27], v[132:135]
  ds_read_b64_tr_b16 v[74:75], v16 offset:25600
  s_waitcnt lgkmcnt(15)
  v_mfma_f32_16x16x32_bf16 v[136:139], v[64:67], v[24:27], v[136:139]
  ds_read_b64_tr_b16 v[76:77], v17 offset:24576
  s_waitcnt lgkmcnt(13)
  v_mfma_f32_16x16x32_bf16 v[140:143], v[68:71], v[24:27], v[140:143]
  ds_read_b128 v[24:27], v7 offset:0
  v_mfma_f32_16x16x32_bf16 v[144:147], v[56:59], v[28:31], v[144:147]
  ds_read_b64_tr_b16 v[78:79], v17 offset:25600
  v_mfma_f32_16x16x32_bf16 v[148:151], v[60:63], v[28:31], v[148:151]
  ds_read_b64_tr_b16 v[80:81], v18 offset:24576
  v_mfma_f32_16x16x32_bf16 v[152:155], v[64:67], v[28:31], v[152:155]
  ds_read_b64_tr_b16 v[82:83], v18 offset:25600
  v_mfma_f32_16x16x32_bf16 v[156:159], v[68:71], v[28:31], v[156:159]
  ds_read_b128 v[28:31], v7 offset:2048
  v_mfma_f32_16x16x32_bf16 v[160:163], v[56:59], v[32:35], v[160:163]
  ds_read_b64_tr_b16 v[84:85], v19 offset:24576
  v_mfma_f32_16x16x32_bf16 v[164:167], v[60:63], v[32:35], v[164:167]
  ds_read_b64_tr_b16 v[86:87], v19 offset:25600
  v_mfma_f32_16x16x32_bf16 v[168:171], v[64:67], v[32:35], v[168:171]
  ds_read_b64_tr_b16 v[104:105], v20 offset:6144
  v_mfma_f32_16x16x32_bf16 v[172:175], v[68:71], v[32:35], v[172:175]
  ds_read_b128 v[32:35], v7 offset:4096
  v_mfma_f32_16x16x32_bf16 v[176:179], v[56:59], v[36:39], v[176:179]
  ds_read_b64_tr_b16 v[106:107], v20 offset:6400
  v_mfma_f32_16x16x32_bf16 v[180:183], v[60:63], v[36:39], v[180:183]
  ds_read_b64_tr_b16 v[108:109], v21 offset:6144
  v_mfma_f32_16x16x32_bf16 v[184:187], v[64:67], v[36:39], v[184:187]
  ds_read_b64_tr_b16 v[110:111], v21 offset:6400
  v_mfma_f32_16x16x32_bf16 v[188:191], v[68:71], v[36:39], v[188:191]
  ds_read_b128 v[36:39], v7 offset:6144
  s_waitcnt lgkmcnt(15)
  v_mfma_f32_16x16x32_bf16 v[192:195], v[56:59], v[40:43], v[192:195]
  v_mfma_f32_16x16x32_bf16 v[196:199], v[60:63], v[40:43], v[196:199]
  v_mfma_f32_16x16x32_bf16 v[200:203], v[64:67], v[40:43], v[200:203]
  v_mfma_f32_16x16x32_bf16 v[204:207], v[68:71], v[40:43], v[204:207]
  ds_read_b128 v[40:43], v7 offset:8192
  v_mfma_f32_16x16x32_bf16 v[208:211], v[56:59], v[44:47], v[208:211]
  v_mfma_f32_16x16x32_bf16 v[212:215], v[60:63], v[44:47], v[212:215]
  v_mfma_f32_16x16x32_bf16 v[216:219], v[64:67], v[44:47], v[216:219]
  v_mfma_f32_16x16x32_bf16 v[220:223], v[68:71], v[44:47], v[220:223]
  ds_read_b128 v[44:47], v7 offset:10240
  v_mfma_f32_16x16x32_bf16 v[224:227], v[56:59], v[48:51], v[224:227]
  v_mfma_f32_16x16x32_bf16 v[228:231], v[60:63], v[48:51], v[228:231]
  v_mfma_f32_16x16x32_bf16 v[232:235], v[64:67], v[48:51], v[232:235]
  v_mfma_f32_16x16x32_bf16 v[236:239], v[68:71], v[48:51], v[236:239]
  ds_read_b128 v[48:51], v7 offset:12288
  v_mfma_f32_16x16x32_bf16 v[240:243], v[56:59], v[52:55], v[240:243]
  v_mfma_f32_16x16x32_bf16 v[244:247], v[60:63], v[52:55], v[244:247]
  v_mfma_f32_16x16x32_bf16 v[248:251], v[64:67], v[52:55], v[248:251]
  v_mfma_f32_16x16x32_bf16 v[252:255], v[68:71], v[52:55], v[252:255]
  ds_read_b128 v[52:55], v7 offset:14336
  v_mfma_f32_16x16x32_bf16 v[112:115], v[96:99], v[88:91], v[112:115]
  v_mfma_f32_16x16x32_bf16 v[116:119], v[100:103], v[88:91], v[116:119]
  ds_read_b128 v[88:91], v13 offset:0
  v_mfma_f32_16x16x32_bf16 v[120:123], v[96:99], v[92:95], v[120:123]
  v_mfma_f32_16x16x32_bf16 v[124:127], v[100:103], v[92:95], v[124:127]
  ds_read_b128 v[92:95], v13 offset:2048
  s_waitcnt lgkmcnt(15)
  v_mfma_f32_16x16x32_bf16 v[128:131], v[72:75], v[24:27], v[128:131]
  v_mfma_f32_16x16x32_bf16 v[132:135], v[76:79], v[24:27], v[132:135]
  v_mfma_f32_16x16x32_bf16 v[136:139], v[80:83], v[24:27], v[136:139]
  s_waitcnt lgkmcnt(12)
  v_mfma_f32_16x16x32_bf16 v[140:143], v[84:87], v[24:27], v[140:143]
  v_mfma_f32_16x16x32_bf16 v[144:147], v[72:75], v[28:31], v[144:147]
  v_mfma_f32_16x16x32_bf16 v[148:151], v[76:79], v[28:31], v[148:151]
  s_waitcnt lgkmcnt(0)
  s_barrier
  v_mfma_f32_16x16x32_bf16 v[152:155], v[80:83], v[28:31], v[152:155]
  ds_read_b128 v[24:27], v8 offset:0
  v_mfma_f32_16x16x32_bf16 v[156:159], v[84:87], v[28:31], v[156:159]
  ds_read_b128 v[28:31], v8 offset:2048
  v_mfma_f32_16x16x32_bf16 v[160:163], v[72:75], v[32:35], v[160:163]
  ds_read_b64_tr_b16 v[56:57], v16 offset:32768
  v_mfma_f32_16x16x32_bf16 v[164:167], v[76:79], v[32:35], v[164:167]
  ds_read_b64_tr_b16 v[58:59], v16 offset:33792
  v_mfma_f32_16x16x32_bf16 v[168:171], v[80:83], v[32:35], v[168:171]
  ds_read_b64_tr_b16 v[60:61], v17 offset:32768
  v_mfma_f32_16x16x32_bf16 v[172:175], v[84:87], v[32:35], v[172:175]
  ds_read_b128 v[32:35], v8 offset:4096
  v_mfma_f32_16x16x32_bf16 v[176:179], v[72:75], v[36:39], v[176:179]
  ds_read_b64_tr_b16 v[62:63], v17 offset:33792
  v_mfma_f32_16x16x32_bf16 v[180:183], v[76:79], v[36:39], v[180:183]
  ds_read_b64_tr_b16 v[64:65], v18 offset:32768
  v_mfma_f32_16x16x32_bf16 v[184:187], v[80:83], v[36:39], v[184:187]
  ds_read_b64_tr_b16 v[66:67], v18 offset:33792
  v_mfma_f32_16x16x32_bf16 v[188:191], v[84:87], v[36:39], v[188:191]
  ds_read_b128 v[36:39], v8 offset:6144
  v_mfma_f32_16x16x32_bf16 v[192:195], v[72:75], v[40:43], v[192:195]
  ds_read_b64_tr_b16 v[68:69], v19 offset:32768
  v_mfma_f32_16x16x32_bf16 v[196:199], v[76:79], v[40:43], v[196:199]
  ds_read_b64_tr_b16 v[70:71], v19 offset:33792
  v_mfma_f32_16x16x32_bf16 v[200:203], v[80:83], v[40:43], v[200:203]
  ds_read_b64_tr_b16 v[96:97], v20 offset:8192
  v_mfma_f32_16x16x32_bf16 v[204:207], v[84:87], v[40:43], v[204:207]
  ds_read_b128 v[40:43], v8 offset:8192
  v_mfma_f32_16x16x32_bf16 v[208:211], v[72:75], v[44:47], v[208:211]
  ds_read_b64_tr_b16 v[98:99], v20 offset:8448
  v_mfma_f32_16x16x32_bf16 v[212:215], v[76:79], v[44:47], v[212:215]
  ds_read_b64_tr_b16 v[100:101], v21 offset:8192
  v_mfma_f32_16x16x32_bf16 v[216:219], v[80:83], v[44:47], v[216:219]
  ds_read_b64_tr_b16 v[102:103], v21 offset:8448
  v_mfma_f32_16x16x32_bf16 v[220:223], v[84:87], v[44:47], v[220:223]
  ds_read_b128 v[44:47], v8 offset:10240
  v_mfma_f32_16x16x32_bf16 v[224:227], v[72:75], v[48:51], v[224:227]
  v_mfma_f32_16x16x32_bf16 v[228:231], v[76:79], v[48:51], v[228:231]
  v_mfma_f32_16x16x32_bf16 v[232:235], v[80:83], v[48:51], v[232:235]
  v_mfma_f32_16x16x32_bf16 v[236:239], v[84:87], v[48:51], v[236:239]
  ds_read_b128 v[48:51], v8 offset:12288
  v_mfma_f32_16x16x32_bf16 v[240:243], v[72:75], v[52:55], v[240:243]
  v_mfma_f32_16x16x32_bf16 v[244:247], v[76:79], v[52:55], v[244:247]
  v_mfma_f32_16x16x32_bf16 v[248:251], v[80:83], v[52:55], v[248:251]
  v_mfma_f32_16x16x32_bf16 v[252:255], v[84:87], v[52:55], v[252:255]
  ds_read_b128 v[52:55], v8 offset:14336
  v_mfma_f32_16x16x32_bf16 v[112:115], v[104:107], v[88:91], v[112:115]
  v_mfma_f32_16x16x32_bf16 v[116:119], v[108:111], v[88:91], v[116:119]
  ds_read_b128 v[88:91], v14 offset:0
  v_mfma_f32_16x16x32_bf16 v[120:123], v[104:107], v[92:95], v[120:123]
  v_mfma_f32_16x16x32_bf16 v[124:127], v[108:111], v[92:95], v[124:127]
  ds_read_b128 v[92:95], v14 offset:2048
  s_cmp_lg_u32 s23, s21
  s_cbranch_scc1 K1XS_12
  buffer_load_dword v0, v1, s[16:19], s20 offen
  s_add_u32 s20, s20, s22
  s_add_u32 s21, s21, 8
  s_cmp_ge_u32 s21, 11
  s_cselect_b32 s21, -1, s21
K1XS_12:
  s_add_u32 s23, s23, 1
  s_waitcnt lgkmcnt(15)
  v_mfma_f32_16x16x32_bf16 v[128:131], v[56:59], v[24:27], v[128:131]
  ds_read_b64_tr_b16 v[72:73], v16 offset:40960
  v_mfma_f32_16x16x32_bf16 v[132:135], v[60:63], v[24:27], v[132:135]
  ds_read_b64_tr_b16 v[74:75], v16 offset:41984
  s_waitcnt lgkmcnt(15)
  v_mfma_f32_16x16x32_bf16 v[136:139], v[64:67], v[24:27], v[136:139]
  ds_read_b64_tr_b16 v[76:77], v17 offset:40960
  s_waitcnt lgkmcnt(13)
  v_mfma_f32_16x16x32_bf16 v[140:143], v[68:71], v[24:27], v[140:143]
  ds_read_b128 v[24:27], v9 offset:0
  v_mfma_f32_16x16x32_bf16 v[144:147], v[56:59], v[28:31], v[144:147]
  ds_read_b64_tr_b16 v[78:79], v17 offset:41984
  v_mfma_f32_16x16x32_bf16 v[148:151], v[60:63], v[28:31], v[148:151]
  ds_read_b64_tr_b16 v[80:81], v18 offset:40960
  v_mfma_f32_16x16x32_bf16 v[152:155], v[64:67], v[28:31], v[152:155]
  ds_read_b64_tr_b16 v[82:83], v18 offset:41984
  v_mfma_f32_16x16x32_bf16 v[156:159], v[68:71], v[28:31], v[156:159]
  ds_read_b128 v[28:31], v9 offset:2048
  v_mfma_f32_16x16x32_bf16 v[160:163], v[56:59], v[32:35], v[160:163]
  ds_read_b64_tr_b16 v[84:85], v19 offset:40960
  v_mfma_f32_16x16x32_bf16 v[164:167], v[60:63], v[32:35], v[164:167]
  ds_read_b64_tr_b16 v[86:87], v19 offset:41984
  v_mfma_f32_16x16x32_bf16 v[168:171], v[64:67], v[32:35], v[168:171]
  ds_read_b64_tr_b16 v[104:105], v20 offset:10240
  v_mfma_f32_16x16x32_bf16 v[172:175], v[68:71], v[32:35], v[172:175]
  ds_read_b128 v[32:35], v9 offset:4096
  v_mfma_f32_16x16x32_bf16 v[176:179], v[56:59], v[36:39], v[176:179]
  ds_read_b64_tr_b16 v[106:107], v20 offset:10496
  v_mfma_f32_16x16x32_bf16 v[180:183], v[60:63], v[36:39], v[180:183]
  ds_read_b64_tr_b16 v[108:109], v21 offset:10240
  v_mfma_f32_16x16x32_bf16 v[184:187], v[64:67], v[36:39], v[184:187]
  ds_read_b64_tr_b16 v[110:111], v21 offset:10496
  v_mfma_f32_16x16x32_bf16 v[188:191], v[68:71], v[36:39], v[188:191]
  ds_read_b128 v[36:39], v9 offset:6144
  s_waitcnt lgkmcnt(15)
  v_mfma_f32_16x16x32_bf16 v[192:195], v[56:59], v[40:43], v[192:195]
  v_mfma_f32_16x16x32_bf16 v[196:199], v[60:63], v[40:43], v[196:199]
  v_mfma_f32_16x16x32_bf16 v[200:203], v[64:67], v[40:43], v[200:203]
  v_mfma_f32_16x16x32_bf16 v[204:207], v[68:71], v[40:43], v[204:207]
  ds_read_b128 v[40:43], v9 offset:8192
  v_mfma_f32_16x16x32_bf16 v[208:211], v[56:59], v[44:47], v[208:211]
  v_mfma_f32_16x16x32_bf16 v[212:215], v[60:63], v[44:47], v[212:215]
  v_mfma_f32_16x16x32_bf16 v[216:219], v[64:67], v[44:47], v[216:219]
  v_mfma_f32_16x16x32_bf16 v[220:223], v[68:71], v[44:47], v[220:223]
  ds_read_b128 v[44:47], v9 offset:10240
  v_mfma_f32_16x16x32_bf16 v[224:227], v[56:59], v[48:51], v[224:227]
  v_mfma_f32_16x16x32_bf16 v[228:231], v[60:63], v[48:51], v[228:231]
  v_mfma_f32_16x16x32_bf16 v[232:235], v[64:67], v[48:51], v[232:235]
  v_mfma_f32_16x16x32_bf16 v[236:239], v[68:71], v[48:51], v[236:239]
  ds_read_b128 v[48:51], v9 offset:12288
  v_mfma_f32_16x16x32_bf16 v[240:243], v[56:59], v[52:55], v[240:243]
  v_mfma_f32_16x16x32_bf16 v[244:247], v[60:63], v[52:55], v[244:247]
  v_mfma_f32_16x16x32_bf16 v[248:251], v[64:67], v[52:55], v[248:251]
  v_mfma_f32_16x16x32_bf16 v[252:255], v[68:71], v[52:55], v[252:255]
  ds_read_b128 v[52:55], v9 offset:14336
  v_mfma_f32_16x16x32_bf16 v[112:115], v[96:99], v[88:91], v[112:115]
  v_mfma_f32_16x16x32_bf16 v[116:119], v[100:103], v[88:91], v[116:119]
  ds_read_b128 v[88:91], v15 offset:0
  v_mfma_f32_16x16x32_bf16 v[120:123], v[96:99], v[92:95], v[120:123]
  v_mfma_f32_16x16x32_bf16 v[124:127], v[100:103], v[92:95], v[124:127]
  ds_read_b128 v[92:95], v15 offset:2048
  s_waitcnt lgkmcnt(15)
  v_mfma_f32_16x16x32_bf16 v[128:131], v[72:75], v[24:27], v[128:131]
  v_mfma_f32_16x16x32_bf16 v[132:135], v[76:79], v[24:27], v[132:135]
  v_mfma_f32_16x16x32_bf16 v[136:139], v[80:83], v[24:27], v[136:139]
  s_waitcnt lgkmcnt(12)
  v_mfma_f32_16x16x32_bf16 v[140:143], v[84:87], v[24:27], v[140:143]
  v_mfma_f32_16x16x32_bf16 v[144:147], v[72:75], v[28:31], v[144:147]
  v_mfma_f32_16x16x32_bf16 v[148:151], v[76:79], v[28:31], v[148:151]
  s_waitcnt lgkmcnt(0)
  s_barrier
  v_mfma_f32_16x16x32_bf16 v[152:155], v[80:83], v[28:31], v[152:155]
  ds_read_b128 v[24:27], v4 offset:0
  v_mfma_f32_16x16x32_bf16 v[156:159], v[84:87], v[28:31], v[156:159]
  ds_read_b128 v[28:31], v4 offset:2048
  v_mfma_f32_16x16x32_bf16 v[160:163], v[72:75], v[32:35], v[160:163]
  ds_read_b64_tr_b16 v[56:57], v16 offset:0
  v_mfma_f32_16x16x32_bf16 v[164:167], v[76:79], v[32:35], v[164:167]
  ds_read_b64_tr_b16 v[58:59], v16 offset:1024
  v_mfma_f32_16x16x32_bf16 v[168:171], v[80:83], v[32:35], v[168:171]
  ds_read_b64_tr_b16 v[60:61], v17 offset:0
  v_mfma_f32_16x16x32_bf16 v[172:175], v[84:87], v[32:35], v[172:175]
  ds_read_b128 v[32:35], v4 offset:4096
  v_mfma_f32_16x16x32_bf16 v[176:179], v[72:75], v[36:39], v[176:179]
  ds_read_b64_tr_b16 v[62:63], v17 offset:1024
  v_mfma_f32_16x16x32_bf16 v[180:183], v[76:79], v[36:39], v[180:183]
  ds_read_b64_tr_b16 v[64:65], v18 offset:0
  v_mfma_f32_16x16x32_bf16 v[184:187], v[80:83], v[36:39], v[184:187]
  ds_read_b64_tr_b16 v[66:67], v18 offset:1024
  v_mfma_f32_16x16x32_bf16 v[188:191], v[84:87], v[36:39], v[188:191]
  ds_read_b128 v[36:39], v4 offset:6144
  v_mfma_f32_16x16x32_bf16 v[192:195], v[72:75], v[40:43], v[192:195]
  ds_read_b64_tr_b16 v[68:69], v19 offset:0
  v_mfma_f32_16x16x32_bf16 v[196:199], v[76:79], v[40:43], v[196:199]
  ds_read_b64_tr_b16 v[70:71], v19 offset:1024
  v_mfma_f32_16x16x32_bf16 v[200:203], v[80:83], v[40:43], v[200:203]
  ds_read_b64_tr_b16 v[96:97], v20 offset:0
  v_mfma_f32_16x16x32_bf16 v[204:207], v[84:87], v[40:43], v[204:207]
  ds_read_b128 v[40:43], v4 offset:8192
  v_mfma_f32_16x16x32_bf16 v[208:211], v[72:75], v[44:47], v[208:211]
  ds_read_b64_tr_b16 v[98:99], v20 offset:256
  v_mfma_f32_16x16x32_bf16 v[212:215], v[76:79], v[44:47], v[212:215]
  ds_read_b64_tr_b16 v[100:101], v21 offset:0
  v_mfma_f32_16x16x32_bf16 v[216:219], v[80:83], v[44:47], v[216:219]
  ds_read_b64_tr_b16 v[102:103], v21 offset:256
  v_mfma_f32_16x16x32_bf16 v[220:223], v[84:87], v[44:47], v[220:223]
  ds_read_b128 v[44:47], v4 offset:10240
  v_mfma_f32_16x16x32_bf16 v[224:227], v[72:75], v[48:51], v[224:227]
  v_mfma_f32_16x16x32_bf16 v[228:231], v[76:79], v[48:51], v[228:231]
  v_mfma_f32_16x16x32_bf16 v[232:235], v[80:83], v[48:51], v[232:235]
  v_mfma_f32_16x16x32_bf16 v[236:239], v[84:87], v[48:51], v[236:239]
  ds_read_b128 v[48:51], v4 offset:12288
  v_mfma_f32_16x16x32_bf16 v[240:243], v[72:75], v[52:55], v[240:243]
  v_mfma_f32_16x16x32_bf16 v[244:247], v[76:79], v[52:55], v[244:247]
  v_mfma_f32_16x16x32_bf16 v[248:251], v[80:83], v[52:55], v[248:251]
  v_mfma_f32_16x16x32_bf16 v[252:255], v[84:87], v[52:55], v[252:255]
  ds_read_b128 v[52:55], v4 offset:14336
  v_mfma_f32_16x16x32_bf16 v[112:115], v[104:107], v[88:91], v[112:115]
  v_mfma_f32_16x16x32_bf16 v[116:119], v[108:111], v[88:91], v[116:119]
  ds_read_b128 v[88:91], v10 offset:0
  v_mfma_f32_16x16x32_bf16 v[120:123], v[104:107], v[92:95], v[120:123]
  v_mfma_f32_16x16x32_bf16 v[124:127], v[108:111], v[92:95], v[124:127]
  ds_read_b128 v[92:95], v10 offset:2048
  s_sub_u32 s11, s11, 1
  s_cmp_lg_u32 s11, 0
  s_cbranch_scc1 K1C_9
  s_waitcnt lgkmcnt(15)
  v_mfma_f32_16x16x32_bf16 v[128:131], v[56:59], v[24:27], v[128:131]
  ds_read_b64_tr_b16 v[72:73], v16 offset:8192
  v_mfma_f32_16x16x32_bf16 v[132:135], v[60:63], v[24:27], v[132:135]
  ds_read_b64_tr_b16 v[74:75], v16 offset:9216
  s_waitcnt lgkmcnt(15)
  v_mfma_f32_16x16x32_bf16 v[136:139], v[64:67], v[24:27], v[136:139]
  ds_read_b64_tr_b16 v[76:77], v17 offset:8192
  s_waitcnt lgkmcnt(13)
  v_mfma_f32_16x16x32_bf16 v[140:143], v[68:71], v[24:27], v[140:143]
  ds_read_b128 v[24:27], v5 offset:0
  v_mfma_f32_16x16x32_bf16 v[144:147], v[56:59], v[28:31], v[144:147]
  ds_read_b64_tr_b16 v[78:79], v17 offset:9216
  v_mfma_f32_16x16x32_bf16 v[148:151], v[60:63], v[28:31], v[148:151]
  ds_read_b64_tr_b16 v[80:81], v18 offset:8192
  v_mfma_f32_16x16x32_bf16 v[152:155], v[64:67], v[28:31], v[152:155]
  ds_read_b64_tr_b16 v[82:83], v18 offset:9216
  v_mfma_f32_16x16x32_bf16 v[156:159], v[68:71], v[28:31], v[156:159]
  ds_read_b128 v[28:31], v5 offset:2048
  v_mfma_f32_16x16x32_bf16 v[160:163], v[56:59], v[32:35], v[160:163]
  ds_read_b64_tr_b16 v[84:85], v19 offset:8192
  v_mfma_f32_16x16x32_bf16 v[164:167], v[60:63], v[32:35], v[164:167]
  ds_read_b64_tr_b16 v[86:87], v19 offset:9216
  v_mfma_f32_16x16x32_bf16 v[168:171], v[64:67], v[32:35], v[168:171]
  ds_read_b64_tr_b16 v[104:105], v20 offset:2048
  v_mfma_f32_16x16x32_bf16 v[172:175], v[68:71], v[32:35], v[172:175]
  ds_read_b128 v[32:35], v5 offset:4096
  v_mfma_f32_16x16x32_bf16 v[176:179], v[56:59], v[36:39], v[176:179]
  ds_read_b64_tr_b16 v[106:107], v20 offset:2304
  v_mfma_f32_16x16x32_bf16 v[180:183], v[60:63], v[36:39], v[180:183]
  ds_read_b64_tr_b16 v[108:109], v21 offset:2048
  v_mfma_f32_16x16x32_bf16 v[184:187], v[64:67], v[36:39], v[184:187]
  ds_read_b64_tr_b16 v[110:111], v21 offset:2304
  v_mfma_f32_16x16x32_bf16 v[188:191], v[68:71], v[36:39], v[188:191]
  ds_read_b128 v[36:39], v5 offset:6144
  s_waitcnt lgkmcnt(15)
  v_mfma_f32_16x16x32_bf16 v[192:195], v[56:59], v[40:43], v[192:195]
  v_mfma_f32_16x16x32_bf16 v[196:199], v[60:63], v[40:43], v[196:199]
  v_mfma_f32_16x16x32_bf16 v[200:203], v[64:67], v[40:43], v[200:203]
  v_mfma_f32_16x16x32_bf16 v[204:207], v[68:71], v[40:43], v[204:207]
  ds_read_b128 v[40:43], v5 offset:8192
  v_mfma_f32_16x16x32_bf16 v[208:211], v[56:59], v[44:47], v[208:211]
  v_mfma_f32_16x16x32_bf16 v[212:215], v[60:63], v[44:47], v[212:215]
  v_mfma_f32_16x16x32_bf16 v[216:219], v[64:67], v[44:47], v[216:219]
  v_mfma_f32_16x16x32_bf16 v[220:223], v[68:71], v[44:47], v[220:223]
  ds_read_b128 v[44:47], v5 offset:10240
  v_mfma_f32_16x16x32_bf16 v[224:227], v[56:59], v[48:51], v[224:227]
  v_mfma_f32_16x16x32_bf16 v[228:231], v[60:63], v[48:51], v[228:231]
  v_mfma_f32_16x16x32_bf16 v[232:235], v[64:67], v[48:51], v[232:235]
  v_mfma_f32_16x16x32_bf16 v[236:239], v[68:71], v[48:51], v[236:239]
  ds_read_b128 v[48:51], v5 offset:12288
  v_mfma_f32_16x16x32_bf16 v[240:243], v[56:59], v[52:55], v[240:243]
  v_mfma_f32_16x16x32_bf16 v[244:247], v[60:63], v[52:55], v[244:247]
  v_mfma_f32_16x16x32_bf16 v[248:251], v[64:67], v[52:55], v[248:251]
  v_mfma_f32_16x16x32_bf16 v[252:255], v[68:71], v[52:55], v[252:255]
  ds_read_b128 v[52:55], v5 offset:14336
  v_mfma_f32_16x16x32_bf16 v[112:115], v[96:99], v[88:91], v[112:115]
  v_mfma_f32_16x16x32_bf16 v[116:119], v[100:103], v[88:91], v[116:119]
  ds_read_b128 v[88:91], v11 offset:0
  v_mfma_f32_16x16x32_bf16 v[120:123], v[96:99], v[92:95], v[120:123]
  v_mfma_f32_16x16x32_bf16 v[124:127], v[100:103], v[92:95], v[124:127]
  ds_read_b128 v[92:95], v11 offset:2048
  s_waitcnt lgkmcnt(15)
  v_mfma_f32_16x16x32_bf16 v[128:131], v[72:75], v[24:27], v[128:131]
  v_mfma_f32_16x16x32_bf16 v[132:135], v[76:79], v[24:27], v[132:135]
  v_mfma_f32_16x16x32_bf16 v[136:139], v[80:83], v[24:27], v[136:139]
  s_waitcnt lgkmcnt(12)
  v_mfma_f32_16x16x32_bf16 v[140:143], v[84:87], v[24:27], v[140:143]
  v_mfma_f32_16x16x32_bf16 v[144:147], v[72:75], v[28:31], v[144:147]
  v_mfma_f32_16x16x32_bf16 v[148:151], v[76:79], v[28:31], v[148:151]
  s_waitcnt lgkmcnt(0)
  s_barrier
  v_mfma_f32_16x16x32_bf16 v[152:155], v[80:83], v[28:31], v[152:155]
  v_mfma_f32_16x16x32_bf16 v[156:159], v[84:87], v[28:31], v[156:159]
  v_mfma_f32_16x16x32_bf16 v[160:163], v[72:75], v[32:35], v[160:163]
  v_mfma_f32_16x16x32_bf16 v[164:167], v[76:79], v[32:35], v[164:167]
  v_mfma_f32_16x16x32_bf16 v[168:171], v[80:83], v[32:35], v[168:171]
  v_mfma_f32_16x16x32_bf16 v[172:175], v[84:87], v[32:35], v[172:175]
  v_mfma_f32_16x16x32_bf16 v[176:179], v[72:75], v[36:39], v[176:179]
  v_mfma_f32_16x16x32_bf16 v[180:183], v[76:79], v[36:39], v[180:183]
  v_mfma_f32_16x16x32_bf16 v[184:187], v[80:83], v[36:39], v[184:187]
  v_mfma_f32_16x16x32_bf16 v[188:191], v[84:87], v[36:39], v[188:191]
  v_mfma_f32_16x16x32_bf16 v[192:195], v[72:75], v[40:43], v[192:195]
  v_mfma_f32_16x16x32_bf16 v[196:199], v[76:79], v[40:43], v[196:199]
  v_mfma_f32_16x16x32_bf16 v[200:203], v[80:83], v[40:43], v[200:203]
  v_mfma_f32_16x16x32_bf16 v[204:207], v[84:87], v[40:43], v[204:207]
  v_mfma_f32_16x16x32_bf16 v[208:211], v[72:75], v[44:47], v[208:211]
  v_mfma_f32_16x16x32_bf16 v[212:215], v[76:79], v[44:47], v[212:215]
  v_mfma_f32_16x16x32_bf16 v[216:219], v[80:83], v[44:47], v[216:219]
  v_mfma_f32_16x16x32_bf16 v[220:223], v[84:87], v[44:47], v[220:223]
  v_mfma_f32_16x16x32_bf16 v[224:227], v[72:75], v[48:51], v[224:227]
  v_mfma_f32_16x16x32_bf16 v[228:231], v[76:79], v[48:51], v[228:231]
  v_mfma_f32_16x16x32_bf16 v[232:235], v[80:83], v[48:51], v[232:235]
  v_mfma_f32_16x16x32_bf16 v[236:239], v[84:87], v[48:51], v[236:239]
  v_mfma_f32_16x16x32_bf16 v[240:243], v[72:75], v[52:55], v[240:243]
  v_mfma_f32_16x16x32_bf16 v[244:247], v[76:79], v[52:55], v[244:247]
  v_mfma_f32_16x16x32_bf16 v[248:251], v[80:83], v[52:55], v[248:251]
  v_mfma_f32_16x16x32_bf16 v[252:255], v[84:87], v[52:55], v[252:255]
  v_mfma_f32_16x16x32_bf16 v[112:115], v[104:107], v[88:91], v[112:115]
  v_mfma_f32_16x16x32_bf16 v[116:119], v[108:111], v[88:91], v[116:119]
  v_mfma_f32_16x16x32_bf16 v[120:123], v[104:107], v[92:95], v[120:123]
  v_mfma_f32_16x16x32_bf16 v[124:127], v[108:111], v[92:95], v[124:127]
K1W_qk_0:
  v_and_b32 v5, 15, v2
  v_lshrrev_b32 v6, 5, v2
  v_lshl_add_u32 v5, v6, 5, v5
  v_lshlrev_b32 v4, 4, v5
  v_bfe_u32 v6, v2, 4, 1
  v_lshl_add_u32 v4, v6, 10, v4
  s_and_b32 s9, s7, 7
  s_lshl_b32 s9, s9, 2
  s_lshl_b32 s10, s13, 1
  s_add_u32 s9, s9, s10
  s_lshl_b32 s9, s9, 6
  s_lshl_b32 s10, s6, 3
  s_add_u32 s9, s9, s10
  s_lshl_b32 s10, s12, 2
  s_add_u32 s9, s9, s10
  s_lshl_b32 s9, s9, 11
  s_add_u32 s9, s9, s8
  v_cvt_pk_bf16_f32 v24, v128, v129
  v_cvt_pk_bf16_f32 v25, v130, v131
  v_cvt_pk_bf16_f32 v26, v132, v133
  v_cvt_pk_bf16_f32 v27, v134, v135
  s_add_u32 s10, s9, 0
  buffer_store_dwordx4 v[24:27], v4, s[48:51], s10 offen offset:0 sc0 sc1
  v_cvt_pk_bf16_f32 v28, v144, v145
  v_cvt_pk_bf16_f32 v29, v146, v147
  v_cvt_pk_bf16_f32 v30, v148, v149
  v_cvt_pk_bf16_f32 v31, v150, v151
  buffer_store_dwordx4 v[28:31], v4, s[48:51], s10 offen offset:256 sc0 sc1
  v_cvt_pk_bf16_f32 v32, v160, v161
  v_cvt_pk_bf16_f32 v33, v162, v163
  v_cvt_pk_bf16_f32 v34, v164, v165
  v_cvt_pk_bf16_f32 v35, v166, v167
  buffer_store_dwordx4 v[32:35], v4, s[48:51], s10 offen offset:2048 sc0 sc1
  v_cvt_pk_bf16_f32 v36, v176, v177
  v_cvt_pk_bf16_f32 v37, v178, v179
  v_cvt_pk_bf16_f32 v38, v180, v181
  v_cvt_pk_bf16_f32 v39, v182, v183
  buffer_store_dwordx4 v[36:39], v4, s[48:51], s10 offen offset:2304 sc0 sc1
  v_cvt_pk_bf16_f32 v40, v192, v193
  v_cvt_pk_bf16_f32 v41, v194, v195
  v_cvt_pk_bf16_f32 v42, v196, v197
  v_cvt_pk_bf16_f32 v43, v198, v199
  s_add_u32 s10, s9, 4096
  buffer_store_dwordx4 v[40:43], v4, s[48:51], s10 offen offset:0 sc0 sc1
  v_cvt_pk_bf16_f32 v44, v208, v209
  v_cvt_pk_bf16_f32 v45, v210, v211
  v_cvt_pk_bf16_f32 v46, v212, v213
  v_cvt_pk_bf16_f32 v47, v214, v215
  buffer_store_dwordx4 v[44:47], v4, s[48:51], s10 offen offset:256 sc0 sc1
  v_cvt_pk_bf16_f32 v48, v224, v225
  v_cvt_pk_bf16_f32 v49, v226, v227
  v_cvt_pk_bf16_f32 v50, v228, v229
  v_cvt_pk_bf16_f32 v51, v230, v231
  buffer_store_dwordx4 v[48:51], v4, s[48:51], s10 offen offset:2048 sc0 sc1
  v_cvt_pk_bf16_f32 v52, v240, v241
  v_cvt_pk_bf16_f32 v53, v242, v243
  v_cvt_pk_bf16_f32 v54, v244, v245
  v_cvt_pk_bf16_f32 v55, v246, v247
  buffer_store_dwordx4 v[52:55], v4, s[48:51], s10 offen offset:2304 sc0 sc1
  v_cvt_pk_bf16_f32 v24, v136, v137
  v_cvt_pk_bf16_f32 v25, v138, v139
  v_cvt_pk_bf16_f32 v26, v140, v141
  v_cvt_pk_bf16_f32 v27, v142, v143
  s_add_u32 s10, s9, 131072
  buffer_store_dwordx4 v[24:27], v4, s[48:51], s10 offen offset:0 sc0 sc1
  v_cvt_pk_bf16_f32 v28, v152, v153
  v_cvt_pk_bf16_f32 v29, v154, v155
  v_cvt_pk_bf16_f32 v30, v156, v157
  v_cvt_pk_bf16_f32 v31, v158, v159
  buffer_store_dwordx4 v[28:31], v4, s[48:51], s10 offen offset:256 sc0 sc1
  v_cvt_pk_bf16_f32 v32, v168, v169
  v_cvt_pk_bf16_f32 v33, v170, v171
  v_cvt_pk_bf16_f32 v34, v172, v173
  v_cvt_pk_bf16_f32 v35, v174, v175
  buffer_store_dwordx4 v[32:35], v4, s[48:51], s10 offen offset:2048 sc0 sc1
  v_cvt_pk_bf16_f32 v36, v184, v185
  v_cvt_pk_bf16_f32 v37, v186, v187
  v_cvt_pk_bf16_f32 v38, v188, v189
  v_cvt_pk_bf16_f32 v39, v190, v191
  buffer_store_dwordx4 v[36:39], v4, s[48:51], s10 offen offset:2304 sc0 sc1
  v_cvt_pk_bf16_f32 v40, v200, v201
  v_cvt_pk_bf16_f32 v41, v202, v203
  v_cvt_pk_bf16_f32 v42, v204, v205
  v_cvt_pk_bf16_f32 v43, v206, v207
  s_add_u32 s10, s9, 135168
  buffer_store_dwordx4 v[40:43], v4, s[48:51], s10 offen offset:0 sc0 sc1
  v_cvt_pk_bf16_f32 v44, v216, v217
  v_cvt_pk_bf16_f32 v45, v218, v219
  s_cbranch_execz K1W_qk_ret
K1W_qk_1:
  v_cvt_pk_bf16_f32 v46, v220, v221
  v_cvt_pk_bf16_f32 v47, v222, v223
  buffer_store_dwordx4 v[44:47], v4, s[48:51], s10 offen offset:256 sc0 sc1
  v_cvt_pk_bf16_f32 v48, v232, v233
  v_cvt_pk_bf16_f32 v49, v234, v235
  v_cvt_pk_bf16_f32 v50, v236, v237
  v_cvt_pk_bf16_f32 v51, v238, v239
  buffer_store_dwordx4 v[48:51], v4, s[48:51], s10 offen offset:2048 sc0 sc1
  v_cvt_pk_bf16_f32 v52, v248, v249
  v_cvt_pk_bf16_f32 v53, v250, v251
  v_cvt_pk_bf16_f32 v54, v252, v253
  v_cvt_pk_bf16_f32 v55, v254, v255
  buffer_store_dwordx4 v[52:55], v4, s[48:51], s10 offen offset:2304 sc0 sc1
  s_lshl_b32 s9, s6, 15
  s_lshl_b32 s10, s63, 11
  s_add_u32 s9, s9, s10
  s_add_u32 s9, s9, 8388608
  v_and_b32 v5, 4, v2
  v_lshlrev_b32 v5, 2, v5
  v_and_b32 v6, 8, v2
  v_lshrrev_b32 v6, 1, v6
  v_or_b32 v5, v5, v6
  v_and_b32 v6, 3, v2
  v_or_b32 v5, v5, v6
  v_and_b32 v6, 32, v2
  v_or_b32 v5, v5, v6
  v_lshlrev_b32 v7, 4, v5
  v_bfe_u32 v6, v2, 4, 1
  v_lshl_add_u32 v7, v6, 10, v7
  s_mov_b32 s10, 1048744942
  v_mul_f32 v112, s10, v112
  v_mul_f32 v113, s10, v113
  v_mul_f32 v114, s10, v114
  v_mul_f32 v115, s10, v115
  v_mul_f32 v116, s10, v116
  v_mul_f32 v117, s10, v117
  v_mul_f32 v118, s10, v118
  v_mul_f32 v119, s10, v119
  v_mul_f32 v120, s10, v120
  v_mul_f32 v121, s10, v121
  v_mul_f32 v122, s10, v122
  v_mul_f32 v123, s10, v123
  v_mul_f32 v124, s10, v124
  v_mul_f32 v125, s10, v125
  v_mul_f32 v126, s10, v126
  v_mul_f32 v127, s10, v127
  v_mul_f32 v8, v112, v112
  v_fmac_f32 v8, v113, v113
  v_fmac_f32 v8, v114, v114
  v_fmac_f32 v8, v115, v115
  v_fmac_f32 v8, v116, v116
  v_fmac_f32 v8, v117, v117
  v_fmac_f32 v8, v118, v118
  v_fmac_f32 v8, v119, v119
  v_mul_f32 v9, v120, v120
  v_fmac_f32 v9, v121, v121
  v_fmac_f32 v9, v122, v122
  v_fmac_f32 v9, v123, v123
  v_fmac_f32 v9, v124, v124
  v_fmac_f32 v9, v125, v125
  v_fmac_f32 v9, v126, v126
  v_fmac_f32 v9, v127, v127
  s_nop 1
  v_permlane16_swap_b32 v8, v9
  v_add_f32 v8, v8, v9
  v_mov_b32 v9, v8
  s_nop 1
  v_permlane32_swap_b32 v8, v9
  v_add_f32 v8, v8, v9
  v_cvt_pk_bf16_f32 v56, v112, v113
  v_cvt_pk_bf16_f32 v57, v114, v115
  v_cvt_pk_bf16_f32 v58, v116, v117
  v_cvt_pk_bf16_f32 v59, v118, v119
  buffer_store_dwordx4 v[56:59], v7, s[48:51], s9 offen offset:0 sc0 sc1
  v_cvt_pk_bf16_f32 v60, v120, v121
  v_cvt_pk_bf16_f32 v61, v122, v123
  v_cvt_pk_bf16_f32 v62, v124, v125
  v_cvt_pk_bf16_f32 v63, v126, v127
  buffer_store_dwordx4 v[60:63], v7, s[48:51], s9 offen offset:128 sc0 sc1
  v_max_f32_dpp v8, v8, v8 row_shr:1
  s_nop 1
  v_max_f32_dpp v8, v8, v8 row_shr:2
  s_nop 1
  v_max_f32_dpp v8, v8, v8 row_shr:4
  s_nop 1
  v_max_f32_dpp v8, v8, v8 row_shr:8
  s_nop 1
  v_max_f32_dpp v8, v8, v8 row_bcast:15 row_mask:0xa
  s_nop 1
  v_max_f32_dpp v8, v8, v8 row_bcast:31 row_mask:0xc
  s_lshl_b32 s9, s6, 3
  s_add_u32 s9, s9, s63
  s_lshl_b32 s9, s9, 2
  s_add_u32 s9, s9, 13893632
  v_mov_b32 v9, 0
  s_cbranch_execz K1W_qk_ret
  s_mov_b32 exec_lo, 0
  s_mov_b32 exec_hi, 0x80000000
  buffer_store_dword v8, v9, s[48:51], s9 offen
  s_mov_b64 exec, -1
  s_endpgm
K1_qv:
  v_mov_b32 v3, 0
  v_mov_b32 v4, 0
  v_mov_b32 v7, 0
  v_mov_b32 v9, 0
  v_mov_b32 v43, 0
  v_mov_b32 v44, 0
  s_mov_b32 s63, 0
  s_mov_b64 exec, 0
  s_and_b32 s9, s5, 1
  s_cmp_eq_u32 s9, 1
  s_cbranch_scc1 K1W_qv_1
  s_branch K1W_qv_0
K1W_qv_ret:
  s_mov_b64 exec, -1
  v_and_b32 v28, 15, v2
  v_lshrrev_b32 v29, 4, v2
  s_lshl_b32 s9, s12, 14
  v_lshlrev_b32 v24, 7, v28
  v_add_u32 v24, s9, v24
  v_lshrrev_b32 v25, 1, v28
  v_xor_b32 v25, v25, v29
  v_xor_b32 v26, 0, v25
  v_lshl_add_u32 v4, v26, 4, v24
  v_add_u32 v6, 0x8000, v4
  v_add_u32 v8, 0x10000, v4
  v_xor_b32 v26, 4, v25
  v_lshl_add_u32 v5, v26, 4, v24
  v_add_u32 v7, 0x8000, v5
  v_add_u32 v9, 0x10000, v5
  s_and_b32 s9, s7, 7
  s_lshr_b32 s9, s9, 1
  s_lshl_b32 s9, s9, 1
  s_add_u32 s9, s9, s5
  s_mov_b32 s63, s9
  s_lshl_b32 s9, s9, 12
  v_add_u32 v10, s9, v4
  v_add_u32 v11, s9, v5
  v_add_u32 v12, s9, v6
  v_add_u32 v13, s9, v7
  v_add_u32 v14, s9, v8
  v_add_u32 v15, s9, v9
  v_bfe_u32 v24, v2, 2, 2
  v_lshl_add_u32 v25, v29, 3, v24
  v_and_b32 v26, 1, v29
  v_lshl_add_u32 v24, v26, 2, v24
  v_and_b32 v27, 3, v2
  v_lshlrev_b32 v27, 3, v27
  v_lshl_add_u32 v20, v25, 6, v27
  v_add_u32 v20, 147456, v20
  v_lshl_add_u32 v20, v26, 5, v20
  v_xor_b32 v21, 32, v20
  v_lshl_add_u32 v25, v25, 8, v27
  v_add_u32 v25, 98304, v25
  s_lshl_b32 s9, s13, 2
  v_xor_b32 v24, s9, v24
  v_xor_b32 v26, 0, v24
  v_lshl_add_u32 v16, v26, 5, v25
  v_xor_b32 v26, 1, v24
  v_lshl_add_u32 v17, v26, 5, v25
  v_xor_b32 v26, 2, v24
  v_lshl_add_u32 v18, v26, 5, v25
  v_xor_b32 v26, 3, v24
  v_lshl_add_u32 v19, v26, 5, v25
  v_mov_b32 v112, 0
  v_mov_b32 v113, 0
  v_mov_b32 v114, 0
  v_mov_b32 v115, 0
  v_mov_b32 v116, 0
  v_mov_b32 v117, 0
  v_mov_b32 v118, 0
  v_mov_b32 v119, 0
  v_mov_b32 v120, 0
  v_mov_b32 v121, 0
  v_mov_b32 v122, 0
  v_mov_b32 v123, 0
  v_mov_b32 v124, 0
  v_mov_b32 v125, 0
  v_mov_b32 v126, 0
  v_mov_b32 v127, 0
  v_mov_b32 v128, 0
  v_mov_b32 v129, 0
  v_mov_b32 v130, 0
  v_mov_b32 v131, 0
  v_mov_b32 v132, 0
  v_mov_b32 v133, 0
  v_mov_b32 v134, 0
  v_mov_b32 v135, 0
  v_mov_b32 v136, 0
  v_mov_b32 v137, 0
  v_mov_b32 v138, 0
  v_mov_b32 v139, 0
  v_mov_b32 v140, 0
  v_mov_b32 v141, 0
  v_mov_b32 v142, 0
  v_mov_b32 v143, 0
  v_mov_b32 v144, 0
  v_mov_b32 v145, 0
  v_mov_b32 v146, 0
  v_mov_b32 v147, 0
  v_mov_b32 v148, 0
  v_mov_b32 v149, 0
  v_mov_b32 v150, 0
  v_mov_b32 v151, 0
  v_mov_b32 v152, 0
  v_mov_b32 v153, 0
  v_mov_b32 v154, 0
  v_mov_b32 v155, 0
  v_mov_b32 v156, 0
  v_mov_b32 v157, 0
  v_mov_b32 v158, 0
  v_mov_b32 v159, 0
  v_mov_b32 v160, 0
  v_mov_b32 v161, 0
  v_mov_b32 v162, 0
  v_mov_b32 v163, 0
  v_mov_b32 v164, 0
  v_mov_b32 v165, 0
  v_mov_b32 v166, 0
  v_mov_b32 v167, 0
  v_mov_b32 v168, 0
  v_mov_b32 v169, 0
  v_mov_b32 v170, 0
  v_mov_b32 v171, 0
  v_mov_b32 v172, 0
  v_mov_b32 v173, 0
  v_mov_b32 v174, 0
  v_mov_b32 v175, 0
  v_mov_b32 v176, 0
  v_mov_b32 v177, 0
  v_mov_b32 v178, 0
  v_mov_b32 v179, 0
  v_mov_b32 v180, 0
  v_mov_b32 v181, 0
  v_mov_b32 v182, 0
  v_mov_b32 v183, 0
  v_mov_b32 v184, 0
  v_mov_b32 v185, 0
  v_mov_b32 v186, 0
  v_mov_b32 v187, 0
  v_mov_b32 v188, 0
  v_mov_b32 v189, 0
  v_mov_b32 v190, 0
  v_mov_b32 v191, 0
  v_mov_b32 v192, 0
  v_mov_b32 v193, 0
  v_mov_b32 v194, 0
  v_mov_b32 v195, 0
  v_mov_b32 v196, 0
  v_mov_b32 v197, 0
  v_mov_b32 v198, 0
  v_mov_b32 v199, 0
  v_mov_b32 v200, 0
  v_mov_b32 v201, 0
  v_mov_b32 v202, 0
  v_mov_b32 v203, 0
  v_mov_b32 v204, 0
  v_mov_b32 v205, 0
  v_mov_b32 v206, 0
  v_mov_b32 v207, 0
  v_mov_b32 v208, 0
  v_mov_b32 v209, 0
  v_mov_b32 v210, 0
  v_mov_b32 v211, 0
  v_mov_b32 v212, 0
  v_mov_b32 v213, 0
  v_mov_b32 v214, 0
  v_mov_b32 v215, 0
  v_mov_b32 v216, 0
  v_mov_b32 v217, 0
  v_mov_b32 v218, 0
  v_mov_b32 v219, 0
  v_mov_b32 v220, 0
  v_mov_b32 v221, 0
  v_mov_b32 v222, 0
  v_mov_b32 v223, 0
  v_mov_b32 v224, 0
  v_mov_b32 v225, 0
  v_mov_b32 v226, 0
  v_mov_b32 v227, 0
  v_mov_b32 v228, 0
  v_mov_b32 v229, 0
  v_mov_b32 v230, 0
  v_mov_b32 v231, 0
  v_mov_b32 v232, 0
  v_mov_b32 v233, 0
  v_mov_b32 v234, 0
  v_mov_b32 v235, 0
  v_mov_b32 v236, 0
  v_mov_b32 v237, 0
  v_mov_b32 v238, 0
  v_mov_b32 v239, 0
  v_mov_b32 v240, 0
  v_mov_b32 v241, 0
  v_mov_b32 v242, 0
  v_mov_b32 v243, 0
  v_mov_b32 v244, 0
  v_mov_b32 v245, 0
  v_mov_b32 v246, 0
  v_mov_b32 v247, 0
  v_mov_b32 v248, 0
  v_mov_b32 v249, 0
  v_mov_b32 v250, 0
  v_mov_b32 v251, 0
  v_mov_b32 v252, 0
  v_mov_b32 v253, 0
  v_mov_b32 v254, 0
  v_mov_b32 v255, 0
  s_barrier
  ds_read_b128 v[24:27], v4 offset:0
  ds_read_b128 v[28:31], v4 offset:2048
  ds_read_b64_tr_b16 v[56:57], v16 offset:0
  ds_read_b64_tr_b16 v[58:59], v16 offset:1024
  ds_read_b64_tr_b16 v[60:61], v17 offset:0
  ds_read_b128 v[32:35], v4 offset:4096
  ds_read_b64_tr_b16 v[62:63], v17 offset:1024
  ds_read_b64_tr_b16 v[64:65], v18 offset:0
  ds_read_b64_tr_b16 v[66:67], v18 offset:1024
  ds_read_b128 v[36:39], v4 offset:6144
  ds_read_b64_tr_b16 v[68:69], v19 offset:0
  ds_read_b64_tr_b16 v[70:71], v19 offset:1024
  ds_read_b64_tr_b16 v[96:97], v20 offset:0
  ds_read_b128 v[40:43], v4 offset:8192
  ds_read_b64_tr_b16 v[98:99], v20 offset:256
  ds_read_b64_tr_b16 v[100:101], v21 offset:0
  ds_read_b64_tr_b16 v[102:103], v21 offset:256
  ds_read_b128 v[44:47], v4 offset:10240
  ds_read_b128 v[48:51], v4 offset:12288
  ds_read_b128 v[52:55], v4 offset:14336
  ds_read_b128 v[88:91], v10 offset:0
  ds_read_b128 v[92:95], v10 offset:2048
  s_mov_b32 s11, 5
.p2align 6
K1C_13:
  s_cmp_lg_u32 s23, s21
  s_cbranch_scc1 K1XS_14
  buffer_load_dword v0, v1, s[16:19], s20 offen
  s_add_u32 s20, s20, s22
  s_add_u32 s21, s21, 8
  s_cmp_ge_u32 s21, 11
  s_cselect_b32 s21, -1, s21
K1XS_14:
  s_add_u32 s23, s23, 1
  s_waitcnt lgkmcnt(15)
  v_mfma_f32_16x16x32_bf16 v[128:131], v[56:59], v[24:27], v[128:131]
  ds_read_b64_tr_b16 v[72:73], v16 offset:8192
  v_mfma_f32_16x16x32_bf16 v[132:135], v[60:63], v[24:27], v[132:135]
  ds_read_b64_tr_b16 v[74:75], v16 offset:9216
  s_waitcnt lgkmcnt(15)
  v_mfma_f32_16x16x32_bf16 v[136:139], v[64:67], v[24:27], v[136:139]
  ds_read_b64_tr_b16 v[76:77], v17 offset:8192
  s_waitcnt lgkmcnt(13)
  v_mfma_f32_16x16x32_bf16 v[140:143], v[68:71], v[24:27], v[140:143]
  ds_read_b128 v[24:27], v5 offset:0
  v_mfma_f32_16x16x32_bf16 v[144:147], v[56:59], v[28:31], v[144:147]
  ds_read_b64_tr_b16 v[78:79], v17 offset:9216
  v_mfma_f32_16x16x32_bf16 v[148:151], v[60:63], v[28:31], v[148:151]
  ds_read_b64_tr_b16 v[80:81], v18 offset:8192
  v_mfma_f32_16x16x32_bf16 v[152:155], v[64:67], v[28:31], v[152:155]
  ds_read_b64_tr_b16 v[82:83], v18 offset:9216
  v_mfma_f32_16x16x32_bf16 v[156:159], v[68:71], v[28:31], v[156:159]
  ds_read_b128 v[28:31], v5 offset:2048
  v_mfma_f32_16x16x32_bf16 v[160:163], v[56:59], v[32:35], v[160:163]
  ds_read_b64_tr_b16 v[84:85], v19 offset:8192
  v_mfma_f32_16x16x32_bf16 v[164:167], v[60:63], v[32:35], v[164:167]
  ds_read_b64_tr_b16 v[86:87], v19 offset:9216
  v_mfma_f32_16x16x32_bf16 v[168:171], v[64:67], v[32:35], v[168:171]
  ds_read_b64_tr_b16 v[104:105], v20 offset:2048
  v_mfma_f32_16x16x32_bf16 v[172:175], v[68:71], v[32:35], v[172:175]
  ds_read_b128 v[32:35], v5 offset:4096
  v_mfma_f32_16x16x32_bf16 v[176:179], v[56:59], v[36:39], v[176:179]
  ds_read_b64_tr_b16 v[106:107], v20 offset:2304
  v_mfma_f32_16x16x32_bf16 v[180:183], v[60:63], v[36:39], v[180:183]
  ds_read_b64_tr_b16 v[108:109], v21 offset:2048
  v_mfma_f32_16x16x32_bf16 v[184:187], v[64:67], v[36:39], v[184:187]
  ds_read_b64_tr_b16 v[110:111], v21 offset:2304
  v_mfma_f32_16x16x32_bf16 v[188:191], v[68:71], v[36:39], v[188:191]
  ds_read_b128 v[36:39], v5 offset:6144
  s_waitcnt lgkmcnt(15)
  v_mfma_f32_16x16x32_bf16 v[192:195], v[56:59], v[40:43], v[192:195]
  v_mfma_f32_16x16x32_bf16 v[196:199], v[60:63], v[40:43], v[196:199]
  v_mfma_f32_16x16x32_bf16 v[200:203], v[64:67], v[40:43], v[200:203]
  v_mfma_f32_16x16x32_bf16 v[204:207], v[68:71], v[40:43], v[204:207]
  ds_read_b128 v[40:43], v5 offset:8192
  v_mfma_f32_16x16x32_bf16 v[208:211], v[56:59], v[44:47], v[208:211]
  v_mfma_f32_16x16x32_bf16 v[212:215], v[60:63], v[44:47], v[212:215]
  v_mfma_f32_16x16x32_bf16 v[216:219], v[64:67], v[44:47], v[216:219]
  v_mfma_f32_16x16x32_bf16 v[220:223], v[68:71], v[44:47], v[220:223]
  ds_read_b128 v[44:47], v5 offset:10240
  v_mfma_f32_16x16x32_bf16 v[224:227], v[56:59], v[48:51], v[224:227]
  v_mfma_f32_16x16x32_bf16 v[228:231], v[60:63], v[48:51], v[228:231]
  v_mfma_f32_16x16x32_bf16 v[232:235], v[64:67], v[48:51], v[232:235]
  v_mfma_f32_16x16x32_bf16 v[236:239], v[68:71], v[48:51], v[236:239]
  ds_read_b128 v[48:51], v5 offset:12288
  v_mfma_f32_16x16x32_bf16 v[240:243], v[56:59], v[52:55], v[240:243]
  v_mfma_f32_16x16x32_bf16 v[244:247], v[60:63], v[52:55], v[244:247]
  v_mfma_f32_16x16x32_bf16 v[248:251], v[64:67], v[52:55], v[248:251]
  v_mfma_f32_16x16x32_bf16 v[252:255], v[68:71], v[52:55], v[252:255]
  ds_read_b128 v[52:55], v5 offset:14336
  v_mfma_f32_16x16x32_bf16 v[112:115], v[88:91], v[96:99], v[112:115]
  v_mfma_f32_16x16x32_bf16 v[116:119], v[88:91], v[100:103], v[116:119]
  ds_read_b128 v[88:91], v11 offset:0
  v_mfma_f32_16x16x32_bf16 v[120:123], v[92:95], v[96:99], v[120:123]
  v_mfma_f32_16x16x32_bf16 v[124:127], v[92:95], v[100:103], v[124:127]
  ds_read_b128 v[92:95], v11 offset:2048
  s_waitcnt lgkmcnt(15)
  v_mfma_f32_16x16x32_bf16 v[128:131], v[72:75], v[24:27], v[128:131]
  v_mfma_f32_16x16x32_bf16 v[132:135], v[76:79], v[24:27], v[132:135]
  v_mfma_f32_16x16x32_bf16 v[136:139], v[80:83], v[24:27], v[136:139]
  s_waitcnt lgkmcnt(12)
  v_mfma_f32_16x16x32_bf16 v[140:143], v[84:87], v[24:27], v[140:143]
  v_mfma_f32_16x16x32_bf16 v[144:147], v[72:75], v[28:31], v[144:147]
  v_mfma_f32_16x16x32_bf16 v[148:151], v[76:79], v[28:31], v[148:151]
  s_waitcnt lgkmcnt(0)
  s_barrier
  v_mfma_f32_16x16x32_bf16 v[152:155], v[80:83], v[28:31], v[152:155]
  ds_read_b128 v[24:27], v6 offset:0
  v_mfma_f32_16x16x32_bf16 v[156:159], v[84:87], v[28:31], v[156:159]
  ds_read_b128 v[28:31], v6 offset:2048
  v_mfma_f32_16x16x32_bf16 v[160:163], v[72:75], v[32:35], v[160:163]
  ds_read_b64_tr_b16 v[56:57], v16 offset:16384
  v_mfma_f32_16x16x32_bf16 v[164:167], v[76:79], v[32:35], v[164:167]
  ds_read_b64_tr_b16 v[58:59], v16 offset:17408
  v_mfma_f32_16x16x32_bf16 v[168:171], v[80:83], v[32:35], v[168:171]
  ds_read_b64_tr_b16 v[60:61], v17 offset:16384
  v_mfma_f32_16x16x32_bf16 v[172:175], v[84:87], v[32:35], v[172:175]
  ds_read_b128 v[32:35], v6 offset:4096
  v_mfma_f32_16x16x32_bf16 v[176:179], v[72:75], v[36:39], v[176:179]
  ds_read_b64_tr_b16 v[62:63], v17 offset:17408
  v_mfma_f32_16x16x32_bf16 v[180:183], v[76:79], v[36:39], v[180:183]
  ds_read_b64_tr_b16 v[64:65], v18 offset:16384
  v_mfma_f32_16x16x32_bf16 v[184:187], v[80:83], v[36:39], v[184:187]
  ds_read_b64_tr_b16 v[66:67], v18 offset:17408
  v_mfma_f32_16x16x32_bf16 v[188:191], v[84:87], v[36:39], v[188:191]
  ds_read_b128 v[36:39], v6 offset:6144
  v_mfma_f32_16x16x32_bf16 v[192:195], v[72:75], v[40:43], v[192:195]
  ds_read_b64_tr_b16 v[68:69], v19 offset:16384
  v_mfma_f32_16x16x32_bf16 v[196:199], v[76:79], v[40:43], v[196:199]
  ds_read_b64_tr_b16 v[70:71], v19 offset:17408
  v_mfma_f32_16x16x32_bf16 v[200:203], v[80:83], v[40:43], v[200:203]
  ds_read_b64_tr_b16 v[96:97], v20 offset:4096
  v_mfma_f32_16x16x32_bf16 v[204:207], v[84:87], v[40:43], v[204:207]
  ds_read_b128 v[40:43], v6 offset:8192
  v_mfma_f32_16x16x32_bf16 v[208:211], v[72:75], v[44:47], v[208:211]
  ds_read_b64_tr_b16 v[98:99], v20 offset:4352
  v_mfma_f32_16x16x32_bf16 v[212:215], v[76:79], v[44:47], v[212:215]
  ds_read_b64_tr_b16 v[100:101], v21 offset:4096
  v_mfma_f32_16x16x32_bf16 v[216:219], v[80:83], v[44:47], v[216:219]
  ds_read_b64_tr_b16 v[102:103], v21 offset:4352
  v_mfma_f32_16x16x32_bf16 v[220:223], v[84:87], v[44:47], v[220:223]
  ds_read_b128 v[44:47], v6 offset:10240
  v_mfma_f32_16x16x32_bf16 v[224:227], v[72:75], v[48:51], v[224:227]
  v_mfma_f32_16x16x32_bf16 v[228:231], v[76:79], v[48:51], v[228:231]
  v_mfma_f32_16x16x32_bf16 v[232:235], v[80:83], v[48:51], v[232:235]
  v_mfma_f32_16x16x32_bf16 v[236:239], v[84:87], v[48:51], v[236:239]
  ds_read_b128 v[48:51], v6 offset:12288
  v_mfma_f32_16x16x32_bf16 v[240:243], v[72:75], v[52:55], v[240:243]
  v_mfma_f32_16x16x32_bf16 v[244:247], v[76:79], v[52:55], v[244:247]
  v_mfma_f32_16x16x32_bf16 v[248:251], v[80:83], v[52:55], v[248:251]
  v_mfma_f32_16x16x32_bf16 v[252:255], v[84:87], v[52:55], v[252:255]
  ds_read_b128 v[52:55], v6 offset:14336
  v_mfma_f32_16x16x32_bf16 v[112:115], v[88:91], v[104:107], v[112:115]
  v_mfma_f32_16x16x32_bf16 v[116:119], v[88:91], v[108:111], v[116:119]
  ds_read_b128 v[88:91], v12 offset:0
  v_mfma_f32_16x16x32_bf16 v[120:123], v[92:95], v[104:107], v[120:123]
  v_mfma_f32_16x16x32_bf16 v[124:127], v[92:95], v[108:111], v[124:127]
  ds_read_b128 v[92:95], v12 offset:2048
  s_cmp_lg_u32 s23, s21
  s_cbranch_scc1 K1XS_15
  buffer_load_dword v0, v1, s[16:19], s20 offen
  s_add_u32 s20, s20, s22
  s_add_u32 s21, s21, 8
  s_cmp_ge_u32 s21, 11
  s_cselect_b32 s21, -1, s21
K1XS_15:
  s_add_u32 s23, s23, 1
  s_waitcnt lgkmcnt(15)
  v_mfma_f32_16x16x32_bf16 v[128:131], v[56:59], v[24:27], v[128:131]
  ds_read_b64_tr_b16 v[72:73], v16 offset:24576
  v_mfma_f32_16x16x32_bf16 v[132:135], v[60:63], v[24:27], v[132:135]
  ds_read_b64_tr_b16 v[74:75], v16 offset:25600
  s_waitcnt lgkmcnt(15)
  v_mfma_f32_16x16x32_bf16 v[136:139], v[64:67], v[24:27], v[136:139]
  ds_read_b64_tr_b16 v[76:77], v17 offset:24576
  s_waitcnt lgkmcnt(13)
  v_mfma_f32_16x16x32_bf16 v[140:143], v[68:71], v[24:27], v[140:143]
  ds_read_b128 v[24:27], v7 offset:0
  v_mfma_f32_16x16x32_bf16 v[144:147], v[56:59], v[28:31], v[144:147]
  ds_read_b64_tr_b16 v[78:79], v17 offset:25600
  v_mfma_f32_16x16x32_bf16 v[148:151], v[60:63], v[28:31], v[148:151]
  ds_read_b64_tr_b16 v[80:81], v18 offset:24576
  v_mfma_f32_16x16x32_bf16 v[152:155], v[64:67], v[28:31], v[152:155]
  ds_read_b64_tr_b16 v[82:83], v18 offset:25600
  v_mfma_f32_16x16x32_bf16 v[156:159], v[68:71], v[28:31], v[156:159]
  ds_read_b128 v[28:31], v7 offset:2048
  v_mfma_f32_16x16x32_bf16 v[160:163], v[56:59], v[32:35], v[160:163]
  ds_read_b64_tr_b16 v[84:85], v19 offset:24576
  v_mfma_f32_16x16x32_bf16 v[164:167], v[60:63], v[32:35], v[164:167]
  ds_read_b64_tr_b16 v[86:87], v19 offset:25600
  v_mfma_f32_16x16x32_bf16 v[168:171], v[64:67], v[32:35], v[168:171]
  ds_read_b64_tr_b16 v[104:105], v20 offset:6144
  v_mfma_f32_16x16x32_bf16 v[172:175], v[68:71], v[32:35], v[172:175]
  ds_read_b128 v[32:35], v7 offset:4096
  v_mfma_f32_16x16x32_bf16 v[176:179], v[56:59], v[36:39], v[176:179]
  ds_read_b64_tr_b16 v[106:107], v20 offset:6400
  v_mfma_f32_16x16x32_bf16 v[180:183], v[60:63], v[36:39], v[180:183]
  ds_read_b64_tr_b16 v[108:109], v21 offset:6144
  v_mfma_f32_16x16x32_bf16 v[184:187], v[64:67], v[36:39], v[184:187]
  ds_read_b64_tr_b16 v[110:111], v21 offset:6400
  v_mfma_f32_16x16x32_bf16 v[188:191], v[68:71], v[36:39], v[188:191]
  ds_read_b128 v[36:39], v7 offset:6144
  s_waitcnt lgkmcnt(15)
  v_mfma_f32_16x16x32_bf16 v[192:195], v[56:59], v[40:43], v[192:195]
  v_mfma_f32_16x16x32_bf16 v[196:199], v[60:63], v[40:43], v[196:199]
  v_mfma_f32_16x16x32_bf16 v[200:203], v[64:67], v[40:43], v[200:203]
  v_mfma_f32_16x16x32_bf16 v[204:207], v[68:71], v[40:43], v[204:207]
  ds_read_b128 v[40:43], v7 offset:8192
  v_mfma_f32_16x16x32_bf16 v[208:211], v[56:59], v[44:47], v[208:211]
  v_mfma_f32_16x16x32_bf16 v[212:215], v[60:63], v[44:47], v[212:215]
  v_mfma_f32_16x16x32_bf16 v[216:219], v[64:67], v[44:47], v[216:219]
  v_mfma_f32_16x16x32_bf16 v[220:223], v[68:71], v[44:47], v[220:223]
  ds_read_b128 v[44:47], v7 offset:10240
  v_mfma_f32_16x16x32_bf16 v[224:227], v[56:59], v[48:51], v[224:227]
  v_mfma_f32_16x16x32_bf16 v[228:231], v[60:63], v[48:51], v[228:231]
  v_mfma_f32_16x16x32_bf16 v[232:235], v[64:67], v[48:51], v[232:235]
  v_mfma_f32_16x16x32_bf16 v[236:239], v[68:71], v[48:51], v[236:239]
  ds_read_b128 v[48:51], v7 offset:12288
  v_mfma_f32_16x16x32_bf16 v[240:243], v[56:59], v[52:55], v[240:243]
  v_mfma_f32_16x16x32_bf16 v[244:247], v[60:63], v[52:55], v[244:247]
  v_mfma_f32_16x16x32_bf16 v[248:251], v[64:67], v[52:55], v[248:251]
  v_mfma_f32_16x16x32_bf16 v[252:255], v[68:71], v[52:55], v[252:255]
  ds_read_b128 v[52:55], v7 offset:14336
  v_mfma_f32_16x16x32_bf16 v[112:115], v[88:91], v[96:99], v[112:115]
  v_mfma_f32_16x16x32_bf16 v[116:119], v[88:91], v[100:103], v[116:119]
  ds_read_b128 v[88:91], v13 offset:0
  v_mfma_f32_16x16x32_bf16 v[120:123], v[92:95], v[96:99], v[120:123]
  v_mfma_f32_16x16x32_bf16 v[124:127], v[92:95], v[100:103], v[124:127]
  ds_read_b128 v[92:95], v13 offset:2048
  s_waitcnt lgkmcnt(15)
  v_mfma_f32_16x16x32_bf16 v[128:131], v[72:75], v[24:27], v[128:131]
  v_mfma_f32_16x16x32_bf16 v[132:135], v[76:79], v[24:27], v[132:135]
  v_mfma_f32_16x16x32_bf16 v[136:139], v[80:83], v[24:27], v[136:139]
  s_waitcnt lgkmcnt(12)
  v_mfma_f32_16x16x32_bf16 v[140:143], v[84:87], v[24:27], v[140:143]
  v_mfma_f32_16x16x32_bf16 v[144:147], v[72:75], v[28:31], v[144:147]
  v_mfma_f32_16x16x32_bf16 v[148:151], v[76:79], v[28:31], v[148:151]
  s_waitcnt lgkmcnt(0)
  s_barrier
  v_mfma_f32_16x16x32_bf16 v[152:155], v[80:83], v[28:31], v[152:155]
  ds_read_b128 v[24:27], v8 offset:0
  v_mfma_f32_16x16x32_bf16 v[156:159], v[84:87], v[28:31], v[156:159]
  ds_read_b128 v[28:31], v8 offset:2048
  v_mfma_f32_16x16x32_bf16 v[160:163], v[72:75], v[32:35], v[160:163]
  ds_read_b64_tr_b16 v[56:57], v16 offset:32768
  v_mfma_f32_16x16x32_bf16 v[164:167], v[76:79], v[32:35], v[164:167]
  ds_read_b64_tr_b16 v[58:59], v16 offset:33792
  v_mfma_f32_16x16x32_bf16 v[168:171], v[80:83], v[32:35], v[168:171]
  ds_read_b64_tr_b16 v[60:61], v17 offset:32768
  v_mfma_f32_16x16x32_bf16 v[172:175], v[84:87], v[32:35], v[172:175]
  ds_read_b128 v[32:35], v8 offset:4096
  v_mfma_f32_16x16x32_bf16 v[176:179], v[72:75], v[36:39], v[176:179]
  ds_read_b64_tr_b16 v[62:63], v17 offset:33792
  v_mfma_f32_16x16x32_bf16 v[180:183], v[76:79], v[36:39], v[180:183]
  ds_read_b64_tr_b16 v[64:65], v18 offset:32768
  v_mfma_f32_16x16x32_bf16 v[184:187], v[80:83], v[36:39], v[184:187]
  ds_read_b64_tr_b16 v[66:67], v18 offset:33792
  v_mfma_f32_16x16x32_bf16 v[188:191], v[84:87], v[36:39], v[188:191]
  ds_read_b128 v[36:39], v8 offset:6144
  v_mfma_f32_16x16x32_bf16 v[192:195], v[72:75], v[40:43], v[192:195]
  ds_read_b64_tr_b16 v[68:69], v19 offset:32768
  v_mfma_f32_16x16x32_bf16 v[196:199], v[76:79], v[40:43], v[196:199]
  ds_read_b64_tr_b16 v[70:71], v19 offset:33792
  v_mfma_f32_16x16x32_bf16 v[200:203], v[80:83], v[40:43], v[200:203]
  ds_read_b64_tr_b16 v[96:97], v20 offset:8192
  v_mfma_f32_16x16x32_bf16 v[204:207], v[84:87], v[40:43], v[204:207]
  ds_read_b128 v[40:43], v8 offset:8192
  v_mfma_f32_16x16x32_bf16 v[208:211], v[72:75], v[44:47], v[208:211]
  ds_read_b64_tr_b16 v[98:99], v20 offset:8448
  v_mfma_f32_16x16x32_bf16 v[212:215], v[76:79], v[44:47], v[212:215]
  ds_read_b64_tr_b16 v[100:101], v21 offset:8192
  v_mfma_f32_16x16x32_bf16 v[216:219], v[80:83], v[44:47], v[216:219]
  ds_read_b64_tr_b16 v[102:103], v21 offset:8448
  v_mfma_f32_16x16x32_bf16 v[220:223], v[84:87], v[44:47], v[220:223]
  ds_read_b128 v[44:47], v8 offset:10240
  v_mfma_f32_16x16x32_bf16 v[224:227], v[72:75], v[48:51], v[224:227]
  v_mfma_f32_16x16x32_bf16 v[228:231], v[76:79], v[48:51], v[228:231]
  v_mfma_f32_16x16x32_bf16 v[232:235], v[80:83], v[48:51], v[232:235]
  v_mfma_f32_16x16x32_bf16 v[236:239], v[84:87], v[48:51], v[236:239]
  ds_read_b128 v[48:51], v8 offset:12288
  v_mfma_f32_16x16x32_bf16 v[240:243], v[72:75], v[52:55], v[240:243]
  v_mfma_f32_16x16x32_bf16 v[244:247], v[76:79], v[52:55], v[244:247]
  v_mfma_f32_16x16x32_bf16 v[248:251], v[80:83], v[52:55], v[248:251]
  v_mfma_f32_16x16x32_bf16 v[252:255], v[84:87], v[52:55], v[252:255]
  ds_read_b128 v[52:55], v8 offset:14336
  v_mfma_f32_16x16x32_bf16 v[112:115], v[88:91], v[104:107], v[112:115]
  v_mfma_f32_16x16x32_bf16 v[116:119], v[88:91], v[108:111], v[116:119]
  ds_read_b128 v[88:91], v14 offset:0
  v_mfma_f32_16x16x32_bf16 v[120:123], v[92:95], v[104:107], v[120:123]
  v_mfma_f32_16x16x32_bf16 v[124:127], v[92:95], v[108:111], v[124:127]
  ds_read_b128 v[92:95], v14 offset:2048
  s_cmp_lg_u32 s23, s21
  s_cbranch_scc1 K1XS_16
  buffer_load_dword v0, v1, s[16:19], s20 offen
  s_add_u32 s20, s20, s22
  s_add_u32 s21, s21, 8
  s_cmp_ge_u32 s21, 11
  s_cselect_b32 s21, -1, s21
K1XS_16:
  s_add_u32 s23, s23, 1
  s_waitcnt lgkmcnt(15)
  v_mfma_f32_16x16x32_bf16 v[128:131], v[56:59], v[24:27], v[128:131]
  ds_read_b64_tr_b16 v[72:73], v16 offset:40960
  v_mfma_f32_16x16x32_bf16 v[132:135], v[60:63], v[24:27], v[132:135]
  ds_read_b64_tr_b16 v[74:75], v16 offset:41984
  s_waitcnt lgkmcnt(15)
  v_mfma_f32_16x16x32_bf16 v[136:139], v[64:67], v[24:27], v[136:139]
  ds_read_b64_tr_b16 v[76:77], v17 offset:40960
  s_waitcnt lgkmcnt(13)
  v_mfma_f32_16x16x32_bf16 v[140:143], v[68:71], v[24:27], v[140:143]
  ds_read_b128 v[24:27], v9 offset:0
  v_mfma_f32_16x16x32_bf16 v[144:147], v[56:59], v[28:31], v[144:147]
  ds_read_b64_tr_b16 v[78:79], v17 offset:41984
  v_mfma_f32_16x16x32_bf16 v[148:151], v[60:63], v[28:31], v[148:151]
  ds_read_b64_tr_b16 v[80:81], v18 offset:40960
  v_mfma_f32_16x16x32_bf16 v[152:155], v[64:67], v[28:31], v[152:155]
  ds_read_b64_tr_b16 v[82:83], v18 offset:41984
  v_mfma_f32_16x16x32_bf16 v[156:159], v[68:71], v[28:31], v[156:159]
  ds_read_b128 v[28:31], v9 offset:2048
  v_mfma_f32_16x16x32_bf16 v[160:163], v[56:59], v[32:35], v[160:163]
  ds_read_b64_tr_b16 v[84:85], v19 offset:40960
  v_mfma_f32_16x16x32_bf16 v[164:167], v[60:63], v[32:35], v[164:167]
  ds_read_b64_tr_b16 v[86:87], v19 offset:41984
  v_mfma_f32_16x16x32_bf16 v[168:171], v[64:67], v[32:35], v[168:171]
  ds_read_b64_tr_b16 v[104:105], v20 offset:10240
  v_mfma_f32_16x16x32_bf16 v[172:175], v[68:71], v[32:35], v[172:175]
  ds_read_b128 v[32:35], v9 offset:4096
  v_mfma_f32_16x16x32_bf16 v[176:179], v[56:59], v[36:39], v[176:179]
  ds_read_b64_tr_b16 v[106:107], v20 offset:10496
  v_mfma_f32_16x16x32_bf16 v[180:183], v[60:63], v[36:39], v[180:183]
  ds_read_b64_tr_b16 v[108:109], v21 offset:10240
  v_mfma_f32_16x16x32_bf16 v[184:187], v[64:67], v[36:39], v[184:187]
  ds_read_b64_tr_b16 v[110:111], v21 offset:10496
  v_mfma_f32_16x16x32_bf16 v[188:191], v[68:71], v[36:39], v[188:191]
  ds_read_b128 v[36:39], v9 offset:6144
  s_waitcnt lgkmcnt(15)
  v_mfma_f32_16x16x32_bf16 v[192:195], v[56:59], v[40:43], v[192:195]
  v_mfma_f32_16x16x32_bf16 v[196:199], v[60:63], v[40:43], v[196:199]
  v_mfma_f32_16x16x32_bf16 v[200:203], v[64:67], v[40:43], v[200:203]
  v_mfma_f32_16x16x32_bf16 v[204:207], v[68:71], v[40:43], v[204:207]
  ds_read_b128 v[40:43], v9 offset:8192
  v_mfma_f32_16x16x32_bf16 v[208:211], v[56:59], v[44:47], v[208:211]
  v_mfma_f32_16x16x32_bf16 v[212:215], v[60:63], v[44:47], v[212:215]
  v_mfma_f32_16x16x32_bf16 v[216:219], v[64:67], v[44:47], v[216:219]
  v_mfma_f32_16x16x32_bf16 v[220:223], v[68:71], v[44:47], v[220:223]
  ds_read_b128 v[44:47], v9 offset:10240
  v_mfma_f32_16x16x32_bf16 v[224:227], v[56:59], v[48:51], v[224:227]
  v_mfma_f32_16x16x32_bf16 v[228:231], v[60:63], v[48:51], v[228:231]
  v_mfma_f32_16x16x32_bf16 v[232:235], v[64:67], v[48:51], v[232:235]
  v_mfma_f32_16x16x32_bf16 v[236:239], v[68:71], v[48:51], v[236:239]
  ds_read_b128 v[48:51], v9 offset:12288
  v_mfma_f32_16x16x32_bf16 v[240:243], v[56:59], v[52:55], v[240:243]
  v_mfma_f32_16x16x32_bf16 v[244:247], v[60:63], v[52:55], v[244:247]
  v_mfma_f32_16x16x32_bf16 v[248:251], v[64:67], v[52:55], v[248:251]
  v_mfma_f32_16x16x32_bf16 v[252:255], v[68:71], v[52:55], v[252:255]
  ds_read_b128 v[52:55], v9 offset:14336
  v_mfma_f32_16x16x32_bf16 v[112:115], v[88:91], v[96:99], v[112:115]
  v_mfma_f32_16x16x32_bf16 v[116:119], v[88:91], v[100:103], v[116:119]
  ds_read_b128 v[88:91], v15 offset:0
  v_mfma_f32_16x16x32_bf16 v[120:123], v[92:95], v[96:99], v[120:123]
  v_mfma_f32_16x16x32_bf16 v[124:127], v[92:95], v[100:103], v[124:127]
  ds_read_b128 v[92:95], v15 offset:2048
  s_waitcnt lgkmcnt(15)
  v_mfma_f32_16x16x32_bf16 v[128:131], v[72:75], v[24:27], v[128:131]
  v_mfma_f32_16x16x32_bf16 v[132:135], v[76:79], v[24:27], v[132:135]
  v_mfma_f32_16x16x32_bf16 v[136:139], v[80:83], v[24:27], v[136:139]
  s_waitcnt lgkmcnt(12)
  v_mfma_f32_16x16x32_bf16 v[140:143], v[84:87], v[24:27], v[140:143]
  v_mfma_f32_16x16x32_bf16 v[144:147], v[72:75], v[28:31], v[144:147]
  v_mfma_f32_16x16x32_bf16 v[148:151], v[76:79], v[28:31], v[148:151]
  s_waitcnt lgkmcnt(0)
  s_barrier
  v_mfma_f32_16x16x32_bf16 v[152:155], v[80:83], v[28:31], v[152:155]
  ds_read_b128 v[24:27], v4 offset:0
  v_mfma_f32_16x16x32_bf16 v[156:159], v[84:87], v[28:31], v[156:159]
  ds_read_b128 v[28:31], v4 offset:2048
  v_mfma_f32_16x16x32_bf16 v[160:163], v[72:75], v[32:35], v[160:163]
  ds_read_b64_tr_b16 v[56:57], v16 offset:0
  v_mfma_f32_16x16x32_bf16 v[164:167], v[76:79], v[32:35], v[164:167]
  ds_read_b64_tr_b16 v[58:59], v16 offset:1024
  v_mfma_f32_16x16x32_bf16 v[168:171], v[80:83], v[32:35], v[168:171]
  ds_read_b64_tr_b16 v[60:61], v17 offset:0
  v_mfma_f32_16x16x32_bf16 v[172:175], v[84:87], v[32:35], v[172:175]
  ds_read_b128 v[32:35], v4 offset:4096
  v_mfma_f32_16x16x32_bf16 v[176:179], v[72:75], v[36:39], v[176:179]
  ds_read_b64_tr_b16 v[62:63], v17 offset:1024
  v_mfma_f32_16x16x32_bf16 v[180:183], v[76:79], v[36:39], v[180:183]
  ds_read_b64_tr_b16 v[64:65], v18 offset:0
  v_mfma_f32_16x16x32_bf16 v[184:187], v[80:83], v[36:39], v[184:187]
  ds_read_b64_tr_b16 v[66:67], v18 offset:1024
  v_mfma_f32_16x16x32_bf16 v[188:191], v[84:87], v[36:39], v[188:191]
  ds_read_b128 v[36:39], v4 offset:6144
  v_mfma_f32_16x16x32_bf16 v[192:195], v[72:75], v[40:43], v[192:195]
  ds_read_b64_tr_b16 v[68:69], v19 offset:0
  v_mfma_f32_16x16x32_bf16 v[196:199], v[76:79], v[40:43], v[196:199]
  ds_read_b64_tr_b16 v[70:71], v19 offset:1024
  v_mfma_f32_16x16x32_bf16 v[200:203], v[80:83], v[40:43], v[200:203]
  ds_read_b64_tr_b16 v[96:97], v20 offset:0
  v_mfma_f32_16x16x32_bf16 v[204:207], v[84:87], v[40:43], v[204:207]
  ds_read_b128 v[40:43], v4 offset:8192
  v_mfma_f32_16x16x32_bf16 v[208:211], v[72:75], v[44:47], v[208:211]
  ds_read_b64_tr_b16 v[98:99], v20 offset:256
  v_mfma_f32_16x16x32_bf16 v[212:215], v[76:79], v[44:47], v[212:215]
  ds_read_b64_tr_b16 v[100:101], v21 offset:0
  v_mfma_f32_16x16x32_bf16 v[216:219], v[80:83], v[44:47], v[216:219]
  ds_read_b64_tr_b16 v[102:103], v21 offset:256
  v_mfma_f32_16x16x32_bf16 v[220:223], v[84:87], v[44:47], v[220:223]
  ds_read_b128 v[44:47], v4 offset:10240
  v_mfma_f32_16x16x32_bf16 v[224:227], v[72:75], v[48:51], v[224:227]
  v_mfma_f32_16x16x32_bf16 v[228:231], v[76:79], v[48:51], v[228:231]
  v_mfma_f32_16x16x32_bf16 v[232:235], v[80:83], v[48:51], v[232:235]
  v_mfma_f32_16x16x32_bf16 v[236:239], v[84:87], v[48:51], v[236:239]
  ds_read_b128 v[48:51], v4 offset:12288
  v_mfma_f32_16x16x32_bf16 v[240:243], v[72:75], v[52:55], v[240:243]
  v_mfma_f32_16x16x32_bf16 v[244:247], v[76:79], v[52:55], v[244:247]
  v_mfma_f32_16x16x32_bf16 v[248:251], v[80:83], v[52:55], v[248:251]
  v_mfma_f32_16x16x32_bf16 v[252:255], v[84:87], v[52:55], v[252:255]
  ds_read_b128 v[52:55], v4 offset:14336
  v_mfma_f32_16x16x32_bf16 v[112:115], v[88:91], v[104:107], v[112:115]
  v_mfma_f32_16x16x32_bf16 v[116:119], v[88:91], v[108:111], v[116:119]
  ds_read_b128 v[88:91], v10 offset:0
  v_mfma_f32_16x16x32_bf16 v[120:123], v[92:95], v[104:107], v[120:123]
  v_mfma_f32_16x16x32_bf16 v[124:127], v[92:95], v[108:111], v[124:127]
  ds_read_b128 v[92:95], v10 offset:2048
  s_sub_u32 s11, s11, 1
  s_cmp_lg_u32 s11, 0
  s_cbranch_scc1 K1C_13
  s_waitcnt lgkmcnt(15)
  v_mfma_f32_16x16x32_bf16 v[128:131], v[56:59], v[24:27], v[128:131]
  ds_read_b64_tr_b16 v[72:73], v16 offset:8192
  v_mfma_f32_16x16x32_bf16 v[132:135], v[60:63], v[24:27], v[132:135]
  ds_read_b64_tr_b16 v[74:75], v16 offset:9216
  s_waitcnt lgkmcnt(15)
  v_mfma_f32_16x16x32_bf16 v[136:139], v[64:67], v[24:27], v[136:139]
  ds_read_b64_tr_b16 v[76:77], v17 offset:8192
  s_waitcnt lgkmcnt(13)
  v_mfma_f32_16x16x32_bf16 v[140:143], v[68:71], v[24:27], v[140:143]
  ds_read_b128 v[24:27], v5 offset:0
  v_mfma_f32_16x16x32_bf16 v[144:147], v[56:59], v[28:31], v[144:147]
  ds_read_b64_tr_b16 v[78:79], v17 offset:9216
  v_mfma_f32_16x16x32_bf16 v[148:151], v[60:63], v[28:31], v[148:151]
  ds_read_b64_tr_b16 v[80:81], v18 offset:8192
  v_mfma_f32_16x16x32_bf16 v[152:155], v[64:67], v[28:31], v[152:155]
  ds_read_b64_tr_b16 v[82:83], v18 offset:9216
  v_mfma_f32_16x16x32_bf16 v[156:159], v[68:71], v[28:31], v[156:159]
  ds_read_b128 v[28:31], v5 offset:2048
  v_mfma_f32_16x16x32_bf16 v[160:163], v[56:59], v[32:35], v[160:163]
  ds_read_b64_tr_b16 v[84:85], v19 offset:8192
  v_mfma_f32_16x16x32_bf16 v[164:167], v[60:63], v[32:35], v[164:167]
  ds_read_b64_tr_b16 v[86:87], v19 offset:9216
  v_mfma_f32_16x16x32_bf16 v[168:171], v[64:67], v[32:35], v[168:171]
  ds_read_b64_tr_b16 v[104:105], v20 offset:2048
  v_mfma_f32_16x16x32_bf16 v[172:175], v[68:71], v[32:35], v[172:175]
  ds_read_b128 v[32:35], v5 offset:4096
  v_mfma_f32_16x16x32_bf16 v[176:179], v[56:59], v[36:39], v[176:179]
  ds_read_b64_tr_b16 v[106:107], v20 offset:2304
  v_mfma_f32_16x16x32_bf16 v[180:183], v[60:63], v[36:39], v[180:183]
  ds_read_b64_tr_b16 v[108:109], v21 offset:2048
  v_mfma_f32_16x16x32_bf16 v[184:187], v[64:67], v[36:39], v[184:187]
  ds_read_b64_tr_b16 v[110:111], v21 offset:2304
  v_mfma_f32_16x16x32_bf16 v[188:191], v[68:71], v[36:39], v[188:191]
  ds_read_b128 v[36:39], v5 offset:6144
  s_waitcnt lgkmcnt(15)
  v_mfma_f32_16x16x32_bf16 v[192:195], v[56:59], v[40:43], v[192:195]
  v_mfma_f32_16x16x32_bf16 v[196:199], v[60:63], v[40:43], v[196:199]
  v_mfma_f32_16x16x32_bf16 v[200:203], v[64:67], v[40:43], v[200:203]
  v_mfma_f32_16x16x32_bf16 v[204:207], v[68:71], v[40:43], v[204:207]
  ds_read_b128 v[40:43], v5 offset:8192
  v_mfma_f32_16x16x32_bf16 v[208:211], v[56:59], v[44:47], v[208:211]
  v_mfma_f32_16x16x32_bf16 v[212:215], v[60:63], v[44:47], v[212:215]
  v_mfma_f32_16x16x32_bf16 v[216:219], v[64:67], v[44:47], v[216:219]
  v_mfma_f32_16x16x32_bf16 v[220:223], v[68:71], v[44:47], v[220:223]
  ds_read_b128 v[44:47], v5 offset:10240
  v_mfma_f32_16x16x32_bf16 v[224:227], v[56:59], v[48:51], v[224:227]
  v_mfma_f32_16x16x32_bf16 v[228:231], v[60:63], v[48:51], v[228:231]
  v_mfma_f32_16x16x32_bf16 v[232:235], v[64:67], v[48:51], v[232:235]
  v_mfma_f32_16x16x32_bf16 v[236:239], v[68:71], v[48:51], v[236:239]
  ds_read_b128 v[48:51], v5 offset:12288
  v_mfma_f32_16x16x32_bf16 v[240:243], v[56:59], v[52:55], v[240:243]
  v_mfma_f32_16x16x32_bf16 v[244:247], v[60:63], v[52:55], v[244:247]
  v_mfma_f32_16x16x32_bf16 v[248:251], v[64:67], v[52:55], v[248:251]
  v_mfma_f32_16x16x32_bf16 v[252:255], v[68:71], v[52:55], v[252:255]
  ds_read_b128 v[52:55], v5 offset:14336
  v_mfma_f32_16x16x32_bf16 v[112:115], v[88:91], v[96:99], v[112:115]
  v_mfma_f32_16x16x32_bf16 v[116:119], v[88:91], v[100:103], v[116:119]
  ds_read_b128 v[88:91], v11 offset:0
  v_mfma_f32_16x16x32_bf16 v[120:123], v[92:95], v[96:99], v[120:123]
  v_mfma_f32_16x16x32_bf16 v[124:127], v[92:95], v[100:103], v[124:127]
  ds_read_b128 v[92:95], v11 offset:2048
  s_waitcnt lgkmcnt(15)
  v_mfma_f32_16x16x32_bf16 v[128:131], v[72:75], v[24:27], v[128:131]
  v_mfma_f32_16x16x32_bf16 v[132:135], v[76:79], v[24:27], v[132:135]
  v_mfma_f32_16x16x32_bf16 v[136:139], v[80:83], v[24:27], v[136:139]
  s_waitcnt lgkmcnt(12)
  v_mfma_f32_16x16x32_bf16 v[140:143], v[84:87], v[24:27], v[140:143]
  v_mfma_f32_16x16x32_bf16 v[144:147], v[72:75], v[28:31], v[144:147]
  v_mfma_f32_16x16x32_bf16 v[148:151], v[76:79], v[28:31], v[148:151]
  s_waitcnt lgkmcnt(0)
  s_barrier
  v_mfma_f32_16x16x32_bf16 v[152:155], v[80:83], v[28:31], v[152:155]
  v_mfma_f32_16x16x32_bf16 v[156:159], v[84:87], v[28:31], v[156:159]
  v_mfma_f32_16x16x32_bf16 v[160:163], v[72:75], v[32:35], v[160:163]
  v_mfma_f32_16x16x32_bf16 v[164:167], v[76:79], v[32:35], v[164:167]
  v_mfma_f32_16x16x32_bf16 v[168:171], v[80:83], v[32:35], v[168:171]
  v_mfma_f32_16x16x32_bf16 v[172:175], v[84:87], v[32:35], v[172:175]
  v_mfma_f32_16x16x32_bf16 v[176:179], v[72:75], v[36:39], v[176:179]
  v_mfma_f32_16x16x32_bf16 v[180:183], v[76:79], v[36:39], v[180:183]
  v_mfma_f32_16x16x32_bf16 v[184:187], v[80:83], v[36:39], v[184:187]
  v_mfma_f32_16x16x32_bf16 v[188:191], v[84:87], v[36:39], v[188:191]
  v_mfma_f32_16x16x32_bf16 v[192:195], v[72:75], v[40:43], v[192:195]
  v_mfma_f32_16x16x32_bf16 v[196:199], v[76:79], v[40:43], v[196:199]
  v_mfma_f32_16x16x32_bf16 v[200:203], v[80:83], v[40:43], v[200:203]
  v_mfma_f32_16x16x32_bf16 v[204:207], v[84:87], v[40:43], v[204:207]
  v_mfma_f32_16x16x32_bf16 v[208:211], v[72:75], v[44:47], v[208:211]
  v_mfma_f32_16x16x32_bf16 v[212:215], v[76:79], v[44:47], v[212:215]
  v_mfma_f32_16x16x32_bf16 v[216:219], v[80:83], v[44:47], v[216:219]
  v_mfma_f32_16x16x32_bf16 v[220:223], v[84:87], v[44:47], v[220:223]
  v_mfma_f32_16x16x32_bf16 v[224:227], v[72:75], v[48:51], v[224:227]
  v_mfma_f32_16x16x32_bf16 v[228:231], v[76:79], v[48:51], v[228:231]
  v_mfma_f32_16x16x32_bf16 v[232:235], v[80:83], v[48:51], v[232:235]
  v_mfma_f32_16x16x32_bf16 v[236:239], v[84:87], v[48:51], v[236:239]
  v_mfma_f32_16x16x32_bf16 v[240:243], v[72:75], v[52:55], v[240:243]
  v_mfma_f32_16x16x32_bf16 v[244:247], v[76:79], v[52:55], v[244:247]
  v_mfma_f32_16x16x32_bf16 v[248:251], v[80:83], v[52:55], v[248:251]
  v_mfma_f32_16x16x32_bf16 v[252:255], v[84:87], v[52:55], v[252:255]
  v_mfma_f32_16x16x32_bf16 v[112:115], v[88:91], v[104:107], v[112:115]
  v_mfma_f32_16x16x32_bf16 v[116:119], v[88:91], v[108:111], v[116:119]
  v_mfma_f32_16x16x32_bf16 v[120:123], v[92:95], v[104:107], v[120:123]
  v_mfma_f32_16x16x32_bf16 v[124:127], v[92:95], v[108:111], v[124:127]
K1W_qv_0:
  v_and_b32 v5, 15, v2
  v_lshrrev_b32 v6, 5, v2
  v_lshl_add_u32 v5, v6, 5, v5
  v_lshlrev_b32 v4, 4, v5
  v_bfe_u32 v6, v2, 4, 1
  v_lshl_add_u32 v4, v6, 10, v4
  s_and_b32 s9, s7, 7
  s_lshl_b32 s9, s9, 2
  s_lshl_b32 s10, s13, 1
  s_add_u32 s9, s9, s10
  s_lshl_b32 s9, s9, 6
  s_lshl_b32 s10, s6, 3
  s_add_u32 s9, s9, s10
  s_lshl_b32 s10, s12, 2
  s_add_u32 s9, s9, s10
  s_lshl_b32 s9, s9, 11
  s_add_u32 s9, s9, s8
  v_cvt_pk_bf16_f32 v24, v128, v129
  v_cvt_pk_bf16_f32 v25, v130, v131
  v_cvt_pk_bf16_f32 v26, v132, v133
  v_cvt_pk_bf16_f32 v27, v134, v135
  s_add_u32 s10, s9, 0
  buffer_store_dwordx4 v[24:27], v4, s[48:51], s10 offen offset:0 sc0 sc1
  v_cvt_pk_bf16_f32 v28, v144, v145
  v_cvt_pk_bf16_f32 v29, v146, v147
  v_cvt_pk_bf16_f32 v30, v148, v149
  v_cvt_pk_bf16_f32 v31, v150, v151
  buffer_store_dwordx4 v[28:31], v4, s[48:51], s10 offen offset:256 sc0 sc1
  v_cvt_pk_bf16_f32 v32, v160, v161
  v_cvt_pk_bf16_f32 v33, v162, v163
  v_cvt_pk_bf16_f32 v34, v164, v165
  v_cvt_pk_bf16_f32 v35, v166, v167
  buffer_store_dwordx4 v[32:35], v4, s[48:51], s10 offen offset:2048 sc0 sc1
  v_cvt_pk_bf16_f32 v36, v176, v177
  v_cvt_pk_bf16_f32 v37, v178, v179
  v_cvt_pk_bf16_f32 v38, v180, v181
  v_cvt_pk_bf16_f32 v39, v182, v183
  buffer_store_dwordx4 v[36:39], v4, s[48:51], s10 offen offset:2304 sc0 sc1
  v_cvt_pk_bf16_f32 v40, v192, v193
  v_cvt_pk_bf16_f32 v41, v194, v195
  v_cvt_pk_bf16_f32 v42, v196, v197
  v_cvt_pk_bf16_f32 v43, v198, v199
  s_add_u32 s10, s9, 4096
  buffer_store_dwordx4 v[40:43], v4, s[48:51], s10 offen offset:0 sc0 sc1
  v_cvt_pk_bf16_f32 v44, v208, v209
  v_cvt_pk_bf16_f32 v45, v210, v211
  v_cvt_pk_bf16_f32 v46, v212, v213
  v_cvt_pk_bf16_f32 v47, v214, v215
  buffer_store_dwordx4 v[44:47], v4, s[48:51], s10 offen offset:256 sc0 sc1
  v_cvt_pk_bf16_f32 v48, v224, v225
  v_cvt_pk_bf16_f32 v49, v226, v227
  v_cvt_pk_bf16_f32 v50, v228, v229
  v_cvt_pk_bf16_f32 v51, v230, v231
  buffer_store_dwordx4 v[48:51], v4, s[48:51], s10 offen offset:2048 sc0 sc1
  v_cvt_pk_bf16_f32 v52, v240, v241
  v_cvt_pk_bf16_f32 v53, v242, v243
  v_cvt_pk_bf16_f32 v54, v244, v245
  v_cvt_pk_bf16_f32 v55, v246, v247
  buffer_store_dwordx4 v[52:55], v4, s[48:51], s10 offen offset:2304 sc0 sc1
  v_cvt_pk_bf16_f32 v24, v136, v137
  v_cvt_pk_bf16_f32 v25, v138, v139
  v_cvt_pk_bf16_f32 v26, v140, v141
  v_cvt_pk_bf16_f32 v27, v142, v143
  s_add_u32 s10, s9, 131072
  buffer_store_dwordx4 v[24:27], v4, s[48:51], s10 offen offset:0 sc0 sc1
  v_cvt_pk_bf16_f32 v28, v152, v153
  v_cvt_pk_bf16_f32 v29, v154, v155
  s_cbranch_execz K1W_qv_ret
K1W_qv_1:
  v_cvt_pk_bf16_f32 v30, v156, v157
  v_cvt_pk_bf16_f32 v31, v158, v159
  buffer_store_dwordx4 v[28:31], v4, s[48:51], s10 offen offset:256 sc0 sc1
  v_cvt_pk_bf16_f32 v32, v168, v169
  v_cvt_pk_bf16_f32 v33, v170, v171
  v_cvt_pk_bf16_f32 v34, v172, v173
  v_cvt_pk_bf16_f32 v35, v174, v175
  buffer_store_dwordx4 v[32:35], v4, s[48:51], s10 offen offset:2048 sc0 sc1
  v_cvt_pk_bf16_f32 v36, v184, v185
  v_cvt_pk_bf16_f32 v37, v186, v187
  v_cvt_pk_bf16_f32 v38, v188, v189
  v_cvt_pk_bf16_f32 v39, v190, v191
  buffer_store_dwordx4 v[36:39], v4, s[48:51], s10 offen offset:2304 sc0 sc1
  v_cvt_pk_bf16_f32 v40, v200, v201
  v_cvt_pk_bf16_f32 v41, v202, v203
  v_cvt_pk_bf16_f32 v42, v204, v205
  v_cvt_pk_bf16_f32 v43, v206, v207
  s_add_u32 s10, s9, 135168
  buffer_store_dwordx4 v[40:43], v4, s[48:51], s10 offen offset:0 sc0 sc1
  v_cvt_pk_bf16_f32 v44, v216, v217
  v_cvt_pk_bf16_f32 v45, v218, v219
  v_cvt_pk_bf16_f32 v46, v220, v221
  v_cvt_pk_bf16_f32 v47, v222, v223
  buffer_store_dwordx4 v[44:47], v4, s[48:51], s10 offen offset:256 sc0 sc1
  v_cvt_pk_bf16_f32 v48, v232, v233
  v_cvt_pk_bf16_f32 v49, v234, v235
  v_cvt_pk_bf16_f32 v50, v236, v237
  v_cvt_pk_bf16_f32 v51, v238, v239
  buffer_store_dwordx4 v[48:51], v4, s[48:51], s10 offen offset:2048 sc0 sc1
  v_cvt_pk_bf16_f32 v52, v248, v249
  v_cvt_pk_bf16_f32 v53, v250, v251
  v_cvt_pk_bf16_f32 v54, v252, v253
  v_cvt_pk_bf16_f32 v55, v254, v255
  buffer_store_dwordx4 v[52:55], v4, s[48:51], s10 offen offset:2304 sc0 sc1
  s_lshl_b32 s9, s6, 15
  s_lshl_b32 s10, s63, 11
  s_add_u32 s9, s9, s10
  s_add_u32 s9, s9, 8404992
  v_max3_f32 v8, |v112|, |v113|, |v114|
  v_max3_f32 v8, v8, |v115|, |v116|
  v_max3_f32 v8, v8, |v117|, |v118|
  v_max3_f32 v8, v8, |v119|, |v120|
  v_max3_f32 v8, v8, |v121|, |v122|
  v_max3_f32 v8, v8, |v123|, |v124|
  v_max3_f32 v8, v8, |v125|, |v126|
  v_max_f32 v8, v8, |v127|
  v_cvt_pk_bf16_f32 v56, v112, v113
  v_cvt_pk_bf16_f32 v57, v114, v115
  v_cvt_pk_bf16_f32 v58, v120, v121
  v_cvt_pk_bf16_f32 v59, v122, v123
  buffer_store_dwordx4 v[56:59], v4, s[48:51], s9 offen offset:0 sc0 sc1
  v_cvt_pk_bf16_f32 v60, v116, v117
  v_cvt_pk_bf16_f32 v61, v118, v119
  v_cvt_pk_bf16_f32 v62, v124, v125
  v_cvt_pk_bf16_f32 v63, v126, v127
  buffer_store_dwordx4 v[60:63], v4, s[48:51], s9 offen offset:256 sc0 sc1
  v_max_f32_dpp v8, v8, v8 row_shr:1
  s_nop 1
  v_max_f32_dpp v8, v8, v8 row_shr:2
  s_nop 1
  v_max_f32_dpp v8, v8, v8 row_shr:4
  s_nop 1
  v_max_f32_dpp v8, v8, v8 row_shr:8
  s_nop 1
  v_max_f32_dpp v8, v8, v8 row_bcast:15 row_mask:0xa
  s_nop 1
  v_max_f32_dpp v8, v8, v8 row_bcast:31 row_mask:0xc
  s_lshl_b32 s9, s6, 3
  s_add_u32 s9, s9, s63
  s_lshl_b32 s9, s9, 2
  s_add_u32 s9, s9, 13893888
  v_mov_b32 v9, 0
  s_cbranch_execz K1W_qv_ret
  s_mov_b32 exec_lo, 0
  s_mov_b32 exec_hi, 0x80000000
  buffer_store_dword v8, v9, s[48:51], s9 offen
  s_mov_b64 exec, -1
  s_endpgm
K1_q:
  v_mov_b32 v3, 0
  v_mov_b32 v4, 0
  v_mov_b32 v7, 0
  v_mov_b32 v9, 0
  v_mov_b32 v43, 0
  v_mov_b32 v44, 0
  s_mov_b32 s63, 0
  s_mov_b64 exec, 0
  s_cmp_lt_u32 s7, 24
  s_cbranch_scc1 K1W_phi_d
  s_and_b32 s9, s5, 1
  s_cmp_eq_u32 s9, 1
  s_cbranch_scc1 K1W_q_1
  s_branch K1W_q_0
K1W_phi_d:
  s_and_b32 s9, s5, 3
  s_cmp_eq_u32 s9, 1
  s_cbranch_scc1 K1W_phi_1
  s_and_b32 s9, s5, 3
  s_cmp_eq_u32 s9, 2
  s_cbranch_scc1 K1W_phi_2
  s_and_b32 s9, s5, 3
  s_cmp_eq_u32 s9, 3
  s_cbranch_scc1 K1W_phi_3
  s_branch K1W_phi_0
K1W_q_ret:
  s_mov_b64 exec, -1
  v_and_b32 v28, 15, v2
  v_lshrrev_b32 v29, 4, v2
  s_lshl_b32 s9, s12, 14
  v_lshlrev_b32 v24, 7, v28
  v_add_u32 v24, s9, v24
  v_lshrrev_b32 v25, 1, v28
  v_xor_b32 v25, v25, v29
  v_xor_b32 v26, 0, v25
  v_lshl_add_u32 v4, v26, 4, v24
  v_add_u32 v6, 0x8000, v4
  v_add_u32 v8, 0x10000, v4
  v_xor_b32 v26, 4, v25
  v_lshl_add_u32 v5, v26, 4, v24
  v_add_u32 v7, 0x8000, v5
  v_add_u32 v9, 0x10000, v5
  v_bfe_u32 v24, v2, 2, 2
  v_lshl_add_u32 v25, v29, 3, v24
  v_and_b32 v26, 1, v29
  v_lshl_add_u32 v24, v26, 2, v24
  v_and_b32 v27, 3, v2
  v_lshlrev_b32 v27, 3, v27
  v_lshl_add_u32 v25, v25, 8, v27
  v_add_u32 v25, 98304, v25
  s_lshl_b32 s9, s13, 2
  v_xor_b32 v24, s9, v24
  v_xor_b32 v26, 0, v24
  v_lshl_add_u32 v16, v26, 5, v25
  v_xor_b32 v26, 1, v24
  v_lshl_add_u32 v17, v26, 5, v25
  v_xor_b32 v26, 2, v24
  v_lshl_add_u32 v18, v26, 5, v25
  v_xor_b32 v26, 3, v24
  v_lshl_add_u32 v19, v26, 5, v25
  v_mov_b32 v128, 0
  v_mov_b32 v129, 0
  v_mov_b32 v130, 0
  v_mov_b32 v131, 0
  v_mov_b32 v132, 0
  v_mov_b32 v133, 0
  v_mov_b32 v134, 0
  v_mov_b32 v135, 0
  v_mov_b32 v136, 0
  v_mov_b32 v137, 0
  v_mov_b32 v138, 0
  v_mov_b32 v139, 0
  v_mov_b32 v140, 0
  v_mov_b32 v141, 0
  v_mov_b32 v142, 0
  v_mov_b32 v143, 0
  v_mov_b32 v144, 0
  v_mov_b32 v145, 0
  v_mov_b32 v146, 0
  v_mov_b32 v147, 0
  v_mov_b32 v148, 0
  v_mov_b32 v149, 0
  v_mov_b32 v150, 0
  v_mov_b32 v151, 0
  v_mov_b32 v152, 0
  v_mov_b32 v153, 0
  v_mov_b32 v154, 0
  v_mov_b32 v155, 0
  v_mov_b32 v156, 0
  v_mov_b32 v157, 0
  v_mov_b32 v158, 0
  v_mov_b32 v159, 0
  v_mov_b32 v160, 0
  v_mov_b32 v161, 0
  v_mov_b32 v162, 0
  v_mov_b32 v163, 0
  v_mov_b32 v164, 0
  v_mov_b32 v165, 0
  v_mov_b32 v166, 0
  v_mov_b32 v167, 0
  v_mov_b32 v168, 0
  v_mov_b32 v169, 0
  v_mov_b32 v170, 0
  v_mov_b32 v171, 0
  v_mov_b32 v172, 0
  v_mov_b32 v173, 0
  v_mov_b32 v174, 0
  v_mov_b32 v175, 0
  v_mov_b32 v176, 0
  v_mov_b32 v177, 0
  v_mov_b32 v178, 0
  v_mov_b32 v179, 0
  v_mov_b32 v180, 0
  v_mov_b32 v181, 0
  v_mov_b32 v182, 0
  v_mov_b32 v183, 0
  v_mov_b32 v184, 0
  v_mov_b32 v185, 0
  v_mov_b32 v186, 0
  v_mov_b32 v187, 0
  v_mov_b32 v188, 0
  v_mov_b32 v189, 0
  v_mov_b32 v190, 0
  v_mov_b32 v191, 0
  v_mov_b32 v192, 0
  v_mov_b32 v193, 0
  v_mov_b32 v194, 0
  v_mov_b32 v195, 0
  v_mov_b32 v196, 0
  v_mov_b32 v197, 0
  v_mov_b32 v198, 0
  v_mov_b32 v199, 0
  v_mov_b32 v200, 0
  v_mov_b32 v201, 0
  v_mov_b32 v202, 0
  v_mov_b32 v203, 0
  v_mov_b32 v204, 0
  v_mov_b32 v205, 0
  v_mov_b32 v206, 0
  v_mov_b32 v207, 0
  v_mov_b32 v208, 0
  v_mov_b32 v209, 0
  v_mov_b32 v210, 0
  v_mov_b32 v211, 0
  v_mov_b32 v212, 0
  v_mov_b32 v213, 0
  v_mov_b32 v214, 0
  v_mov_b32 v215, 0
  v_mov_b32 v216, 0
  v_mov_b32 v217, 0
  v_mov_b32 v218, 0
  v_mov_b32 v219, 0
  v_mov_b32 v220, 0
  v_mov_b32 v221, 0
  v_mov_b32 v222, 0
  v_mov_b32 v223, 0
  v_mov_b32 v224, 0
  v_mov_b32 v225, 0
  v_mov_b32 v226, 0
  v_mov_b32 v227, 0
  v_mov_b32 v228, 0
  v_mov_b32 v229, 0
  v_mov_b32 v230, 0
  v_mov_b32 v231, 0
  v_mov_b32 v232, 0
  v_mov_b32 v233, 0
  v_mov_b32 v234, 0
  v_mov_b32 v235, 0
  v_mov_b32 v236, 0
  v_mov_b32 v237, 0
  v_mov_b32 v238, 0
  v_mov_b32 v239, 0
  v_mov_b32 v240, 0
  v_mov_b32 v241, 0
  v_mov_b32 v242, 0
  v_mov_b32 v243, 0
  v_mov_b32 v244, 0
  v_mov_b32 v245, 0
  v_mov_b32 v246, 0
  v_mov_b32 v247, 0
  v_mov_b32 v248, 0
  v_mov_b32 v249, 0
  v_mov_b32 v250, 0
  v_mov_b32 v251, 0
  v_mov_b32 v252, 0
  v_mov_b32 v253, 0
  v_mov_b32 v254, 0
  v_mov_b32 v255, 0
  s_barrier
  ds_read_b128 v[24:27], v4 offset:0
  ds_read_b128 v[28:31], v4 offset:2048
  ds_read_b64_tr_b16 v[56:57], v16 offset:0
  ds_read_b64_tr_b16 v[58:59], v16 offset:1024
  ds_read_b64_tr_b16 v[60:61], v17 offset:0
  ds_read_b128 v[32:35], v4 offset:4096
  ds_read_b64_tr_b16 v[62:63], v17 offset:1024
  ds_read_b64_tr_b16 v[64:65], v18 offset:0
  ds_read_b64_tr_b16 v[66:67], v18 offset:1024
  ds_read_b128 v[36:39], v4 offset:6144
  ds_read_b64_tr_b16 v[68:69], v19 offset:0
  ds_read_b64_tr_b16 v[70:71], v19 offset:1024
  ds_read_b128 v[40:43], v4 offset:8192
  ds_read_b128 v[44:47], v4 offset:10240
  ds_read_b128 v[48:51], v4 offset:12288
  ds_read_b128 v[52:55], v4 offset:14336
  s_mov_b32 s11, 5
.p2align 6
K1C_17:
  s_cmp_lg_u32 s23, s21
  s_cbranch_scc1 K1XS_18
  buffer_load_dword v0, v1, s[16:19], s20 offen
  s_add_u32 s20, s20, s22
  s_add_u32 s21, s21, 8
  s_cmp_ge_u32 s21, 11
  s_cselect_b32 s21, -1, s21
K1XS_18:
  s_add_u32 s23, s23, 1
  s_waitcnt lgkmcnt(12)
  v_mfma_f32_16x16x32_bf16 v[128:131], v[56:59], v[24:27], v[128:131]
  ds_read_b64_tr_b16 v[72:73], v16 offset:8192
  s_waitcnt lgkmcnt(10)
  v_mfma_f32_16x16x32_bf16 v[132:135], v[60:63], v[24:27], v[132:135]
  ds_read_b64_tr_b16 v[74:75], v16 offset:9216
  s_waitcnt lgkmcnt(9)
  v_mfma_f32_16x16x32_bf16 v[136:139], v[64:67], v[24:27], v[136:139]
  ds_read_b64_tr_b16 v[76:77], v17 offset:8192
  s_waitcnt lgkmcnt(7)
  v_mfma_f32_16x16x32_bf16 v[140:143], v[68:71], v[24:27], v[140:143]
  ds_read_b128 v[24:27], v5 offset:0
  v_mfma_f32_16x16x32_bf16 v[144:147], v[56:59], v[28:31], v[144:147]
  ds_read_b64_tr_b16 v[78:79], v17 offset:9216
  v_mfma_f32_16x16x32_bf16 v[148:151], v[60:63], v[28:31], v[148:151]
  ds_read_b64_tr_b16 v[80:81], v18 offset:8192
  v_mfma_f32_16x16x32_bf16 v[152:155], v[64:67], v[28:31], v[152:155]
  ds_read_b64_tr_b16 v[82:83], v18 offset:9216
  v_mfma_f32_16x16x32_bf16 v[156:159], v[68:71], v[28:31], v[156:159]
  ds_read_b128 v[28:31], v5 offset:2048
  v_mfma_f32_16x16x32_bf16 v[160:163], v[56:59], v[32:35], v[160:163]
  ds_read_b64_tr_b16 v[84:85], v19 offset:8192
  v_mfma_f32_16x16x32_bf16 v[164:167], v[60:63], v[32:35], v[164:167]
  ds_read_b64_tr_b16 v[86:87], v19 offset:9216
  v_mfma_f32_16x16x32_bf16 v[168:171], v[64:67], v[32:35], v[168:171]
  v_mfma_f32_16x16x32_bf16 v[172:175], v[68:71], v[32:35], v[172:175]
  ds_read_b128 v[32:35], v5 offset:4096
  v_mfma_f32_16x16x32_bf16 v[176:179], v[56:59], v[36:39], v[176:179]
  v_mfma_f32_16x16x32_bf16 v[180:183], v[60:63], v[36:39], v[180:183]
  v_mfma_f32_16x16x32_bf16 v[184:187], v[64:67], v[36:39], v[184:187]
  v_mfma_f32_16x16x32_bf16 v[188:191], v[68:71], v[36:39], v[188:191]
  ds_read_b128 v[36:39], v5 offset:6144
  s_waitcnt lgkmcnt(15)
  v_mfma_f32_16x16x32_bf16 v[192:195], v[56:59], v[40:43], v[192:195]
  v_mfma_f32_16x16x32_bf16 v[196:199], v[60:63], v[40:43], v[196:199]
  v_mfma_f32_16x16x32_bf16 v[200:203], v[64:67], v[40:43], v[200:203]
  v_mfma_f32_16x16x32_bf16 v[204:207], v[68:71], v[40:43], v[204:207]
  ds_read_b128 v[40:43], v5 offset:8192
  s_waitcnt lgkmcnt(15)
  v_mfma_f32_16x16x32_bf16 v[208:211], v[56:59], v[44:47], v[208:211]
  v_mfma_f32_16x16x32_bf16 v[212:215], v[60:63], v[44:47], v[212:215]
  v_mfma_f32_16x16x32_bf16 v[216:219], v[64:67], v[44:47], v[216:219]
  v_mfma_f32_16x16x32_bf16 v[220:223], v[68:71], v[44:47], v[220:223]
  ds_read_b128 v[44:47], v5 offset:10240
  s_waitcnt lgkmcnt(15)
  v_mfma_f32_16x16x32_bf16 v[224:227], v[56:59], v[48:51], v[224:227]
  v_mfma_f32_16x16x32_bf16 v[228:231], v[60:63], v[48:51], v[228:231]
  v_mfma_f32_16x16x32_bf16 v[232:235], v[64:67], v[48:51], v[232:235]
  v_mfma_f32_16x16x32_bf16 v[236:239], v[68:71], v[48:51], v[236:239]
  ds_read_b128 v[48:51], v5 offset:12288
  s_waitcnt lgkmcnt(15)
  v_mfma_f32_16x16x32_bf16 v[240:243], v[56:59], v[52:55], v[240:243]
  v_mfma_f32_16x16x32_bf16 v[244:247], v[60:63], v[52:55], v[244:247]
  v_mfma_f32_16x16x32_bf16 v[248:251], v[64:67], v[52:55], v[248:251]
  v_mfma_f32_16x16x32_bf16 v[252:255], v[68:71], v[52:55], v[252:255]
  ds_read_b128 v[52:55], v5 offset:14336
  s_waitcnt lgkmcnt(12)
  v_mfma_f32_16x16x32_bf16 v[128:131], v[72:75], v[24:27], v[128:131]
  s_waitcnt lgkmcnt(11)
  v_mfma_f32_16x16x32_bf16 v[132:135], v[76:79], v[24:27], v[132:135]
  s_waitcnt lgkmcnt(9)
  v_mfma_f32_16x16x32_bf16 v[136:139], v[80:83], v[24:27], v[136:139]
  s_waitcnt lgkmcnt(6)
  v_mfma_f32_16x16x32_bf16 v[140:143], v[84:87], v[24:27], v[140:143]
  v_mfma_f32_16x16x32_bf16 v[144:147], v[72:75], v[28:31], v[144:147]
  v_mfma_f32_16x16x32_bf16 v[148:151], v[76:79], v[28:31], v[148:151]
  s_waitcnt lgkmcnt(0)
  s_barrier
  v_mfma_f32_16x16x32_bf16 v[152:155], v[80:83], v[28:31], v[152:155]
  ds_read_b128 v[24:27], v6 offset:0
  v_mfma_f32_16x16x32_bf16 v[156:159], v[84:87], v[28:31], v[156:159]
  ds_read_b128 v[28:31], v6 offset:2048
  v_mfma_f32_16x16x32_bf16 v[160:163], v[72:75], v[32:35], v[160:163]
  ds_read_b64_tr_b16 v[56:57], v16 offset:16384
  v_mfma_f32_16x16x32_bf16 v[164:167], v[76:79], v[32:35], v[164:167]
  ds_read_b64_tr_b16 v[58:59], v16 offset:17408
  v_mfma_f32_16x16x32_bf16 v[168:171], v[80:83], v[32:35], v[168:171]
  ds_read_b64_tr_b16 v[60:61], v17 offset:16384
  v_mfma_f32_16x16x32_bf16 v[172:175], v[84:87], v[32:35], v[172:175]
  ds_read_b128 v[32:35], v6 offset:4096
  v_mfma_f32_16x16x32_bf16 v[176:179], v[72:75], v[36:39], v[176:179]
  ds_read_b64_tr_b16 v[62:63], v17 offset:17408
  v_mfma_f32_16x16x32_bf16 v[180:183], v[76:79], v[36:39], v[180:183]
  ds_read_b64_tr_b16 v[64:65], v18 offset:16384
  v_mfma_f32_16x16x32_bf16 v[184:187], v[80:83], v[36:39], v[184:187]
  ds_read_b64_tr_b16 v[66:67], v18 offset:17408
  v_mfma_f32_16x16x32_bf16 v[188:191], v[84:87], v[36:39], v[188:191]
  ds_read_b128 v[36:39], v6 offset:6144
  v_mfma_f32_16x16x32_bf16 v[192:195], v[72:75], v[40:43], v[192:195]
  ds_read_b64_tr_b16 v[68:69], v19 offset:16384
  v_mfma_f32_16x16x32_bf16 v[196:199], v[76:79], v[40:43], v[196:199]
  ds_read_b64_tr_b16 v[70:71], v19 offset:17408
  v_mfma_f32_16x16x32_bf16 v[200:203], v[80:83], v[40:43], v[200:203]
  v_mfma_f32_16x16x32_bf16 v[204:207], v[84:87], v[40:43], v[204:207]
  ds_read_b128 v[40:43], v6 offset:8192
  v_mfma_f32_16x16x32_bf16 v[208:211], v[72:75], v[44:47], v[208:211]
  v_mfma_f32_16x16x32_bf16 v[212:215], v[76:79], v[44:47], v[212:215]
  v_mfma_f32_16x16x32_bf16 v[216:219], v[80:83], v[44:47], v[216:219]
  v_mfma_f32_16x16x32_bf16 v[220:223], v[84:87], v[44:47], v[220:223]
  ds_read_b128 v[44:47], v6 offset:10240
  v_mfma_f32_16x16x32_bf16 v[224:227], v[72:75], v[48:51], v[224:227]
  v_mfma_f32_16x16x32_bf16 v[228:231], v[76:79], v[48:51], v[228:231]
  v_mfma_f32_16x16x32_bf16 v[232:235], v[80:83], v[48:51], v[232:235]
  v_mfma_f32_16x16x32_bf16 v[236:239], v[84:87], v[48:51], v[236:239]
  ds_read_b128 v[48:51], v6 offset:12288
  v_mfma_f32_16x16x32_bf16 v[240:243], v[72:75], v[52:55], v[240:243]
  v_mfma_f32_16x16x32_bf16 v[244:247], v[76:79], v[52:55], v[244:247]
  v_mfma_f32_16x16x32_bf16 v[248:251], v[80:83], v[52:55], v[248:251]
  v_mfma_f32_16x16x32_bf16 v[252:255], v[84:87], v[52:55], v[252:255]
  ds_read_b128 v[52:55], v6 offset:14336
  s_cmp_lg_u32 s23, s21
  s_cbranch_scc1 K1XS_19
  buffer_load_dword v0, v1, s[16:19], s20 offen
  s_add_u32 s20, s20, s22
  s_add_u32 s21, s21, 8
  s_cmp_ge_u32 s21, 11
  s_cselect_b32 s21, -1, s21
K1XS_19:
  s_add_u32 s23, s23, 1
  s_waitcnt lgkmcnt(12)
  v_mfma_f32_16x16x32_bf16 v[128:131], v[56:59], v[24:27], v[128:131]
  ds_read_b64_tr_b16 v[72:73], v16 offset:24576
  s_waitcnt lgkmcnt(10)
  v_mfma_f32_16x16x32_bf16 v[132:135], v[60:63], v[24:27], v[132:135]
  ds_read_b64_tr_b16 v[74:75], v16 offset:25600
  s_waitcnt lgkmcnt(9)
  v_mfma_f32_16x16x32_bf16 v[136:139], v[64:67], v[24:27], v[136:139]
  ds_read_b64_tr_b16 v[76:77], v17 offset:24576
  s_waitcnt lgkmcnt(7)
  v_mfma_f32_16x16x32_bf16 v[140:143], v[68:71], v[24:27], v[140:143]
  ds_read_b128 v[24:27], v7 offset:0
  v_mfma_f32_16x16x32_bf16 v[144:147], v[56:59], v[28:31], v[144:147]
  ds_read_b64_tr_b16 v[78:79], v17 offset:25600
  v_mfma_f32_16x16x32_bf16 v[148:151], v[60:63], v[28:31], v[148:151]
  ds_read_b64_tr_b16 v[80:81], v18 offset:24576
  v_mfma_f32_16x16x32_bf16 v[152:155], v[64:67], v[28:31], v[152:155]
  ds_read_b64_tr_b16 v[82:83], v18 offset:25600
  v_mfma_f32_16x16x32_bf16 v[156:159], v[68:71], v[28:31], v[156:159]
  ds_read_b128 v[28:31], v7 offset:2048
  v_mfma_f32_16x16x32_bf16 v[160:163], v[56:59], v[32:35], v[160:163]
  ds_read_b64_tr_b16 v[84:85], v19 offset:24576
  v_mfma_f32_16x16x32_bf16 v[164:167], v[60:63], v[32:35], v[164:167]
  ds_read_b64_tr_b16 v[86:87], v19 offset:25600
  v_mfma_f32_16x16x32_bf16 v[168:171], v[64:67], v[32:35], v[168:171]
  v_mfma_f32_16x16x32_bf16 v[172:175], v[68:71], v[32:35], v[172:175]
  ds_read_b128 v[32:35], v7 offset:4096
  v_mfma_f32_16x16x32_bf16 v[176:179], v[56:59], v[36:39], v[176:179]
  v_mfma_f32_16x16x32_bf16 v[180:183], v[60:63], v[36:39], v[180:183]
  v_mfma_f32_16x16x32_bf16 v[184:187], v[64:67], v[36:39], v[184:187]
  v_mfma_f32_16x16x32_bf16 v[188:191], v[68:71], v[36:39], v[188:191]
  ds_read_b128 v[36:39], v7 offset:6144
  s_waitcnt lgkmcnt(15)
  v_mfma_f32_16x16x32_bf16 v[192:195], v[56:59], v[40:43], v[192:195]
  v_mfma_f32_16x16x32_bf16 v[196:199], v[60:63], v[40:43], v[196:199]
  v_mfma_f32_16x16x32_bf16 v[200:203], v[64:67], v[40:43], v[200:203]
  v_mfma_f32_16x16x32_bf16 v[204:207], v[68:71], v[40:43], v[204:207]
  ds_read_b128 v[40:43], v7 offset:8192
  s_waitcnt lgkmcnt(15)
  v_mfma_f32_16x16x32_bf16 v[208:211], v[56:59], v[44:47], v[208:211]
  v_mfma_f32_16x16x32_bf16 v[212:215], v[60:63], v[44:47], v[212:215]
  v_mfma_f32_16x16x32_bf16 v[216:219], v[64:67], v[44:47], v[216:219]
  v_mfma_f32_16x16x32_bf16 v[220:223], v[68:71], v[44:47], v[220:223]
  ds_read_b128 v[44:47], v7 offset:10240
  s_waitcnt lgkmcnt(15)
  v_mfma_f32_16x16x32_bf16 v[224:227], v[56:59], v[48:51], v[224:227]
  v_mfma_f32_16x16x32_bf16 v[228:231], v[60:63], v[48:51], v[228:231]
  v_mfma_f32_16x16x32_bf16 v[232:235], v[64:67], v[48:51], v[232:235]
  v_mfma_f32_16x16x32_bf16 v[236:239], v[68:71], v[48:51], v[236:239]
  ds_read_b128 v[48:51], v7 offset:12288
  s_waitcnt lgkmcnt(15)
  v_mfma_f32_16x16x32_bf16 v[240:243], v[56:59], v[52:55], v[240:243]
  v_mfma_f32_16x16x32_bf16 v[244:247], v[60:63], v[52:55], v[244:247]
  v_mfma_f32_16x16x32_bf16 v[248:251], v[64:67], v[52:55], v[248:251]
  v_mfma_f32_16x16x32_bf16 v[252:255], v[68:71], v[52:55], v[252:255]
  ds_read_b128 v[52:55], v7 offset:14336
  s_waitcnt lgkmcnt(12)
  v_mfma_f32_16x16x32_bf16 v[128:131], v[72:75], v[24:27], v[128:131]
  s_waitcnt lgkmcnt(11)
  v_mfma_f32_16x16x32_bf16 v[132:135], v[76:79], v[24:27], v[132:135]
  s_waitcnt lgkmcnt(9)
  v_mfma_f32_16x16x32_bf16 v[136:139], v[80:83], v[24:27], v[136:139]
  s_waitcnt lgkmcnt(6)
  v_mfma_f32_16x16x32_bf16 v[140:143], v[84:87], v[24:27], v[140:143]
  v_mfma_f32_16x16x32_bf16 v[144:147], v[72:75], v[28:31], v[144:147]
  v_mfma_f32_16x16x32_bf16 v[148:151], v[76:79], v[28:31], v[148:151]
  s_waitcnt lgkmcnt(0)
  s_barrier
  v_mfma_f32_16x16x32_bf16 v[152:155], v[80:83], v[28:31], v[152:155]
  ds_read_b128 v[24:27], v8 offset:0
  v_mfma_f32_16x16x32_bf16 v[156:159], v[84:87], v[28:31], v[156:159]
  ds_read_b128 v[28:31], v8 offset:2048
  v_mfma_f32_16x16x32_bf16 v[160:163], v[72:75], v[32:35], v[160:163]
  ds_read_b64_tr_b16 v[56:57], v16 offset:32768
  v_mfma_f32_16x16x32_bf16 v[164:167], v[76:79], v[32:35], v[164:167]
  ds_read_b64_tr_b16 v[58:59], v16 offset:33792
  v_mfma_f32_16x16x32_bf16 v[168:171], v[80:83], v[32:35], v[168:171]
  ds_read_b64_tr_b16 v[60:61], v17 offset:32768
  v_mfma_f32_16x16x32_bf16 v[172:175], v[84:87], v[32:35], v[172:175]
  ds_read_b128 v[32:35], v8 offset:4096
  v_mfma_f32_16x16x32_bf16 v[176:179], v[72:75], v[36:39], v[176:179]
  ds_read_b64_tr_b16 v[62:63], v17 offset:33792
  v_mfma_f32_16x16x32_bf16 v[180:183], v[76:79], v[36:39], v[180:183]
  ds_read_b64_tr_b16 v[64:65], v18 offset:32768
  v_mfma_f32_16x16x32_bf16 v[184:187], v[80:83], v[36:39], v[184:187]
  ds_read_b64_tr_b16 v[66:67], v18 offset:33792
  v_mfma_f32_16x16x32_bf16 v[188:191], v[84:87], v[36:39], v[188:191]
  ds_read_b128 v[36:39], v8 offset:6144
  v_mfma_f32_16x16x32_bf16 v[192:195], v[72:75], v[40:43], v[192:195]
  ds_read_b64_tr_b16 v[68:69], v19 offset:32768
  v_mfma_f32_16x16x32_bf16 v[196:199], v[76:79], v[40:43], v[196:199]
  ds_read_b64_tr_b16 v[70:71], v19 offset:33792
  v_mfma_f32_16x16x32_bf16 v[200:203], v[80:83], v[40:43], v[200:203]
  v_mfma_f32_16x16x32_bf16 v[204:207], v[84:87], v[40:43], v[204:207]
  ds_read_b128 v[40:43], v8 offset:8192
  v_mfma_f32_16x16x32_bf16 v[208:211], v[72:75], v[44:47], v[208:211]
  v_mfma_f32_16x16x32_bf16 v[212:215], v[76:79], v[44:47], v[212:215]
  v_mfma_f32_16x16x32_bf16 v[216:219], v[80:83], v[44:47], v[216:219]
  v_mfma_f32_16x16x32_bf16 v[220:223], v[84:87], v[44:47], v[220:223]
  ds_read_b128 v[44:47], v8 offset:10240
  v_mfma_f32_16x16x32_bf16 v[224:227], v[72:75], v[48:51], v[224:227]
  v_mfma_f32_16x16x32_bf16 v[228:231], v[76:79], v[48:51], v[228:231]
  v_mfma_f32_16x16x32_bf16 v[232:235], v[80:83], v[48:51], v[232:235]
  v_mfma_f32_16x16x32_bf16 v[236:239], v[84:87], v[48:51], v[236:239]
  ds_read_b128 v[48:51], v8 offset:12288
  v_mfma_f32_16x16x32_bf16 v[240:243], v[72:75], v[52:55], v[240:243]
  v_mfma_f32_16x16x32_bf16 v[244:247], v[76:79], v[52:55], v[244:247]
  v_mfma_f32_16x16x32_bf16 v[248:251], v[80:83], v[52:55], v[248:251]
  v_mfma_f32_16x16x32_bf16 v[252:255], v[84:87], v[52:55], v[252:255]
  ds_read_b128 v[52:55], v8 offset:14336
  s_cmp_lg_u32 s23, s21
  s_cbranch_scc1 K1XS_20
  buffer_load_dword v0, v1, s[16:19], s20 offen
  s_add_u32 s20, s20, s22
  s_add_u32 s21, s21, 8
  s_cmp_ge_u32 s21, 11
  s_cselect_b32 s21, -1, s21
K1XS_20:
  s_add_u32 s23, s23, 1
  s_waitcnt lgkmcnt(12)
  v_mfma_f32_16x16x32_bf16 v[128:131], v[56:59], v[24:27], v[128:131]
  ds_read_b64_tr_b16 v[72:73], v16 offset:40960
  s_waitcnt lgkmcnt(10)
  v_mfma_f32_16x16x32_bf16 v[132:135], v[60:63], v[24:27], v[132:135]
  ds_read_b64_tr_b16 v[74:75], v16 offset:41984
  s_waitcnt lgkmcnt(9)
  v_mfma_f32_16x16x32_bf16 v[136:139], v[64:67], v[24:27], v[136:139]
  ds_read_b64_tr_b16 v[76:77], v17 offset:40960
  s_waitcnt lgkmcnt(7)
  v_mfma_f32_16x16x32_bf16 v[140:143], v[68:71], v[24:27], v[140:143]
  ds_read_b128 v[24:27], v9 offset:0
  v_mfma_f32_16x16x32_bf16 v[144:147], v[56:59], v[28:31], v[144:147]
  ds_read_b64_tr_b16 v[78:79], v17 offset:41984
  v_mfma_f32_16x16x32_bf16 v[148:151], v[60:63], v[28:31], v[148:151]
  ds_read_b64_tr_b16 v[80:81], v18 offset:40960
  v_mfma_f32_16x16x32_bf16 v[152:155], v[64:67], v[28:31], v[152:155]
  ds_read_b64_tr_b16 v[82:83], v18 offset:41984
  v_mfma_f32_16x16x32_bf16 v[156:159], v[68:71], v[28:31], v[156:159]
  ds_read_b128 v[28:31], v9 offset:2048
  v_mfma_f32_16x16x32_bf16 v[160:163], v[56:59], v[32:35], v[160:163]
  ds_read_b64_tr_b16 v[84:85], v19 offset:40960
  v_mfma_f32_16x16x32_bf16 v[164:167], v[60:63], v[32:35], v[164:167]
  ds_read_b64_tr_b16 v[86:87], v19 offset:41984
  v_mfma_f32_16x16x32_bf16 v[168:171], v[64:67], v[32:35], v[168:171]
  v_mfma_f32_16x16x32_bf16 v[172:175], v[68:71], v[32:35], v[172:175]
  ds_read_b128 v[32:35], v9 offset:4096
  v_mfma_f32_16x16x32_bf16 v[176:179], v[56:59], v[36:39], v[176:179]
  v_mfma_f32_16x16x32_bf16 v[180:183], v[60:63], v[36:39], v[180:183]
  v_mfma_f32_16x16x32_bf16 v[184:187], v[64:67], v[36:39], v[184:187]
  v_mfma_f32_16x16x32_bf16 v[188:191], v[68:71], v[36:39], v[188:191]
  ds_read_b128 v[36:39], v9 offset:6144
  s_waitcnt lgkmcnt(15)
  v_mfma_f32_16x16x32_bf16 v[192:195], v[56:59], v[40:43], v[192:195]
  v_mfma_f32_16x16x32_bf16 v[196:199], v[60:63], v[40:43], v[196:199]
  v_mfma_f32_16x16x32_bf16 v[200:203], v[64:67], v[40:43], v[200:203]
  v_mfma_f32_16x16x32_bf16 v[204:207], v[68:71], v[40:43], v[204:207]
  ds_read_b128 v[40:43], v9 offset:8192
  s_waitcnt lgkmcnt(15)
  v_mfma_f32_16x16x32_bf16 v[208:211], v[56:59], v[44:47], v[208:211]
  v_mfma_f32_16x16x32_bf16 v[212:215], v[60:63], v[44:47], v[212:215]
  v_mfma_f32_16x16x32_bf16 v[216:219], v[64:67], v[44:47], v[216:219]
  v_mfma_f32_16x16x32_bf16 v[220:223], v[68:71], v[44:47], v[220:223]
  ds_read_b128 v[44:47], v9 offset:10240
  s_waitcnt lgkmcnt(15)
  v_mfma_f32_16x16x32_bf16 v[224:227], v[56:59], v[48:51], v[224:227]
  v_mfma_f32_16x16x32_bf16 v[228:231], v[60:63], v[48:51], v[228:231]
  v_mfma_f32_16x16x32_bf16 v[232:235], v[64:67], v[48:51], v[232:235]
  v_mfma_f32_16x16x32_bf16 v[236:239], v[68:71], v[48:51], v[236:239]
  ds_read_b128 v[48:51], v9 offset:12288
  s_waitcnt lgkmcnt(15)
  v_mfma_f32_16x16x32_bf16 v[240:243], v[56:59], v[52:55], v[240:243]
  v_mfma_f32_16x16x32_bf16 v[244:247], v[60:63], v[52:55], v[244:247]
  v_mfma_f32_16x16x32_bf16 v[248:251], v[64:67], v[52:55], v[248:251]
  v_mfma_f32_16x16x32_bf16 v[252:255], v[68:71], v[52:55], v[252:255]
  ds_read_b128 v[52:55], v9 offset:14336
  s_waitcnt lgkmcnt(12)
  v_mfma_f32_16x16x32_bf16 v[128:131], v[72:75], v[24:27], v[128:131]
  s_waitcnt lgkmcnt(11)
  v_mfma_f32_16x16x32_bf16 v[132:135], v[76:79], v[24:27], v[132:135]
  s_waitcnt lgkmcnt(9)
  v_mfma_f32_16x16x32_bf16 v[136:139], v[80:83], v[24:27], v[136:139]
  s_waitcnt lgkmcnt(6)
  v_mfma_f32_16x16x32_bf16 v[140:143], v[84:87], v[24:27], v[140:143]
  v_mfma_f32_16x16x32_bf16 v[144:147], v[72:75], v[28:31], v[144:147]
  v_mfma_f32_16x16x32_bf16 v[148:151], v[76:79], v[28:31], v[148:151]
  s_waitcnt lgkmcnt(0)
  s_barrier
  v_mfma_f32_16x16x32_bf16 v[152:155], v[80:83], v[28:31], v[152:155]
  ds_read_b128 v[24:27], v4 offset:0
  v_mfma_f32_16x16x32_bf16 v[156:159], v[84:87], v[28:31], v[156:159]
  ds_read_b128 v[28:31], v4 offset:2048
  v_mfma_f32_16x16x32_bf16 v[160:163], v[72:75], v[32:35], v[160:163]
  ds_read_b64_tr_b16 v[56:57], v16 offset:0
  v_mfma_f32_16x16x32_bf16 v[164:167], v[76:79], v[32:35], v[164:167]
  ds_read_b64_tr_b16 v[58:59], v16 offset:1024
  v_mfma_f32_16x16x32_bf16 v[168:171], v[80:83], v[32:35], v[168:171]
  ds_read_b64_tr_b16 v[60:61], v17 offset:0
  v_mfma_f32_16x16x32_bf16 v[172:175], v[84:87], v[32:35], v[172:175]
  ds_read_b128 v[32:35], v4 offset:4096
  v_mfma_f32_16x16x32_bf16 v[176:179], v[72:75], v[36:39], v[176:179]
  ds_read_b64_tr_b16 v[62:63], v17 offset:1024
  v_mfma_f32_16x16x32_bf16 v[180:183], v[76:79], v[36:39], v[180:183]
  ds_read_b64_tr_b16 v[64:65], v18 offset:0
  v_mfma_f32_16x16x32_bf16 v[184:187], v[80:83], v[36:39], v[184:187]
  ds_read_b64_tr_b16 v[66:67], v18 offset:1024
  v_mfma_f32_16x16x32_bf16 v[188:191], v[84:87], v[36:39], v[188:191]
  ds_read_b128 v[36:39], v4 offset:6144
  v_mfma_f32_16x16x32_bf16 v[192:195], v[72:75], v[40:43], v[192:195]
  ds_read_b64_tr_b16 v[68:69], v19 offset:0
  v_mfma_f32_16x16x32_bf16 v[196:199], v[76:79], v[40:43], v[196:199]
  ds_read_b64_tr_b16 v[70:71], v19 offset:1024
  v_mfma_f32_16x16x32_bf16 v[200:203], v[80:83], v[40:43], v[200:203]
  v_mfma_f32_16x16x32_bf16 v[204:207], v[84:87], v[40:43], v[204:207]
  ds_read_b128 v[40:43], v4 offset:8192
  v_mfma_f32_16x16x32_bf16 v[208:211], v[72:75], v[44:47], v[208:211]
  v_mfma_f32_16x16x32_bf16 v[212:215], v[76:79], v[44:47], v[212:215]
  v_mfma_f32_16x16x32_bf16 v[216:219], v[80:83], v[44:47], v[216:219]
  v_mfma_f32_16x16x32_bf16 v[220:223], v[84:87], v[44:47], v[220:223]
  ds_read_b128 v[44:47], v4 offset:10240
  v_mfma_f32_16x16x32_bf16 v[224:227], v[72:75], v[48:51], v[224:227]
  v_mfma_f32_16x16x32_bf16 v[228:231], v[76:79], v[48:51], v[228:231]
  v_mfma_f32_16x16x32_bf16 v[232:235], v[80:83], v[48:51], v[232:235]
  v_mfma_f32_16x16x32_bf16 v[236:239], v[84:87], v[48:51], v[236:239]
  ds_read_b128 v[48:51], v4 offset:12288
  v_mfma_f32_16x16x32_bf16 v[240:243], v[72:75], v[52:55], v[240:243]
  v_mfma_f32_16x16x32_bf16 v[244:247], v[76:79], v[52:55], v[244:247]
  v_mfma_f32_16x16x32_bf16 v[248:251], v[80:83], v[52:55], v[248:251]
  v_mfma_f32_16x16x32_bf16 v[252:255], v[84:87], v[52:55], v[252:255]
  ds_read_b128 v[52:55], v4 offset:14336
  s_sub_u32 s11, s11, 1
  s_cmp_lg_u32 s11, 0
  s_cbranch_scc1 K1C_17
  s_waitcnt lgkmcnt(12)
  v_mfma_f32_16x16x32_bf16 v[128:131], v[56:59], v[24:27], v[128:131]
  ds_read_b64_tr_b16 v[72:73], v16 offset:8192
  s_waitcnt lgkmcnt(10)
  v_mfma_f32_16x16x32_bf16 v[132:135], v[60:63], v[24:27], v[132:135]
  ds_read_b64_tr_b16 v[74:75], v16 offset:9216
  s_waitcnt lgkmcnt(9)
  v_mfma_f32_16x16x32_bf16 v[136:139], v[64:67], v[24:27], v[136:139]
  ds_read_b64_tr_b16 v[76:77], v17 offset:8192
  s_waitcnt lgkmcnt(7)
  v_mfma_f32_16x16x32_bf16 v[140:143], v[68:71], v[24:27], v[140:143]
  ds_read_b128 v[24:27], v5 offset:0
  v_mfma_f32_16x16x32_bf16 v[144:147], v[56:59], v[28:31], v[144:147]
  ds_read_b64_tr_b16 v[78:79], v17 offset:9216
  v_mfma_f32_16x16x32_bf16 v[148:151], v[60:63], v[28:31], v[148:151]
  ds_read_b64_tr_b16 v[80:81], v18 offset:8192
  v_mfma_f32_16x16x32_bf16 v[152:155], v[64:67], v[28:31], v[152:155]
  ds_read_b64_tr_b16 v[82:83], v18 offset:9216
  v_mfma_f32_16x16x32_bf16 v[156:159], v[68:71], v[28:31], v[156:159]
  ds_read_b128 v[28:31], v5 offset:2048
  v_mfma_f32_16x16x32_bf16 v[160:163], v[56:59], v[32:35], v[160:163]
  ds_read_b64_tr_b16 v[84:85], v19 offset:8192
  v_mfma_f32_16x16x32_bf16 v[164:167], v[60:63], v[32:35], v[164:167]
  ds_read_b64_tr_b16 v[86:87], v19 offset:9216
  v_mfma_f32_16x16x32_bf16 v[168:171], v[64:67], v[32:35], v[168:171]
  v_mfma_f32_16x16x32_bf16 v[172:175], v[68:71], v[32:35], v[172:175]
  ds_read_b128 v[32:35], v5 offset:4096
  v_mfma_f32_16x16x32_bf16 v[176:179], v[56:59], v[36:39], v[176:179]
  v_mfma_f32_16x16x32_bf16 v[180:183], v[60:63], v[36:39], v[180:183]
  v_mfma_f32_16x16x32_bf16 v[184:187], v[64:67], v[36:39], v[184:187]
  v_mfma_f32_16x16x32_bf16 v[188:191], v[68:71], v[36:39], v[188:191]
  ds_read_b128 v[36:39], v5 offset:6144
  s_waitcnt lgkmcnt(15)
  v_mfma_f32_16x16x32_bf16 v[192:195], v[56:59], v[40:43], v[192:195]
  v_mfma_f32_16x16x32_bf16 v[196:199], v[60:63], v[40:43], v[196:199]
  v_mfma_f32_16x16x32_bf16 v[200:203], v[64:67], v[40:43], v[200:203]
  v_mfma_f32_16x16x32_bf16 v[204:207], v[68:71], v[40:43], v[204:207]
  ds_read_b128 v[40:43], v5 offset:8192
  s_waitcnt lgkmcnt(15)
  v_mfma_f32_16x16x32_bf16 v[208:211], v[56:59], v[44:47], v[208:211]
  v_mfma_f32_16x16x32_bf16 v[212:215], v[60:63], v[44:47], v[212:215]
  v_mfma_f32_16x16x32_bf16 v[216:219], v[64:67], v[44:47], v[216:219]
  v_mfma_f32_16x16x32_bf16 v[220:223], v[68:71], v[44:47], v[220:223]
  ds_read_b128 v[44:47], v5 offset:10240
  s_waitcnt lgkmcnt(15)
  v_mfma_f32_16x16x32_bf16 v[224:227], v[56:59], v[48:51], v[224:227]
  v_mfma_f32_16x16x32_bf16 v[228:231], v[60:63], v[48:51], v[228:231]
  v_mfma_f32_16x16x32_bf16 v[232:235], v[64:67], v[48:51], v[232:235]
  v_mfma_f32_16x16x32_bf16 v[236:239], v[68:71], v[48:51], v[236:239]
  ds_read_b128 v[48:51], v5 offset:12288
  s_waitcnt lgkmcnt(15)
  v_mfma_f32_16x16x32_bf16 v[240:243], v[56:59], v[52:55], v[240:243]
  v_mfma_f32_16x16x32_bf16 v[244:247], v[60:63], v[52:55], v[244:247]
  v_mfma_f32_16x16x32_bf16 v[248:251], v[64:67], v[52:55], v[248:251]
  v_mfma_f32_16x16x32_bf16 v[252:255], v[68:71], v[52:55], v[252:255]
  ds_read_b128 v[52:55], v5 offset:14336
  s_waitcnt lgkmcnt(12)
  v_mfma_f32_16x16x32_bf16 v[128:131], v[72:75], v[24:27], v[128:131]
  s_waitcnt lgkmcnt(11)
  v_mfma_f32_16x16x32_bf16 v[132:135], v[76:79], v[24:27], v[132:135]
  s_waitcnt lgkmcnt(9)
  v_mfma_f32_16x16x32_bf16 v[136:139], v[80:83], v[24:27], v[136:139]
  s_waitcnt lgkmcnt(6)
  v_mfma_f32_16x16x32_bf16 v[140:143], v[84:87], v[24:27], v[140:143]
  v_mfma_f32_16x16x32_bf16 v[144:147], v[72:75], v[28:31], v[144:147]
  v_mfma_f32_16x16x32_bf16 v[148:151], v[76:79], v[28:31], v[148:151]
  s_waitcnt lgkmcnt(0)
  s_barrier
  v_mfma_f32_16x16x32_bf16 v[152:155], v[80:83], v[28:31], v[152:155]
  v_mfma_f32_16x16x32_bf16 v[156:159], v[84:87], v[28:31], v[156:159]
  v_mfma_f32_16x16x32_bf16 v[160:163], v[72:75], v[32:35], v[160:163]
  v_mfma_f32_16x16x32_bf16 v[164:167], v[76:79], v[32:35], v[164:167]
  v_mfma_f32_16x16x32_bf16 v[168:171], v[80:83], v[32:35], v[168:171]
  v_mfma_f32_16x16x32_bf16 v[172:175], v[84:87], v[32:35], v[172:175]
  v_mfma_f32_16x16x32_bf16 v[176:179], v[72:75], v[36:39], v[176:179]
  v_mfma_f32_16x16x32_bf16 v[180:183], v[76:79], v[36:39], v[180:183]
  v_mfma_f32_16x16x32_bf16 v[184:187], v[80:83], v[36:39], v[184:187]
  v_mfma_f32_16x16x32_bf16 v[188:191], v[84:87], v[36:39], v[188:191]
  v_mfma_f32_16x16x32_bf16 v[192:195], v[72:75], v[40:43], v[192:195]
  v_mfma_f32_16x16x32_bf16 v[196:199], v[76:79], v[40:43], v[196:199]
  v_mfma_f32_16x16x32_bf16 v[200:203], v[80:83], v[40:43], v[200:203]
  v_mfma_f32_16x16x32_bf16 v[204:207], v[84:87], v[40:43], v[204:207]
  v_mfma_f32_16x16x32_bf16 v[208:211], v[72:75], v[44:47], v[208:211]
  v_mfma_f32_16x16x32_bf16 v[212:215], v[76:79], v[44:47], v[212:215]
  v_mfma_f32_16x16x32_bf16 v[216:219], v[80:83], v[44:47], v[216:219]
  v_mfma_f32_16x16x32_bf16 v[220:223], v[84:87], v[44:47], v[220:223]
  v_mfma_f32_16x16x32_bf16 v[224:227], v[72:75], v[48:51], v[224:227]
  v_mfma_f32_16x16x32_bf16 v[228:231], v[76:79], v[48:51], v[228:231]
  v_mfma_f32_16x16x32_bf16 v[232:235], v[80:83], v[48:51], v[232:235]
  v_mfma_f32_16x16x32_bf16 v[236:239], v[84:87], v[48:51], v[236:239]
  v_mfma_f32_16x16x32_bf16 v[240:243], v[72:75], v[52:55], v[240:243]
  v_mfma_f32_16x16x32_bf16 v[244:247], v[76:79], v[52:55], v[244:247]
  v_mfma_f32_16x16x32_bf16 v[248:251], v[80:83], v[52:55], v[248:251]
  v_mfma_f32_16x16x32_bf16 v[252:255], v[84:87], v[52:55], v[252:255]
  s_cmp_lt_u32 s7, 24
  s_cbranch_scc1 K1_phi
K1W_q_0:
  v_and_b32 v5, 15, v2
  v_lshrrev_b32 v6, 5, v2
  v_lshl_add_u32 v5, v6, 5, v5
  v_lshlrev_b32 v4, 4, v5
  v_bfe_u32 v6, v2, 4, 1
  v_lshl_add_u32 v4, v6, 10, v4
  s_and_b32 s9, s7, 7
  s_lshl_b32 s9, s9, 2
  s_lshl_b32 s10, s13, 1
  s_add_u32 s9, s9, s10
  s_lshl_b32 s9, s9, 6
  s_lshl_b32 s10, s6, 3
  s_add_u32 s9, s9, s10
  s_lshl_b32 s10, s12, 2
  s_add_u32 s9, s9, s10
  s_lshl_b32 s9, s9, 11
  s_add_u32 s9, s9, s8
  v_cvt_pk_bf16_f32 v24, v128, v129
  v_cvt_pk_bf16_f32 v25, v130, v131
  v_cvt_pk_bf16_f32 v26, v132, v133
  v_cvt_pk_bf16_f32 v27, v134, v135
  s_add_u32 s10, s9, 0
  buffer_store_dwordx4 v[24:27], v4, s[48:51], s10 offen offset:0 sc0 sc1
  v_cvt_pk_bf16_f32 v28, v144, v145
  v_cvt_pk_bf16_f32 v29, v146, v147
  v_cvt_pk_bf16_f32 v30, v148, v149
  v_cvt_pk_bf16_f32 v31, v150, v151
  buffer_store_dwordx4 v[28:31], v4, s[48:51], s10 offen offset:256 sc0 sc1
  v_cvt_pk_bf16_f32 v32, v160, v161
  v_cvt_pk_bf16_f32 v33, v162, v163
  v_cvt_pk_bf16_f32 v34, v164, v165
  v_cvt_pk_bf16_f32 v35, v166, v167
  buffer_store_dwordx4 v[32:35], v4, s[48:51], s10 offen offset:2048 sc0 sc1
  v_cvt_pk_bf16_f32 v36, v176, v177
  v_cvt_pk_bf16_f32 v37, v178, v179
  v_cvt_pk_bf16_f32 v38, v180, v181
  v_cvt_pk_bf16_f32 v39, v182, v183
  buffer_store_dwordx4 v[36:39], v4, s[48:51], s10 offen offset:2304 sc0 sc1
  v_cvt_pk_bf16_f32 v40, v192, v193
  v_cvt_pk_bf16_f32 v41, v194, v195
  v_cvt_pk_bf16_f32 v42, v196, v197
  v_cvt_pk_bf16_f32 v43, v198, v199
  s_add_u32 s10, s9, 4096
  buffer_store_dwordx4 v[40:43], v4, s[48:51], s10 offen offset:0 sc0 sc1
  v_cvt_pk_bf16_f32 v44, v208, v209
  v_cvt_pk_bf16_f32 v45, v210, v211
  v_cvt_pk_bf16_f32 v46, v212, v213
  v_cvt_pk_bf16_f32 v47, v214, v215
  buffer_store_dwordx4 v[44:47], v4, s[48:51], s10 offen offset:256 sc0 sc1
  v_cvt_pk_bf16_f32 v48, v224, v225
  s_cbranch_execz K1W_q_ret
K1W_q_1:
  v_cvt_pk_bf16_f32 v49, v226, v227
  v_cvt_pk_bf16_f32 v50, v228, v229
  v_cvt_pk_bf16_f32 v51, v230, v231
  buffer_store_dwordx4 v[48:51], v4, s[48:51], s10 offen offset:2048 sc0 sc1
  v_cvt_pk_bf16_f32 v52, v240, v241
  v_cvt_pk_bf16_f32 v53, v242, v243
  v_cvt_pk_bf16_f32 v54, v244, v245
  v_cvt_pk_bf16_f32 v55, v246, v247
  buffer_store_dwordx4 v[52:55], v4, s[48:51], s10 offen offset:2304 sc0 sc1
  v_cvt_pk_bf16_f32 v24, v136, v137
  v_cvt_pk_bf16_f32 v25, v138, v139
  v_cvt_pk_bf16_f32 v26, v140, v141
  v_cvt_pk_bf16_f32 v27, v142, v143
  s_add_u32 s10, s9, 131072
  buffer_store_dwordx4 v[24:27], v4, s[48:51], s10 offen offset:0 sc0 sc1
  v_cvt_pk_bf16_f32 v28, v152, v153
  v_cvt_pk_bf16_f32 v29, v154, v155
  v_cvt_pk_bf16_f32 v30, v156, v157
  v_cvt_pk_bf16_f32 v31, v158, v159
  buffer_store_dwordx4 v[28:31], v4, s[48:51], s10 offen offset:256 sc0 sc1
  v_cvt_pk_bf16_f32 v32, v168, v169
  v_cvt_pk_bf16_f32 v33, v170, v171
  v_cvt_pk_bf16_f32 v34, v172, v173
  v_cvt_pk_bf16_f32 v35, v174, v175
  buffer_store_dwordx4 v[32:35], v4, s[48:51], s10 offen offset:2048 sc0 sc1
  v_cvt_pk_bf16_f32 v36, v184, v185
  v_cvt_pk_bf16_f32 v37, v186, v187
  v_cvt_pk_bf16_f32 v38, v188, v189
  v_cvt_pk_bf16_f32 v39, v190, v191
  buffer_store_dwordx4 v[36:39], v4, s[48:51], s10 offen offset:2304 sc0 sc1
  v_cvt_pk_bf16_f32 v40, v200, v201
  v_cvt_pk_bf16_f32 v41, v202, v203
  v_cvt_pk_bf16_f32 v42, v204, v205
  v_cvt_pk_bf16_f32 v43, v206, v207
  s_add_u32 s10, s9, 135168
  buffer_store_dwordx4 v[40:43], v4, s[48:51], s10 offen offset:0 sc0 sc1
  v_cvt_pk_bf16_f32 v44, v216, v217
  v_cvt_pk_bf16_f32 v45, v218, v219
  v_cvt_pk_bf16_f32 v46, v220, v221
  v_cvt_pk_bf16_f32 v47, v222, v223
  buffer_store_dwordx4 v[44:47], v4, s[48:51], s10 offen offset:256 sc0 sc1
  v_cvt_pk_bf16_f32 v48, v232, v233
  v_cvt_pk_bf16_f32 v49, v234, v235
  v_cvt_pk_bf16_f32 v50, v236, v237
  v_cvt_pk_bf16_f32 v51, v238, v239
  buffer_store_dwordx4 v[48:51], v4, s[48:51], s10 offen offset:2048 sc0 sc1
  v_cvt_pk_bf16_f32 v52, v248, v249
  v_cvt_pk_bf16_f32 v53, v250, v251
  v_cvt_pk_bf16_f32 v54, v252, v253
  v_cvt_pk_bf16_f32 v55, v254, v255
  buffer_store_dwordx4 v[52:55], v4, s[48:51], s10 offen offset:2304 sc0 sc1
  s_cbranch_execz K1W_q_ret
  s_endpgm
K1_phi:
  s_nop 15
K1W_phi_0:
  s_mov_b32 s64, 1069066811
  s_mov_b32 s65, 1069066811
  v_lshrrev_b32 v117, 5, v2
  v_bfe_u32 v118, v2, 2, 2
  v_lshl_add_u32 v119, v117, 3, v118
  v_bfe_u32 v120, v2, 4, 1
  v_and_b32 v121, 3, v2
  v_lshl_add_u32 v121, v120, 2, v121
  v_lshlrev_b32 v116, 3, v121
  v_lshl_add_u32 v116, v119, 6, v116
  s_lshl_b32 s9, s13, 12
  s_add_u32 s9, s9, 147456
  v_add_u32 v116, s9, v116
  ds_read_b64_tr_b16 v[100:101], v116 offset:0
  ds_read_b64_tr_b16 v[102:103], v116 offset:1024
  ds_read_b64_tr_b16 v[104:105], v116 offset:256
  ds_read_b64_tr_b16 v[106:107], v116 offset:1280
  ds_read_b64_tr_b16 v[108:109], v116 offset:2048
  ds_read_b64_tr_b16 v[110:111], v116 offset:3072
  ds_read_b64_tr_b16 v[112:113], v116 offset:2304
  ds_read_b64_tr_b16 v[114:115], v116 offset:3328
  v_lshlrev_b32 v3, 4, v2
  s_and_b32 s9, s7, 7
  s_lshl_b32 s9, s9, 2
  s_lshl_b32 s10, s13, 1
  s_add_u32 s9, s9, s10
  s_lshl_b32 s9, s9, 6
  s_lshl_b32 s10, s6, 3
  s_add_u32 s9, s9, s10
  s_lshl_b32 s10, s12, 2
  s_add_u32 s9, s9, s10
  s_lshl_b32 s9, s9, 12
  s_add_u32 s9, s9, 33554432
  s_add_u32 s10, s9, 0x40000
  v_cvt_pk_bf16_f32 v52, v128, v129
  v_cvt_pk_bf16_f32 v53, v130, v131
  v_cvt_pk_bf16_f32 v54, v132, v133
  v_cvt_pk_bf16_f32 v55, v134, v135
  v_cvt_pk_bf16_f32 v56, v144, v145
  v_cvt_pk_bf16_f32 v57, v146, v147
  v_cvt_pk_bf16_f32 v58, v148, v149
  v_cvt_pk_bf16_f32 v59, v150, v151
  v_cvt_pk_bf16_f32 v60, v136, v137
  v_cvt_pk_bf16_f32 v61, v138, v139
  v_cvt_pk_bf16_f32 v62, v140, v141
  v_cvt_pk_bf16_f32 v63, v142, v143
  v_cvt_pk_bf16_f32 v64, v152, v153
  v_cvt_pk_bf16_f32 v65, v154, v155
  v_cvt_pk_bf16_f32 v66, v156, v157
  v_cvt_pk_bf16_f32 v67, v158, v159
  v_permlane16_swap_b32 v52, v56
  v_permlane16_swap_b32 v53, v57
  v_permlane16_swap_b32 v54, v58
  v_permlane16_swap_b32 v55, v59
  v_permlane16_swap_b32 v60, v64
  v_permlane16_swap_b32 v61, v65
  v_permlane16_swap_b32 v62, v66
  v_permlane16_swap_b32 v63, v67
  s_waitcnt lgkmcnt(6)
  v_mfma_f32_32x32x16_bf16 v[128:143], v[100:103], v[52:55], 0
  s_waitcnt lgkmcnt(2)
  v_mfma_f32_32x32x16_bf16 v[144:159], v[108:111], v[60:63], 0
  v_mfma_f32_32x32x16_bf16 v[128:143], v[104:107], v[56:59], v[128:143]
  s_waitcnt lgkmcnt(0)
  v_mfma_f32_32x32x16_bf16 v[144:159], v[112:115], v[64:67], v[144:159]
  v_cvt_pk_bf16_f32 v68, v160, v161
  v_cvt_pk_bf16_f32 v69, v162, v163
  v_cvt_pk_bf16_f32 v70, v164, v165
  v_cvt_pk_bf16_f32 v71, v166, v167
  v_cvt_pk_bf16_f32 v72, v176, v177
  v_cvt_pk_bf16_f32 v73, v178, v179
  v_cvt_pk_bf16_f32 v74, v180, v181
  v_cvt_pk_bf16_f32 v75, v182, v183
  v_cvt_pk_bf16_f32 v76, v168, v169
  v_cvt_pk_bf16_f32 v77, v170, v171
  v_cvt_pk_bf16_f32 v78, v172, v173
  v_cvt_pk_bf16_f32 v79, v174, v175
  v_cvt_pk_bf16_f32 v80, v184, v185
  v_cvt_pk_bf16_f32 v81, v186, v187
  v_cvt_pk_bf16_f32 v82, v188, v189
  v_cvt_pk_bf16_f32 v83, v190, v191
  v_permlane16_swap_b32 v68, v72
  v_permlane16_swap_b32 v69, v73
  v_permlane16_swap_b32 v70, v74
  v_permlane16_swap_b32 v71, v75
  v_permlane16_swap_b32 v76, v80
  v_permlane16_swap_b32 v77, v81
  v_permlane16_swap_b32 v78, v82
  v_permlane16_swap_b32 v79, v83
  v_mfma_f32_32x32x16_bf16 v[160:175], v[100:103], v[68:71], 0
  s_nop 0
  v_mfma_f32_32x32x16_bf16 v[176:191], v[108:111], v[76:79], 0
  v_mfma_f32_32x32x16_bf16 v[160:175], v[104:107], v[72:75], v[160:175]
  v_mfma_f32_32x32x16_bf16 v[176:191], v[112:115], v[80:83], v[176:191]
  v_cvt_pk_bf16_f32 v52, v192, v193
  v_cvt_pk_bf16_f32 v53, v194, v195
  v_cvt_pk_bf16_f32 v54, v196, v197
  v_cvt_pk_bf16_f32 v55, v198, v199
  v_cvt_pk_bf16_f32 v56, v208, v209
  v_cvt_pk_bf16_f32 v57, v210, v211
  v_cvt_pk_bf16_f32 v58, v212, v213
  v_cvt_pk_bf16_f32 v59, v214, v215
  v_cvt_pk_bf16_f32 v60, v200, v201
  v_cvt_pk_bf16_f32 v61, v202, v203
  v_cvt_pk_bf16_f32 v62, v204, v205
  v_cvt_pk_bf16_f32 v63, v206, v207
  v_cvt_pk_bf16_f32 v64, v216, v217
  v_cvt_pk_bf16_f32 v65, v218, v219
  v_cvt_pk_bf16_f32 v66, v220, v221
  v_cvt_pk_bf16_f32 v67, v222, v223
  v_permlane16_swap_b32 v52, v56
  v_permlane16_swap_b32 v53, v57
  v_permlane16_swap_b32 v54, v58
  v_permlane16_swap_b32 v55, v59
  v_permlane16_swap_b32 v60, v64
  v_permlane16_swap_b32 v61, v65
  v_permlane16_swap_b32 v62, v66
  v_permlane16_swap_b32 v63, v67
  v_mfma_f32_32x32x16_bf16 v[192:207], v[100:103], v[52:55], 0
  s_nop 0
  v_mfma_f32_32x32x16_bf16 v[208:223], v[108:111], v[60:63], 0
  v_mfma_f32_32x32x16_bf16 v[192:207], v[104:107], v[56:59], v[192:207]
  v_mfma_f32_32x32x16_bf16 v[208:223], v[112:115], v[64:67], v[208:223]
  v_cvt_pk_bf16_f32 v68, v224, v225
  v_cvt_pk_bf16_f32 v69, v226, v227
  v_cvt_pk_bf16_f32 v70, v228, v229
  v_cvt_pk_bf16_f32 v71, v230, v231
  v_cvt_pk_bf16_f32 v72, v240, v241
  v_cvt_pk_bf16_f32 v73, v242, v243
  v_cvt_pk_bf16_f32 v74, v244, v245
  v_cvt_pk_bf16_f32 v75, v246, v247
  v_cvt_pk_bf16_f32 v76, v232, v233
  v_cvt_pk_bf16_f32 v77, v234, v235
  v_cvt_pk_bf16_f32 v78, v236, v237
  v_cvt_pk_bf16_f32 v79, v238, v239
  v_cvt_pk_bf16_f32 v80, v248, v249
  v_cvt_pk_bf16_f32 v81, v250, v251
  v_cvt_pk_bf16_f32 v82, v252, v253
  v_cvt_pk_bf16_f32 v83, v254, v255
  v_permlane16_swap_b32 v68, v72
  v_permlane16_swap_b32 v69, v73
  v_permlane16_swap_b32 v70, v74
  v_permlane16_swap_b32 v71, v75
  v_permlane16_swap_b32 v76, v80
  v_permlane16_swap_b32 v77, v81
  v_permlane16_swap_b32 v78, v82
  v_permlane16_swap_b32 v79, v83
  v_mfma_f32_32x32x16_bf16 v[224:239], v[100:103], v[68:71], 0
  s_nop 0
  v_mfma_f32_32x32x16_bf16 v[240:255], v[108:111], v[76:79], 0
  v_mfma_f32_32x32x16_bf16 v[224:239], v[104:107], v[72:75], v[224:239]
  v_mfma_f32_32x32x16_bf16 v[240:255], v[112:115], v[80:83], v[240:255]
  v_max3_f32 v4, v128, v129, v130
  v_max3_f32 v12, v144, v145, v146
  v_min3_f32 v5, v128, v129, v130
  v_min3_f32 v13, v144, v145, v146
  v_max3_f32 v4, v4, v131, v132
  v_max3_f32 v12, v12, v147, v148
  v_min3_f32 v5, v5, v131, v132
  v_min3_f32 v13, v13, v147, v148
  v_max3_f32 v4, v4, v133, v134
  v_max3_f32 v12, v12, v149, v150
  v_min3_f32 v5, v5, v133, v134
  v_min3_f32 v13, v13, v149, v150
  v_max3_f32 v4, v4, v135, v136
  v_max3_f32 v12, v12, v151, v152
  v_min3_f32 v5, v5, v135, v136
  v_min3_f32 v13, v13, v151, v152
  v_max3_f32 v4, v4, v137, v138
  v_max3_f32 v12, v12, v153, v154
  v_min3_f32 v5, v5, v137, v138
  v_min3_f32 v13, v13, v153, v154
  v_max3_f32 v4, v4, v139, v140
  v_max3_f32 v12, v12, v155, v156
  v_min3_f32 v5, v5, v139, v140
  v_min3_f32 v13, v13, v155, v156
  v_max3_f32 v4, v4, v141, v142
  v_max3_f32 v12, v12, v157, v158
  v_min3_f32 v5, v5, v141, v142
  v_min3_f32 v13, v13, v157, v158
  v_max_f32 v4, v4, v143
  v_max_f32 v12, v12, v159
  v_min_f32 v5, v5, v143
  v_min_f32 v13, v13, v159
  v_mov_b32 v6, v4
  v_mov_b32 v14, v12
  v_mov_b32 v7, v5
  v_mov_b32 v15, v13
  v_permlane32_swap_b32 v4, v6
  v_permlane32_swap_b32 v12, v14
  v_permlane32_swap_b32 v5, v7
  v_permlane32_swap_b32 v13, v15
  v_max_f32 v4, v4, v6
  v_max_f32 v12, v12, v14
  v_min_f32 v5, v5, v7
  v_min_f32 v13, v13, v15
  v_mul_f32 v6, s64, v4
  v_mul_f32 v14, s64, v12
  v_mul_f32 v4, s64, v5
  v_mul_f32 v12, s64, v13
  v_pk_fma_f32 v[20:21], v[128:129], s[64:65], v[6:7] op_sel_hi:[1,0,0] neg_lo:[0,0,1] neg_hi:[0,0,1]
  v_pk_fma_f32 v[36:37], v[144:145], s[64:65], v[14:15] op_sel_hi:[1,0,0] neg_lo:[0,0,1] neg_hi:[0,0,1]
  v_pk_fma_f32 v[128:129], v[128:129], s[64:65], v[4:5] op_sel_hi:[1,0,0] neg_lo:[1,0,0] neg_hi:[1,0,0]
  v_pk_fma_f32 v[144:145], v[144:145], s[64:65], v[12:13] op_sel_hi:[1,0,0] neg_lo:[1,0,0] neg_hi:[1,0,0]
  v_pk_fma_f32 v[22:23], v[130:131], s[64:65], v[6:7] op_sel_hi:[1,0,0] neg_lo:[0,0,1] neg_hi:[0,0,1]
  v_pk_fma_f32 v[38:39], v[146:147], s[64:65], v[14:15] op_sel_hi:[1,0,0] neg_lo:[0,0,1] neg_hi:[0,0,1]
  v_pk_fma_f32 v[130:131], v[130:131], s[64:65], v[4:5] op_sel_hi:[1,0,0] neg_lo:[1,0,0] neg_hi:[1,0,0]
  v_pk_fma_f32 v[146:147], v[146:147], s[64:65], v[12:13] op_sel_hi:[1,0,0] neg_lo:[1,0,0] neg_hi:[1,0,0]
  v_pk_fma_f32 v[24:25], v[132:133], s[64:65], v[6:7] op_sel_hi:[1,0,0] neg_lo:[0,0,1] neg_hi:[0,0,1]
  v_pk_fma_f32 v[40:41], v[148:149], s[64:65], v[14:15] op_sel_hi:[1,0,0] neg_lo:[0,0,1] neg_hi:[0,0,1]
  v_pk_fma_f32 v[132:133], v[132:133], s[64:65], v[4:5] op_sel_hi:[1,0,0] neg_lo:[1,0,0] neg_hi:[1,0,0]
  v_pk_fma_f32 v[148:149], v[148:149], s[64:65], v[12:13] op_sel_hi:[1,0,0] neg_lo:[1,0,0] neg_hi:[1,0,0]
  v_pk_fma_f32 v[26:27], v[134:135], s[64:65], v[6:7] op_sel_hi:[1,0,0] neg_lo:[0,0,1] neg_hi:[0,0,1]
  v_pk_fma_f32 v[42:43], v[150:151], s[64:65], v[14:15] op_sel_hi:[1,0,0] neg_lo:[0,0,1] neg_hi:[0,0,1]
  v_pk_fma_f32 v[134:135], v[134:135], s[64:65], v[4:5] op_sel_hi:[1,0,0] neg_lo:[1,0,0] neg_hi:[1,0,0]
  v_pk_fma_f32 v[150:151], v[150:151], s[64:65], v[12:13] op_sel_hi:[1,0,0] neg_lo:[1,0,0] neg_hi:[1,0,0]
  v_pk_fma_f32 v[28:29], v[136:137], s[64:65], v[6:7] op_sel_hi:[1,0,0] neg_lo:[0,0,1] neg_hi:[0,0,1]
  v_pk_fma_f32 v[44:45], v[152:153], s[64:65], v[14:15] op_sel_hi:[1,0,0] neg_lo:[0,0,1] neg_hi:[0,0,1]
  v_pk_fma_f32 v[136:137], v[136:137], s[64:65], v[4:5] op_sel_hi:[1,0,0] neg_lo:[1,0,0] neg_hi:[1,0,0]
  v_pk_fma_f32 v[152:153], v[152:153], s[64:65], v[12:13] op_sel_hi:[1,0,0] neg_lo:[1,0,0] neg_hi:[1,0,0]
  v_pk_fma_f32 v[30:31], v[138:139], s[64:65], v[6:7] op_sel_hi:[1,0,0] neg_lo:[0,0,1] neg_hi:[0,0,1]
  v_pk_fma_f32 v[46:47], v[154:155], s[64:65], v[14:15] op_sel_hi:[1,0,0] neg_lo:[0,0,1] neg_hi:[0,0,1]
  v_pk_fma_f32 v[138:139], v[138:139], s[64:65], v[4:5] op_sel_hi:[1,0,0] neg_lo:[1,0,0] neg_hi:[1,0,0]
  v_pk_fma_f32 v[154:155], v[154:155], s[64:65], v[12:13] op_sel_hi:[1,0,0] neg_lo:[1,0,0] neg_hi:[1,0,0]
  v_pk_fma_f32 v[32:33], v[140:141], s[64:65], v[6:7] op_sel_hi:[1,0,0] neg_lo:[0,0,1] neg_hi:[0,0,1]
  v_pk_fma_f32 v[48:49], v[156:157], s[64:65], v[14:15] op_sel_hi:[1,0,0] neg_lo:[0,0,1] neg_hi:[0,0,1]
  v_pk_fma_f32 v[140:141], v[140:141], s[64:65], v[4:5] op_sel_hi:[1,0,0] neg_lo:[1,0,0] neg_hi:[1,0,0]
  v_pk_fma_f32 v[156:157], v[156:157], s[64:65], v[12:13] op_sel_hi:[1,0,0] neg_lo:[1,0,0] neg_hi:[1,0,0]
  v_pk_fma_f32 v[34:35], v[142:143], s[64:65], v[6:7] op_sel_hi:[1,0,0] neg_lo:[0,0,1] neg_hi:[0,0,1]
  v_pk_fma_f32 v[50:51], v[158:159], s[64:65], v[14:15] op_sel_hi:[1,0,0] neg_lo:[0,0,1] neg_hi:[0,0,1]
  v_pk_fma_f32 v[142:143], v[142:143], s[64:65], v[4:5] op_sel_hi:[1,0,0] neg_lo:[1,0,0] neg_hi:[1,0,0]
  v_pk_fma_f32 v[158:159], v[158:159], s[64:65], v[12:13] op_sel_hi:[1,0,0] neg_lo:[1,0,0] neg_hi:[1,0,0]
  v_exp_f32 v20, v20
  v_exp_f32 v36, v36
  v_exp_f32 v128, v128
  v_exp_f32 v144, v144
  v_exp_f32 v21, v21
  v_exp_f32 v37, v37
  v_exp_f32 v129, v129
  v_exp_f32 v145, v145
  v_exp_f32 v22, v22
  v_exp_f32 v38, v38
  v_exp_f32 v130, v130
  v_exp_f32 v146, v146
  v_exp_f32 v23, v23
  v_exp_f32 v39, v39
  v_exp_f32 v131, v131
  v_exp_f32 v147, v147
  v_exp_f32 v24, v24
  v_exp_f32 v40, v40
  v_exp_f32 v132, v132
  v_exp_f32 v148, v148
  v_exp_f32 v25, v25
  v_exp_f32 v41, v41
  v_exp_f32 v133, v133
  v_exp_f32 v149, v149
  v_exp_f32 v26, v26
  v_exp_f32 v42, v42
  v_exp_f32 v134, v134
  v_exp_f32 v150, v150
  v_exp_f32 v27, v27
  v_exp_f32 v43, v43
  v_exp_f32 v135, v135
  v_exp_f32 v151, v151
  v_exp_f32 v28, v28
  v_exp_f32 v44, v44
  v_exp_f32 v136, v136
  v_exp_f32 v152, v152
  v_exp_f32 v29, v29
  v_exp_f32 v45, v45
  v_exp_f32 v137, v137
  v_exp_f32 v153, v153
  v_exp_f32 v30, v30
  v_exp_f32 v46, v46
  v_exp_f32 v138, v138
  v_exp_f32 v154, v154
  v_exp_f32 v31, v31
  v_exp_f32 v47, v47
  v_exp_f32 v139, v139
  v_exp_f32 v155, v155
  v_exp_f32 v32, v32
  v_exp_f32 v48, v48
  v_exp_f32 v140, v140
  v_exp_f32 v156, v156
  v_exp_f32 v33, v33
  v_exp_f32 v49, v49
  v_exp_f32 v141, v141
  v_exp_f32 v157, v157
  v_exp_f32 v34, v34
  v_exp_f32 v50, v50
  v_exp_f32 v142, v142
  v_exp_f32 v158, v158
  v_exp_f32 v35, v35
  v_exp_f32 v51, v51
  v_exp_f32 v143, v143
  v_exp_f32 v159, v159
  v_pk_add_f32 v[8:9], v[20:21], v[22:23]
  v_pk_add_f32 v[16:17], v[36:37], v[38:39]
  v_pk_add_f32 v[10:11], v[128:129], v[130:131]
  v_pk_add_f32 v[18:19], v[144:145], v[146:147]
  v_pk_add_f32 v[8:9], v[8:9], v[24:25]
  v_pk_add_f32 v[16:17], v[16:17], v[40:41]
  v_pk_add_f32 v[10:11], v[10:11], v[132:133]
  v_pk_add_f32 v[18:19], v[18:19], v[148:149]
  v_pk_add_f32 v[8:9], v[8:9], v[26:27]
  v_pk_add_f32 v[16:17], v[16:17], v[42:43]
  s_cbranch_execz K1W_q_ret
K1W_phi_1:
  v_pk_add_f32 v[10:11], v[10:11], v[134:135]
  v_pk_add_f32 v[18:19], v[18:19], v[150:151]
  v_pk_add_f32 v[8:9], v[8:9], v[28:29]
  v_pk_add_f32 v[16:17], v[16:17], v[44:45]
  v_pk_add_f32 v[10:11], v[10:11], v[136:137]
  v_pk_add_f32 v[18:19], v[18:19], v[152:153]
  v_pk_add_f32 v[8:9], v[8:9], v[30:31]
  v_pk_add_f32 v[16:17], v[16:17], v[46:47]
  v_pk_add_f32 v[10:11], v[10:11], v[138:139]
  v_pk_add_f32 v[18:19], v[18:19], v[154:155]
  v_pk_add_f32 v[8:9], v[8:9], v[32:33]
  v_pk_add_f32 v[16:17], v[16:17], v[48:49]
  v_pk_add_f32 v[10:11], v[10:11], v[140:141]
  v_pk_add_f32 v[18:19], v[18:19], v[156:157]
  v_pk_add_f32 v[8:9], v[8:9], v[34:35]
  v_pk_add_f32 v[16:17], v[16:17], v[50:51]
  v_pk_add_f32 v[10:11], v[10:11], v[142:143]
  v_pk_add_f32 v[18:19], v[18:19], v[158:159]
  v_add_f32 v8, v8, v9
  v_add_f32 v16, v16, v17
  v_add_f32 v10, v10, v11
  v_add_f32 v18, v18, v19
  v_mov_b32 v9, v8
  v_mov_b32 v17, v16
  v_mov_b32 v11, v10
  v_mov_b32 v19, v18
  v_permlane32_swap_b32 v8, v9
  v_permlane32_swap_b32 v16, v17
  v_permlane32_swap_b32 v10, v11
  v_permlane32_swap_b32 v18, v19
  v_add_f32 v8, v8, v9
  v_add_f32 v16, v16, v17
  v_add_f32 v10, v10, v11
  v_add_f32 v18, v18, v19
  v_rcp_f32 v8, v8
  v_rcp_f32 v16, v16
  v_rcp_f32 v10, v10
  v_rcp_f32 v18, v18
  v_pk_mul_f32 v[20:21], v[20:21], v[8:9] op_sel_hi:[1,0]
  v_pk_mul_f32 v[36:37], v[36:37], v[16:17] op_sel_hi:[1,0]
  v_pk_mul_f32 v[128:129], v[128:129], v[10:11] op_sel_hi:[1,0]
  v_pk_mul_f32 v[144:145], v[144:145], v[18:19] op_sel_hi:[1,0]
  v_pk_mul_f32 v[22:23], v[22:23], v[8:9] op_sel_hi:[1,0]
  v_pk_mul_f32 v[38:39], v[38:39], v[16:17] op_sel_hi:[1,0]
  v_pk_mul_f32 v[130:131], v[130:131], v[10:11] op_sel_hi:[1,0]
  v_pk_mul_f32 v[146:147], v[146:147], v[18:19] op_sel_hi:[1,0]
  v_pk_mul_f32 v[24:25], v[24:25], v[8:9] op_sel_hi:[1,0]
  v_pk_mul_f32 v[40:41], v[40:41], v[16:17] op_sel_hi:[1,0]
  v_pk_mul_f32 v[132:133], v[132:133], v[10:11] op_sel_hi:[1,0]
  v_pk_mul_f32 v[148:149], v[148:149], v[18:19] op_sel_hi:[1,0]
  v_pk_mul_f32 v[26:27], v[26:27], v[8:9] op_sel_hi:[1,0]
  v_pk_mul_f32 v[42:43], v[42:43], v[16:17] op_sel_hi:[1,0]
  v_pk_mul_f32 v[134:135], v[134:135], v[10:11] op_sel_hi:[1,0]
  v_pk_mul_f32 v[150:151], v[150:151], v[18:19] op_sel_hi:[1,0]
  v_pk_mul_f32 v[28:29], v[28:29], v[8:9] op_sel_hi:[1,0]
  v_pk_mul_f32 v[44:45], v[44:45], v[16:17] op_sel_hi:[1,0]
  v_pk_mul_f32 v[136:137], v[136:137], v[10:11] op_sel_hi:[1,0]
  v_pk_mul_f32 v[152:153], v[152:153], v[18:19] op_sel_hi:[1,0]
  v_pk_mul_f32 v[30:31], v[30:31], v[8:9] op_sel_hi:[1,0]
  v_pk_mul_f32 v[46:47], v[46:47], v[16:17] op_sel_hi:[1,0]
  v_pk_mul_f32 v[138:139], v[138:139], v[10:11] op_sel_hi:[1,0]
  v_pk_mul_f32 v[154:155], v[154:155], v[18:19] op_sel_hi:[1,0]
  v_pk_mul_f32 v[32:33], v[32:33], v[8:9] op_sel_hi:[1,0]
  v_pk_mul_f32 v[48:49], v[48:49], v[16:17] op_sel_hi:[1,0]
  v_pk_mul_f32 v[140:141], v[140:141], v[10:11] op_sel_hi:[1,0]
  v_pk_mul_f32 v[156:157], v[156:157], v[18:19] op_sel_hi:[1,0]
  v_pk_mul_f32 v[34:35], v[34:35], v[8:9] op_sel_hi:[1,0]
  v_pk_mul_f32 v[50:51], v[50:51], v[16:17] op_sel_hi:[1,0]
  v_pk_mul_f32 v[142:143], v[142:143], v[10:11] op_sel_hi:[1,0]
  v_pk_mul_f32 v[158:159], v[158:159], v[18:19] op_sel_hi:[1,0]
  v_cvt_pk_bf16_f32 v20, v20, v21
  v_cvt_pk_bf16_f32 v36, v36, v37
  v_cvt_pk_bf16_f32 v128, v128, v129
  v_cvt_pk_bf16_f32 v144, v144, v145
  v_cvt_pk_bf16_f32 v21, v22, v23
  v_cvt_pk_bf16_f32 v37, v38, v39
  v_cvt_pk_bf16_f32 v129, v130, v131
  v_cvt_pk_bf16_f32 v145, v146, v147
  v_cvt_pk_bf16_f32 v22, v24, v25
  v_cvt_pk_bf16_f32 v38, v40, v41
  v_cvt_pk_bf16_f32 v130, v132, v133
  v_cvt_pk_bf16_f32 v146, v148, v149
  v_cvt_pk_bf16_f32 v23, v26, v27
  v_cvt_pk_bf16_f32 v39, v42, v43
  v_cvt_pk_bf16_f32 v131, v134, v135
  v_cvt_pk_bf16_f32 v147, v150, v151
  v_cvt_pk_bf16_f32 v24, v28, v29
  v_cvt_pk_bf16_f32 v40, v44, v45
  v_cvt_pk_bf16_f32 v132, v136, v137
  v_cvt_pk_bf16_f32 v148, v152, v153
  v_cvt_pk_bf16_f32 v25, v30, v31
  v_cvt_pk_bf16_f32 v41, v46, v47
  v_cvt_pk_bf16_f32 v133, v138, v139
  v_cvt_pk_bf16_f32 v149, v154, v155
  v_cvt_pk_bf16_f32 v26, v32, v33
  v_cvt_pk_bf16_f32 v42, v48, v49
  v_cvt_pk_bf16_f32 v134, v140, v141
  v_cvt_pk_bf16_f32 v150, v156, v157
  v_cvt_pk_bf16_f32 v27, v34, v35
  v_cvt_pk_bf16_f32 v43, v50, v51
  v_cvt_pk_bf16_f32 v135, v142, v143
  v_cvt_pk_bf16_f32 v151, v158, v159
  v_max3_f32 v4, v160, v161, v162
  v_max3_f32 v12, v176, v177, v178
  v_min3_f32 v5, v160, v161, v162
  v_min3_f32 v13, v176, v177, v178
  v_max3_f32 v4, v4, v163, v164
  v_max3_f32 v12, v12, v179, v180
  v_min3_f32 v5, v5, v163, v164
  v_min3_f32 v13, v13, v179, v180
  v_max3_f32 v4, v4, v165, v166
  v_max3_f32 v12, v12, v181, v182
  v_min3_f32 v5, v5, v165, v166
  v_min3_f32 v13, v13, v181, v182
  buffer_store_dwordx4 v[20:23], v3, s[48:51], s9 offen offset:0 sc0 sc1
  v_max3_f32 v4, v4, v167, v168
  v_max3_f32 v12, v12, v183, v184
  v_min3_f32 v5, v5, v167, v168
  v_min3_f32 v13, v13, v183, v184
  v_max3_f32 v4, v4, v169, v170
  v_max3_f32 v12, v12, v185, v186
  v_min3_f32 v5, v5, v169, v170
  v_min3_f32 v13, v13, v185, v186
  v_max3_f32 v4, v4, v171, v172
  v_max3_f32 v12, v12, v187, v188
  v_min3_f32 v5, v5, v171, v172
  v_min3_f32 v13, v13, v187, v188
  v_max3_f32 v4, v4, v173, v174
  v_max3_f32 v12, v12, v189, v190
  v_min3_f32 v5, v5, v173, v174
  v_min3_f32 v13, v13, v189, v190
  v_max_f32 v4, v4, v175
  v_max_f32 v12, v12, v191
  v_min_f32 v5, v5, v175
  v_min_f32 v13, v13, v191
  v_mov_b32 v6, v4
  v_mov_b32 v14, v12
  v_mov_b32 v7, v5
  v_mov_b32 v15, v13
  v_permlane32_swap_b32 v4, v6
  v_permlane32_swap_b32 v12, v14
  v_permlane32_swap_b32 v5, v7
  v_permlane32_swap_b32 v13, v15
  buffer_store_dwordx4 v[36:39], v3, s[48:51], s10 offen offset:0 sc0 sc1
  v_max_f32 v4, v4, v6
  v_max_f32 v12, v12, v14
  v_min_f32 v5, v5, v7
  v_min_f32 v13, v13, v15
  v_mul_f32 v6, s64, v4
  v_mul_f32 v14, s64, v12
  v_mul_f32 v4, s64, v5
  v_mul_f32 v12, s64, v13
  v_pk_fma_f32 v[52:53], v[160:161], s[64:65], v[6:7] op_sel_hi:[1,0,0] neg_lo:[0,0,1] neg_hi:[0,0,1]
  v_pk_fma_f32 v[68:69], v[176:177], s[64:65], v[14:15] op_sel_hi:[1,0,0] neg_lo:[0,0,1] neg_hi:[0,0,1]
  v_pk_fma_f32 v[160:161], v[160:161], s[64:65], v[4:5] op_sel_hi:[1,0,0] neg_lo:[1,0,0] neg_hi:[1,0,0]
  v_pk_fma_f32 v[176:177], v[176:177], s[64:65], v[12:13] op_sel_hi:[1,0,0] neg_lo:[1,0,0] neg_hi:[1,0,0]
  v_pk_fma_f32 v[54:55], v[162:163], s[64:65], v[6:7] op_sel_hi:[1,0,0] neg_lo:[0,0,1] neg_hi:[0,0,1]
  v_pk_fma_f32 v[70:71], v[178:179], s[64:65], v[14:15] op_sel_hi:[1,0,0] neg_lo:[0,0,1] neg_hi:[0,0,1]
  v_pk_fma_f32 v[162:163], v[162:163], s[64:65], v[4:5] op_sel_hi:[1,0,0] neg_lo:[1,0,0] neg_hi:[1,0,0]
  v_pk_fma_f32 v[178:179], v[178:179], s[64:65], v[12:13] op_sel_hi:[1,0,0] neg_lo:[1,0,0] neg_hi:[1,0,0]
  v_pk_fma_f32 v[56:57], v[164:165], s[64:65], v[6:7] op_sel_hi:[1,0,0] neg_lo:[0,0,1] neg_hi:[0,0,1]
  v_pk_fma_f32 v[72:73], v[180:181], s[64:65], v[14:15] op_sel_hi:[1,0,0] neg_lo:[0,0,1] neg_hi:[0,0,1]
  v_pk_fma_f32 v[164:165], v[164:165], s[64:65], v[4:5] op_sel_hi:[1,0,0] neg_lo:[1,0,0] neg_hi:[1,0,0]
  v_pk_fma_f32 v[180:181], v[180:181], s[64:65], v[12:13] op_sel_hi:[1,0,0] neg_lo:[1,0,0] neg_hi:[1,0,0]
  v_pk_fma_f32 v[58:59], v[166:167], s[64:65], v[6:7] op_sel_hi:[1,0,0] neg_lo:[0,0,1] neg_hi:[0,0,1]
  v_pk_fma_f32 v[74:75], v[182:183], s[64:65], v[14:15] op_sel_hi:[1,0,0] neg_lo:[0,0,1] neg_hi:[0,0,1]
  v_pk_fma_f32 v[166:167], v[166:167], s[64:65], v[4:5] op_sel_hi:[1,0,0] neg_lo:[1,0,0] neg_hi:[1,0,0]
  v_pk_fma_f32 v[182:183], v[182:183], s[64:65], v[12:13] op_sel_hi:[1,0,0] neg_lo:[1,0,0] neg_hi:[1,0,0]
  v_pk_fma_f32 v[60:61], v[168:169], s[64:65], v[6:7] op_sel_hi:[1,0,0] neg_lo:[0,0,1] neg_hi:[0,0,1]
  v_pk_fma_f32 v[76:77], v[184:185], s[64:65], v[14:15] op_sel_hi:[1,0,0] neg_lo:[0,0,1] neg_hi:[0,0,1]
  v_pk_fma_f32 v[168:169], v[168:169], s[64:65], v[4:5] op_sel_hi:[1,0,0] neg_lo:[1,0,0] neg_hi:[1,0,0]
  v_pk_fma_f32 v[184:185], v[184:185], s[64:65], v[12:13] op_sel_hi:[1,0,0] neg_lo:[1,0,0] neg_hi:[1,0,0]
  buffer_store_dwordx4 v[24:27], v3, s[48:51], s9 offen offset:1024 sc0 sc1
  v_pk_fma_f32 v[62:63], v[170:171], s[64:65], v[6:7] op_sel_hi:[1,0,0] neg_lo:[0,0,1] neg_hi:[0,0,1]
  v_pk_fma_f32 v[78:79], v[186:187], s[64:65], v[14:15] op_sel_hi:[1,0,0] neg_lo:[0,0,1] neg_hi:[0,0,1]
  v_pk_fma_f32 v[170:171], v[170:171], s[64:65], v[4:5] op_sel_hi:[1,0,0] neg_lo:[1,0,0] neg_hi:[1,0,0]
  v_pk_fma_f32 v[186:187], v[186:187], s[64:65], v[12:13] op_sel_hi:[1,0,0] neg_lo:[1,0,0] neg_hi:[1,0,0]
  v_pk_fma_f32 v[64:65], v[172:173], s[64:65], v[6:7] op_sel_hi:[1,0,0] neg_lo:[0,0,1] neg_hi:[0,0,1]
  v_pk_fma_f32 v[80:81], v[188:189], s[64:65], v[14:15] op_sel_hi:[1,0,0] neg_lo:[0,0,1] neg_hi:[0,0,1]
  v_pk_fma_f32 v[172:173], v[172:173], s[64:65], v[4:5] op_sel_hi:[1,0,0] neg_lo:[1,0,0] neg_hi:[1,0,0]
  v_pk_fma_f32 v[188:189], v[188:189], s[64:65], v[12:13] op_sel_hi:[1,0,0] neg_lo:[1,0,0] neg_hi:[1,0,0]
  v_pk_fma_f32 v[66:67], v[174:175], s[64:65], v[6:7] op_sel_hi:[1,0,0] neg_lo:[0,0,1] neg_hi:[0,0,1]
  v_pk_fma_f32 v[82:83], v[190:191], s[64:65], v[14:15] op_sel_hi:[1,0,0] neg_lo:[0,0,1] neg_hi:[0,0,1]
  v_pk_fma_f32 v[174:175], v[174:175], s[64:65], v[4:5] op_sel_hi:[1,0,0] neg_lo:[1,0,0] neg_hi:[1,0,0]
  v_pk_fma_f32 v[190:191], v[190:191], s[64:65], v[12:13] op_sel_hi:[1,0,0] neg_lo:[1,0,0] neg_hi:[1,0,0]
  v_exp_f32 v52, v52
  v_exp_f32 v68, v68
  v_exp_f32 v160, v160
  v_exp_f32 v176, v176
  v_exp_f32 v53, v53
  v_exp_f32 v69, v69
  v_exp_f32 v161, v161
  v_exp_f32 v177, v177
  v_exp_f32 v54, v54
  v_exp_f32 v70, v70
  v_exp_f32 v162, v162
  v_exp_f32 v178, v178
  v_exp_f32 v55, v55
  v_exp_f32 v71, v71
  v_exp_f32 v163, v163
  v_exp_f32 v179, v179
  buffer_store_dwordx4 v[40:43], v3, s[48:51], s10 offen offset:1024 sc0 sc1
  v_exp_f32 v56, v56
  v_exp_f32 v72, v72
  v_exp_f32 v164, v164
  v_exp_f32 v180, v180
  v_exp_f32 v57, v57
  v_exp_f32 v73, v73
  v_exp_f32 v165, v165
  v_exp_f32 v181, v181
  v_exp_f32 v58, v58
  v_exp_f32 v74, v74
  v_exp_f32 v166, v166
  v_exp_f32 v182, v182
  v_exp_f32 v59, v59
  v_exp_f32 v75, v75
  v_exp_f32 v167, v167
  v_exp_f32 v183, v183
  v_exp_f32 v60, v60
  v_exp_f32 v76, v76
  v_exp_f32 v168, v168
  v_exp_f32 v184, v184
  v_exp_f32 v61, v61
  v_exp_f32 v77, v77
  v_exp_f32 v169, v169
  v_exp_f32 v185, v185
  v_exp_f32 v62, v62
  v_exp_f32 v78, v78
  v_exp_f32 v170, v170
  v_exp_f32 v186, v186
  buffer_store_dwordx4 v[128:131], v3, s[48:51], s9 offen offset:2048 sc0 sc1
  v_exp_f32 v63, v63
  v_exp_f32 v79, v79
  v_exp_f32 v171, v171
  v_exp_f32 v187, v187
  v_exp_f32 v64, v64
  v_exp_f32 v80, v80
  v_exp_f32 v172, v172
  v_exp_f32 v188, v188
  v_exp_f32 v65, v65
  v_exp_f32 v81, v81
  v_exp_f32 v173, v173
  v_exp_f32 v189, v189
  v_exp_f32 v66, v66
  v_exp_f32 v82, v82
  v_exp_f32 v174, v174
  v_exp_f32 v190, v190
  v_exp_f32 v67, v67
  v_exp_f32 v83, v83
  v_exp_f32 v175, v175
  v_exp_f32 v191, v191
  v_pk_add_f32 v[8:9], v[52:53], v[54:55]
  v_pk_add_f32 v[16:17], v[68:69], v[70:71]
  v_pk_add_f32 v[10:11], v[160:161], v[162:163]
  v_pk_add_f32 v[18:19], v[176:177], v[178:179]
  v_pk_add_f32 v[8:9], v[8:9], v[56:57]
  v_pk_add_f32 v[16:17], v[16:17], v[72:73]
  v_pk_add_f32 v[10:11], v[10:11], v[164:165]
  v_pk_add_f32 v[18:19], v[18:19], v[180:181]
  buffer_store_dwordx4 v[144:147], v3, s[48:51], s10 offen offset:2048 sc0 sc1
  v_pk_add_f32 v[8:9], v[8:9], v[58:59]
  v_pk_add_f32 v[16:17], v[16:17], v[74:75]
  v_pk_add_f32 v[10:11], v[10:11], v[166:167]
  v_pk_add_f32 v[18:19], v[18:19], v[182:183]
  v_pk_add_f32 v[8:9], v[8:9], v[60:61]
  v_pk_add_f32 v[16:17], v[16:17], v[76:77]
  v_pk_add_f32 v[10:11], v[10:11], v[168:169]
  v_pk_add_f32 v[18:19], v[18:19], v[184:185]
  v_pk_add_f32 v[8:9], v[8:9], v[62:63]
  v_pk_add_f32 v[16:17], v[16:17], v[78:79]
  v_pk_add_f32 v[10:11], v[10:11], v[170:171]
  v_pk_add_f32 v[18:19], v[18:19], v[186:187]
  v_pk_add_f32 v[8:9], v[8:9], v[64:65]
  v_pk_add_f32 v[16:17], v[16:17], v[80:81]
  v_pk_add_f32 v[10:11], v[10:11], v[172:173]
  v_pk_add_f32 v[18:19], v[18:19], v[188:189]
  v_pk_add_f32 v[8:9], v[8:9], v[66:67]
  v_pk_add_f32 v[16:17], v[16:17], v[82:83]
  v_pk_add_f32 v[10:11], v[10:11], v[174:175]
  v_pk_add_f32 v[18:19], v[18:19], v[190:191]
  v_add_f32 v8, v8, v9
  v_add_f32 v16, v16, v17
  v_add_f32 v10, v10, v11
  v_add_f32 v18, v18, v19
  v_mov_b32 v9, v8
  v_mov_b32 v17, v16
  v_mov_b32 v11, v10
  v_mov_b32 v19, v18
  buffer_store_dwordx4 v[132:135], v3, s[48:51], s9 offen offset:3072 sc0 sc1
  v_permlane32_swap_b32 v8, v9
  v_permlane32_swap_b32 v16, v17
  v_permlane32_swap_b32 v10, v11
  v_permlane32_swap_b32 v18, v19
  v_add_f32 v8, v8, v9
  v_add_f32 v16, v16, v17
  v_add_f32 v10, v10, v11
  v_add_f32 v18, v18, v19
  v_rcp_f32 v8, v8
  v_rcp_f32 v16, v16
  v_rcp_f32 v10, v10
  v_rcp_f32 v18, v18
  s_cbranch_execz K1W_q_ret
K1W_phi_2:
  v_pk_mul_f32 v[52:53], v[52:53], v[8:9] op_sel_hi:[1,0]
  v_pk_mul_f32 v[68:69], v[68:69], v[16:17] op_sel_hi:[1,0]
  v_pk_mul_f32 v[160:161], v[160:161], v[10:11] op_sel_hi:[1,0]
  v_pk_mul_f32 v[176:177], v[176:177], v[18:19] op_sel_hi:[1,0]
  v_pk_mul_f32 v[54:55], v[54:55], v[8:9] op_sel_hi:[1,0]
  v_pk_mul_f32 v[70:71], v[70:71], v[16:17] op_sel_hi:[1,0]
  v_pk_mul_f32 v[162:163], v[162:163], v[10:11] op_sel_hi:[1,0]
  v_pk_mul_f32 v[178:179], v[178:179], v[18:19] op_sel_hi:[1,0]
  v_pk_mul_f32 v[56:57], v[56:57], v[8:9] op_sel_hi:[1,0]
  v_pk_mul_f32 v[72:73], v[72:73], v[16:17] op_sel_hi:[1,0]
  v_pk_mul_f32 v[164:165], v[164:165], v[10:11] op_sel_hi:[1,0]
  v_pk_mul_f32 v[180:181], v[180:181], v[18:19] op_sel_hi:[1,0]
  v_pk_mul_f32 v[58:59], v[58:59], v[8:9] op_sel_hi:[1,0]
  v_pk_mul_f32 v[74:75], v[74:75], v[16:17] op_sel_hi:[1,0]
  v_pk_mul_f32 v[166:167], v[166:167], v[10:11] op_sel_hi:[1,0]
  v_pk_mul_f32 v[182:183], v[182:183], v[18:19] op_sel_hi:[1,0]
  buffer_store_dwordx4 v[148:151], v3, s[48:51], s10 offen offset:3072 sc0 sc1
  s_add_u32 s9, s9, 4096
  s_add_u32 s10, s10, 4096
  v_pk_mul_f32 v[60:61], v[60:61], v[8:9] op_sel_hi:[1,0]
  v_pk_mul_f32 v[76:77], v[76:77], v[16:17] op_sel_hi:[1,0]
  v_pk_mul_f32 v[168:169], v[168:169], v[10:11] op_sel_hi:[1,0]
  v_pk_mul_f32 v[184:185], v[184:185], v[18:19] op_sel_hi:[1,0]
  v_pk_mul_f32 v[62:63], v[62:63], v[8:9] op_sel_hi:[1,0]
  v_pk_mul_f32 v[78:79], v[78:79], v[16:17] op_sel_hi:[1,0]
  v_pk_mul_f32 v[170:171], v[170:171], v[10:11] op_sel_hi:[1,0]
  v_pk_mul_f32 v[186:187], v[186:187], v[18:19] op_sel_hi:[1,0]
  v_pk_mul_f32 v[64:65], v[64:65], v[8:9] op_sel_hi:[1,0]
  v_pk_mul_f32 v[80:81], v[80:81], v[16:17] op_sel_hi:[1,0]
  v_pk_mul_f32 v[172:173], v[172:173], v[10:11] op_sel_hi:[1,0]
  v_pk_mul_f32 v[188:189], v[188:189], v[18:19] op_sel_hi:[1,0]
  v_pk_mul_f32 v[66:67], v[66:67], v[8:9] op_sel_hi:[1,0]
  v_pk_mul_f32 v[82:83], v[82:83], v[16:17] op_sel_hi:[1,0]
  v_pk_mul_f32 v[174:175], v[174:175], v[10:11] op_sel_hi:[1,0]
  v_pk_mul_f32 v[190:191], v[190:191], v[18:19] op_sel_hi:[1,0]
  v_cvt_pk_bf16_f32 v52, v52, v53
  v_cvt_pk_bf16_f32 v68, v68, v69
  v_cvt_pk_bf16_f32 v160, v160, v161
  v_cvt_pk_bf16_f32 v176, v176, v177
  v_cvt_pk_bf16_f32 v53, v54, v55
  v_cvt_pk_bf16_f32 v69, v70, v71
  v_cvt_pk_bf16_f32 v161, v162, v163
  v_cvt_pk_bf16_f32 v177, v178, v179
  v_cvt_pk_bf16_f32 v54, v56, v57
  v_cvt_pk_bf16_f32 v70, v72, v73
  v_cvt_pk_bf16_f32 v162, v164, v165
  v_cvt_pk_bf16_f32 v178, v180, v181
  v_cvt_pk_bf16_f32 v55, v58, v59
  v_cvt_pk_bf16_f32 v71, v74, v75
  v_cvt_pk_bf16_f32 v163, v166, v167
  v_cvt_pk_bf16_f32 v179, v182, v183
  v_cvt_pk_bf16_f32 v56, v60, v61
  v_cvt_pk_bf16_f32 v72, v76, v77
  v_cvt_pk_bf16_f32 v164, v168, v169
  v_cvt_pk_bf16_f32 v180, v184, v185
  v_cvt_pk_bf16_f32 v57, v62, v63
  v_cvt_pk_bf16_f32 v73, v78, v79
  v_cvt_pk_bf16_f32 v165, v170, v171
  v_cvt_pk_bf16_f32 v181, v186, v187
  v_cvt_pk_bf16_f32 v58, v64, v65
  v_cvt_pk_bf16_f32 v74, v80, v81
  v_cvt_pk_bf16_f32 v166, v172, v173
  v_cvt_pk_bf16_f32 v182, v188, v189
  v_cvt_pk_bf16_f32 v59, v66, v67
  v_cvt_pk_bf16_f32 v75, v82, v83
  v_cvt_pk_bf16_f32 v167, v174, v175
  v_cvt_pk_bf16_f32 v183, v190, v191
  v_max3_f32 v4, v192, v193, v194
  v_max3_f32 v12, v208, v209, v210
  v_min3_f32 v5, v192, v193, v194
  v_min3_f32 v13, v208, v209, v210
  v_max3_f32 v4, v4, v195, v196
  v_max3_f32 v12, v12, v211, v212
  v_min3_f32 v5, v5, v195, v196
  v_min3_f32 v13, v13, v211, v212
  v_max3_f32 v4, v4, v197, v198
  v_max3_f32 v12, v12, v213, v214
  v_min3_f32 v5, v5, v197, v198
  v_min3_f32 v13, v13, v213, v214
  buffer_store_dwordx4 v[52:55], v3, s[48:51], s9 offen offset:0 sc0 sc1
  v_max3_f32 v4, v4, v199, v200
  v_max3_f32 v12, v12, v215, v216
  v_min3_f32 v5, v5, v199, v200
  v_min3_f32 v13, v13, v215, v216
  v_max3_f32 v4, v4, v201, v202
  v_max3_f32 v12, v12, v217, v218
  v_min3_f32 v5, v5, v201, v202
  v_min3_f32 v13, v13, v217, v218
  v_max3_f32 v4, v4, v203, v204
  v_max3_f32 v12, v12, v219, v220
  v_min3_f32 v5, v5, v203, v204
  v_min3_f32 v13, v13, v219, v220
  v_max3_f32 v4, v4, v205, v206
  v_max3_f32 v12, v12, v221, v222
  v_min3_f32 v5, v5, v205, v206
  v_min3_f32 v13, v13, v221, v222
  v_max_f32 v4, v4, v207
  v_max_f32 v12, v12, v223
  v_min_f32 v5, v5, v207
  v_min_f32 v13, v13, v223
  v_mov_b32 v6, v4
  v_mov_b32 v14, v12
  v_mov_b32 v7, v5
  v_mov_b32 v15, v13
  v_permlane32_swap_b32 v4, v6
  v_permlane32_swap_b32 v12, v14
  v_permlane32_swap_b32 v5, v7
  v_permlane32_swap_b32 v13, v15
  buffer_store_dwordx4 v[68:71], v3, s[48:51], s10 offen offset:0 sc0 sc1
  v_max_f32 v4, v4, v6
  v_max_f32 v12, v12, v14
  v_min_f32 v5, v5, v7
  v_min_f32 v13, v13, v15
  v_mul_f32 v6, s64, v4
  v_mul_f32 v14, s64, v12
  v_mul_f32 v4, s64, v5
  v_mul_f32 v12, s64, v13
  v_pk_fma_f32 v[20:21], v[192:193], s[64:65], v[6:7] op_sel_hi:[1,0,0] neg_lo:[0,0,1] neg_hi:[0,0,1]
  v_pk_fma_f32 v[36:37], v[208:209], s[64:65], v[14:15] op_sel_hi:[1,0,0] neg_lo:[0,0,1] neg_hi:[0,0,1]
  v_pk_fma_f32 v[192:193], v[192:193], s[64:65], v[4:5] op_sel_hi:[1,0,0] neg_lo:[1,0,0] neg_hi:[1,0,0]
  v_pk_fma_f32 v[208:209], v[208:209], s[64:65], v[12:13] op_sel_hi:[1,0,0] neg_lo:[1,0,0] neg_hi:[1,0,0]
  v_pk_fma_f32 v[22:23], v[194:195], s[64:65], v[6:7] op_sel_hi:[1,0,0] neg_lo:[0,0,1] neg_hi:[0,0,1]
  v_pk_fma_f32 v[38:39], v[210:211], s[64:65], v[14:15] op_sel_hi:[1,0,0] neg_lo:[0,0,1] neg_hi:[0,0,1]
  v_pk_fma_f32 v[194:195], v[194:195], s[64:65], v[4:5] op_sel_hi:[1,0,0] neg_lo:[1,0,0] neg_hi:[1,0,0]
  v_pk_fma_f32 v[210:211], v[210:211], s[64:65], v[12:13] op_sel_hi:[1,0,0] neg_lo:[1,0,0] neg_hi:[1,0,0]
  v_pk_fma_f32 v[24:25], v[196:197], s[64:65], v[6:7] op_sel_hi:[1,0,0] neg_lo:[0,0,1] neg_hi:[0,0,1]
  v_pk_fma_f32 v[40:41], v[212:213], s[64:65], v[14:15] op_sel_hi:[1,0,0] neg_lo:[0,0,1] neg_hi:[0,0,1]
  v_pk_fma_f32 v[196:197], v[196:197], s[64:65], v[4:5] op_sel_hi:[1,0,0] neg_lo:[1,0,0] neg_hi:[1,0,0]
  v_pk_fma_f32 v[212:213], v[212:213], s[64:65], v[12:13] op_sel_hi:[1,0,0] neg_lo:[1,0,0] neg_hi:[1,0,0]
  v_pk_fma_f32 v[26:27], v[198:199], s[64:65], v[6:7] op_sel_hi:[1,0,0] neg_lo:[0,0,1] neg_hi:[0,0,1]
  v_pk_fma_f32 v[42:43], v[214:215], s[64:65], v[14:15] op_sel_hi:[1,0,0] neg_lo:[0,0,1] neg_hi:[0,0,1]
  v_pk_fma_f32 v[198:199], v[198:199], s[64:65], v[4:5] op_sel_hi:[1,0,0] neg_lo:[1,0,0] neg_hi:[1,0,0]
  v_pk_fma_f32 v[214:215], v[214:215], s[64:65], v[12:13] op_sel_hi:[1,0,0] neg_lo:[1,0,0] neg_hi:[1,0,0]
  v_pk_fma_f32 v[28:29], v[200:201], s[64:65], v[6:7] op_sel_hi:[1,0,0] neg_lo:[0,0,1] neg_hi:[0,0,1]
  v_pk_fma_f32 v[44:45], v[216:217], s[64:65], v[14:15] op_sel_hi:[1,0,0] neg_lo:[0,0,1] neg_hi:[0,0,1]
  v_pk_fma_f32 v[200:201], v[200:201], s[64:65], v[4:5] op_sel_hi:[1,0,0] neg_lo:[1,0,0] neg_hi:[1,0,0]
  v_pk_fma_f32 v[216:217], v[216:217], s[64:65], v[12:13] op_sel_hi:[1,0,0] neg_lo:[1,0,0] neg_hi:[1,0,0]
  buffer_store_dwordx4 v[56:59], v3, s[48:51], s9 offen offset:1024 sc0 sc1
  v_pk_fma_f32 v[30:31], v[202:203], s[64:65], v[6:7] op_sel_hi:[1,0,0] neg_lo:[0,0,1] neg_hi:[0,0,1]
  v_pk_fma_f32 v[46:47], v[218:219], s[64:65], v[14:15] op_sel_hi:[1,0,0] neg_lo:[0,0,1] neg_hi:[0,0,1]
  v_pk_fma_f32 v[202:203], v[202:203], s[64:65], v[4:5] op_sel_hi:[1,0,0] neg_lo:[1,0,0] neg_hi:[1,0,0]
  v_pk_fma_f32 v[218:219], v[218:219], s[64:65], v[12:13] op_sel_hi:[1,0,0] neg_lo:[1,0,0] neg_hi:[1,0,0]
  v_pk_fma_f32 v[32:33], v[204:205], s[64:65], v[6:7] op_sel_hi:[1,0,0] neg_lo:[0,0,1] neg_hi:[0,0,1]
  v_pk_fma_f32 v[48:49], v[220:221], s[64:65], v[14:15] op_sel_hi:[1,0,0] neg_lo:[0,0,1] neg_hi:[0,0,1]
  v_pk_fma_f32 v[204:205], v[204:205], s[64:65], v[4:5] op_sel_hi:[1,0,0] neg_lo:[1,0,0] neg_hi:[1,0,0]
  v_pk_fma_f32 v[220:221], v[220:221], s[64:65], v[12:13] op_sel_hi:[1,0,0] neg_lo:[1,0,0] neg_hi:[1,0,0]
  v_pk_fma_f32 v[34:35], v[206:207], s[64:65], v[6:7] op_sel_hi:[1,0,0] neg_lo:[0,0,1] neg_hi:[0,0,1]
  v_pk_fma_f32 v[50:51], v[222:223], s[64:65], v[14:15] op_sel_hi:[1,0,0] neg_lo:[0,0,1] neg_hi:[0,0,1]
  v_pk_fma_f32 v[206:207], v[206:207], s[64:65], v[4:5] op_sel_hi:[1,0,0] neg_lo:[1,0,0] neg_hi:[1,0,0]
  v_pk_fma_f32 v[222:223], v[222:223], s[64:65], v[12:13] op_sel_hi:[1,0,0] neg_lo:[1,0,0] neg_hi:[1,0,0]
  v_exp_f32 v20, v20
  v_exp_f32 v36, v36
  v_exp_f32 v192, v192
  v_exp_f32 v208, v208
  v_exp_f32 v21, v21
  v_exp_f32 v37, v37
  v_exp_f32 v193, v193
  v_exp_f32 v209, v209
  v_exp_f32 v22, v22
  v_exp_f32 v38, v38
  v_exp_f32 v194, v194
  v_exp_f32 v210, v210
  v_exp_f32 v23, v23
  v_exp_f32 v39, v39
  v_exp_f32 v195, v195
  v_exp_f32 v211, v211
  buffer_store_dwordx4 v[72:75], v3, s[48:51], s10 offen offset:1024 sc0 sc1
  v_exp_f32 v24, v24
  v_exp_f32 v40, v40
  v_exp_f32 v196, v196
  v_exp_f32 v212, v212
  v_exp_f32 v25, v25
  v_exp_f32 v41, v41
  v_exp_f32 v197, v197
  v_exp_f32 v213, v213
  v_exp_f32 v26, v26
  v_exp_f32 v42, v42
  v_exp_f32 v198, v198
  v_exp_f32 v214, v214
  v_exp_f32 v27, v27
  v_exp_f32 v43, v43
  v_exp_f32 v199, v199
  v_exp_f32 v215, v215
  v_exp_f32 v28, v28
  v_exp_f32 v44, v44
  v_exp_f32 v200, v200
  v_exp_f32 v216, v216
  v_exp_f32 v29, v29
  v_exp_f32 v45, v45
  v_exp_f32 v201, v201
  v_exp_f32 v217, v217
  v_exp_f32 v30, v30
  v_exp_f32 v46, v46
  v_exp_f32 v202, v202
  v_exp_f32 v218, v218
  buffer_store_dwordx4 v[160:163], v3, s[48:51], s9 offen offset:2048 sc0 sc1
  v_exp_f32 v31, v31
  v_exp_f32 v47, v47
  v_exp_f32 v203, v203
  v_exp_f32 v219, v219
  v_exp_f32 v32, v32
  v_exp_f32 v48, v48
  v_exp_f32 v204, v204
  v_exp_f32 v220, v220
  v_exp_f32 v33, v33
  v_exp_f32 v49, v49
  v_exp_f32 v205, v205
  v_exp_f32 v221, v221
  v_exp_f32 v34, v34
  v_exp_f32 v50, v50
  v_exp_f32 v206, v206
  v_exp_f32 v222, v222
  v_exp_f32 v35, v35
  v_exp_f32 v51, v51
  v_exp_f32 v207, v207
  v_exp_f32 v223, v223
  v_pk_add_f32 v[8:9], v[20:21], v[22:23]
  v_pk_add_f32 v[16:17], v[36:37], v[38:39]
  v_pk_add_f32 v[10:11], v[192:193], v[194:195]
  v_pk_add_f32 v[18:19], v[208:209], v[210:211]
  v_pk_add_f32 v[8:9], v[8:9], v[24:25]
  v_pk_add_f32 v[16:17], v[16:17], v[40:41]
  v_pk_add_f32 v[10:11], v[10:11], v[196:197]
  v_pk_add_f32 v[18:19], v[18:19], v[212:213]
  buffer_store_dwordx4 v[176:179], v3, s[48:51], s10 offen offset:2048 sc0 sc1
  v_pk_add_f32 v[8:9], v[8:9], v[26:27]
  v_pk_add_f32 v[16:17], v[16:17], v[42:43]
  v_pk_add_f32 v[10:11], v[10:11], v[198:199]
  v_pk_add_f32 v[18:19], v[18:19], v[214:215]
  v_pk_add_f32 v[8:9], v[8:9], v[28:29]
  v_pk_add_f32 v[16:17], v[16:17], v[44:45]
  v_pk_add_f32 v[10:11], v[10:11], v[200:201]
  v_pk_add_f32 v[18:19], v[18:19], v[216:217]
  v_pk_add_f32 v[8:9], v[8:9], v[30:31]
  v_pk_add_f32 v[16:17], v[16:17], v[46:47]
  v_pk_add_f32 v[10:11], v[10:11], v[202:203]
  v_pk_add_f32 v[18:19], v[18:19], v[218:219]
  v_pk_add_f32 v[8:9], v[8:9], v[32:33]
  v_pk_add_f32 v[16:17], v[16:17], v[48:49]
  v_pk_add_f32 v[10:11], v[10:11], v[204:205]
  v_pk_add_f32 v[18:19], v[18:19], v[220:221]
  v_pk_add_f32 v[8:9], v[8:9], v[34:35]
  v_pk_add_f32 v[16:17], v[16:17], v[50:51]
  v_pk_add_f32 v[10:11], v[10:11], v[206:207]
  v_pk_add_f32 v[18:19], v[18:19], v[222:223]
  v_add_f32 v8, v8, v9
  v_add_f32 v16, v16, v17
  v_add_f32 v10, v10, v11
  v_add_f32 v18, v18, v19
  v_mov_b32 v9, v8
  v_mov_b32 v17, v16
  v_mov_b32 v11, v10
  v_mov_b32 v19, v18
  buffer_store_dwordx4 v[164:167], v3, s[48:51], s9 offen offset:3072 sc0 sc1
  v_permlane32_swap_b32 v8, v9
  v_permlane32_swap_b32 v16, v17
  v_permlane32_swap_b32 v10, v11
  v_permlane32_swap_b32 v18, v19
  v_add_f32 v8, v8, v9
  v_add_f32 v16, v16, v17
  v_add_f32 v10, v10, v11
  v_add_f32 v18, v18, v19
  v_rcp_f32 v8, v8
  v_rcp_f32 v16, v16
  v_rcp_f32 v10, v10
  v_rcp_f32 v18, v18
  v_pk_mul_f32 v[20:21], v[20:21], v[8:9] op_sel_hi:[1,0]
  v_pk_mul_f32 v[36:37], v[36:37], v[16:17] op_sel_hi:[1,0]
  v_pk_mul_f32 v[192:193], v[192:193], v[10:11] op_sel_hi:[1,0]
  v_pk_mul_f32 v[208:209], v[208:209], v[18:19] op_sel_hi:[1,0]
  v_pk_mul_f32 v[22:23], v[22:23], v[8:9] op_sel_hi:[1,0]
  v_pk_mul_f32 v[38:39], v[38:39], v[16:17] op_sel_hi:[1,0]
  v_pk_mul_f32 v[194:195], v[194:195], v[10:11] op_sel_hi:[1,0]
  v_pk_mul_f32 v[210:211], v[210:211], v[18:19] op_sel_hi:[1,0]
  v_pk_mul_f32 v[24:25], v[24:25], v[8:9] op_sel_hi:[1,0]
  v_pk_mul_f32 v[40:41], v[40:41], v[16:17] op_sel_hi:[1,0]
  v_pk_mul_f32 v[196:197], v[196:197], v[10:11] op_sel_hi:[1,0]
  v_pk_mul_f32 v[212:213], v[212:213], v[18:19] op_sel_hi:[1,0]
  v_pk_mul_f32 v[26:27], v[26:27], v[8:9] op_sel_hi:[1,0]
  v_pk_mul_f32 v[42:43], v[42:43], v[16:17] op_sel_hi:[1,0]
  v_pk_mul_f32 v[198:199], v[198:199], v[10:11] op_sel_hi:[1,0]
  v_pk_mul_f32 v[214:215], v[214:215], v[18:19] op_sel_hi:[1,0]
  buffer_store_dwordx4 v[180:183], v3, s[48:51], s10 offen offset:3072 sc0 sc1
  s_add_u32 s9, s9, 4096
  s_add_u32 s10, s10, 4096
  v_pk_mul_f32 v[28:29], v[28:29], v[8:9] op_sel_hi:[1,0]
  v_pk_mul_f32 v[44:45], v[44:45], v[16:17] op_sel_hi:[1,0]
  v_pk_mul_f32 v[200:201], v[200:201], v[10:11] op_sel_hi:[1,0]
  v_pk_mul_f32 v[216:217], v[216:217], v[18:19] op_sel_hi:[1,0]
  v_pk_mul_f32 v[30:31], v[30:31], v[8:9] op_sel_hi:[1,0]
  v_pk_mul_f32 v[46:47], v[46:47], v[16:17] op_sel_hi:[1,0]
  v_pk_mul_f32 v[202:203], v[202:203], v[10:11] op_sel_hi:[1,0]
  v_pk_mul_f32 v[218:219], v[218:219], v[18:19] op_sel_hi:[1,0]
  v_pk_mul_f32 v[32:33], v[32:33], v[8:9] op_sel_hi:[1,0]
  v_pk_mul_f32 v[48:49], v[48:49], v[16:17] op_sel_hi:[1,0]
  v_pk_mul_f32 v[204:205], v[204:205], v[10:11] op_sel_hi:[1,0]
  v_pk_mul_f32 v[220:221], v[220:221], v[18:19] op_sel_hi:[1,0]
  v_pk_mul_f32 v[34:35], v[34:35], v[8:9] op_sel_hi:[1,0]
  v_pk_mul_f32 v[50:51], v[50:51], v[16:17] op_sel_hi:[1,0]
  v_pk_mul_f32 v[206:207], v[206:207], v[10:11] op_sel_hi:[1,0]
  v_pk_mul_f32 v[222:223], v[222:223], v[18:19] op_sel_hi:[1,0]
  v_cvt_pk_bf16_f32 v20, v20, v21
  v_cvt_pk_bf16_f32 v36, v36, v37
  v_cvt_pk_bf16_f32 v192, v192, v193
  s_cbranch_execz K1W_q_ret
K1W_phi_3:
  v_cvt_pk_bf16_f32 v208, v208, v209
  v_cvt_pk_bf16_f32 v21, v22, v23
  v_cvt_pk_bf16_f32 v37, v38, v39
  v_cvt_pk_bf16_f32 v193, v194, v195
  v_cvt_pk_bf16_f32 v209, v210, v211
  v_cvt_pk_bf16_f32 v22, v24, v25
  v_cvt_pk_bf16_f32 v38, v40, v41
  v_cvt_pk_bf16_f32 v194, v196, v197
  v_cvt_pk_bf16_f32 v210, v212, v213
  v_cvt_pk_bf16_f32 v23, v26, v27
  v_cvt_pk_bf16_f32 v39, v42, v43
  v_cvt_pk_bf16_f32 v195, v198, v199
  v_cvt_pk_bf16_f32 v211, v214, v215
  v_cvt_pk_bf16_f32 v24, v28, v29
  v_cvt_pk_bf16_f32 v40, v44, v45
  v_cvt_pk_bf16_f32 v196, v200, v201
  v_cvt_pk_bf16_f32 v212, v216, v217
  v_cvt_pk_bf16_f32 v25, v30, v31
  v_cvt_pk_bf16_f32 v41, v46, v47
  v_cvt_pk_bf16_f32 v197, v202, v203
  v_cvt_pk_bf16_f32 v213, v218, v219
  v_cvt_pk_bf16_f32 v26, v32, v33
  v_cvt_pk_bf16_f32 v42, v48, v49
  v_cvt_pk_bf16_f32 v198, v204, v205
  v_cvt_pk_bf16_f32 v214, v220, v221
  v_cvt_pk_bf16_f32 v27, v34, v35
  v_cvt_pk_bf16_f32 v43, v50, v51
  v_cvt_pk_bf16_f32 v199, v206, v207
  v_cvt_pk_bf16_f32 v215, v222, v223
  v_max3_f32 v4, v224, v225, v226
  v_max3_f32 v12, v240, v241, v242
  v_min3_f32 v5, v224, v225, v226
  v_min3_f32 v13, v240, v241, v242
  v_max3_f32 v4, v4, v227, v228
  v_max3_f32 v12, v12, v243, v244
  v_min3_f32 v5, v5, v227, v228
  v_min3_f32 v13, v13, v243, v244
  v_max3_f32 v4, v4, v229, v230
  v_max3_f32 v12, v12, v245, v246
  v_min3_f32 v5, v5, v229, v230
  v_min3_f32 v13, v13, v245, v246
  buffer_store_dwordx4 v[20:23], v3, s[48:51], s9 offen offset:0 sc0 sc1
  v_max3_f32 v4, v4, v231, v232
  v_max3_f32 v12, v12, v247, v248
  v_min3_f32 v5, v5, v231, v232
  v_min3_f32 v13, v13, v247, v248
  v_max3_f32 v4, v4, v233, v234
  v_max3_f32 v12, v12, v249, v250
  v_min3_f32 v5, v5, v233, v234
  v_min3_f32 v13, v13, v249, v250
  v_max3_f32 v4, v4, v235, v236
  v_max3_f32 v12, v12, v251, v252
  v_min3_f32 v5, v5, v235, v236
  v_min3_f32 v13, v13, v251, v252
  v_max3_f32 v4, v4, v237, v238
  v_max3_f32 v12, v12, v253, v254
  v_min3_f32 v5, v5, v237, v238
  v_min3_f32 v13, v13, v253, v254
  v_max_f32 v4, v4, v239
  v_max_f32 v12, v12, v255
  v_min_f32 v5, v5, v239
  v_min_f32 v13, v13, v255
  v_mov_b32 v6, v4
  v_mov_b32 v14, v12
  v_mov_b32 v7, v5
  v_mov_b32 v15, v13
  v_permlane32_swap_b32 v4, v6
  v_permlane32_swap_b32 v12, v14
  v_permlane32_swap_b32 v5, v7
  v_permlane32_swap_b32 v13, v15
  buffer_store_dwordx4 v[36:39], v3, s[48:51], s10 offen offset:0 sc0 sc1
  v_max_f32 v4, v4, v6
  v_max_f32 v12, v12, v14
  v_min_f32 v5, v5, v7
  v_min_f32 v13, v13, v15
  v_mul_f32 v6, s64, v4
  v_mul_f32 v14, s64, v12
  v_mul_f32 v4, s64, v5
  v_mul_f32 v12, s64, v13
  v_pk_fma_f32 v[52:53], v[224:225], s[64:65], v[6:7] op_sel_hi:[1,0,0] neg_lo:[0,0,1] neg_hi:[0,0,1]
  v_pk_fma_f32 v[68:69], v[240:241], s[64:65], v[14:15] op_sel_hi:[1,0,0] neg_lo:[0,0,1] neg_hi:[0,0,1]
  v_pk_fma_f32 v[224:225], v[224:225], s[64:65], v[4:5] op_sel_hi:[1,0,0] neg_lo:[1,0,0] neg_hi:[1,0,0]
  v_pk_fma_f32 v[240:241], v[240:241], s[64:65], v[12:13] op_sel_hi:[1,0,0] neg_lo:[1,0,0] neg_hi:[1,0,0]
  v_pk_fma_f32 v[54:55], v[226:227], s[64:65], v[6:7] op_sel_hi:[1,0,0] neg_lo:[0,0,1] neg_hi:[0,0,1]
  v_pk_fma_f32 v[70:71], v[242:243], s[64:65], v[14:15] op_sel_hi:[1,0,0] neg_lo:[0,0,1] neg_hi:[0,0,1]
  v_pk_fma_f32 v[226:227], v[226:227], s[64:65], v[4:5] op_sel_hi:[1,0,0] neg_lo:[1,0,0] neg_hi:[1,0,0]
  v_pk_fma_f32 v[242:243], v[242:243], s[64:65], v[12:13] op_sel_hi:[1,0,0] neg_lo:[1,0,0] neg_hi:[1,0,0]
  v_pk_fma_f32 v[56:57], v[228:229], s[64:65], v[6:7] op_sel_hi:[1,0,0] neg_lo:[0,0,1] neg_hi:[0,0,1]
  v_pk_fma_f32 v[72:73], v[244:245], s[64:65], v[14:15] op_sel_hi:[1,0,0] neg_lo:[0,0,1] neg_hi:[0,0,1]
  v_pk_fma_f32 v[228:229], v[228:229], s[64:65], v[4:5] op_sel_hi:[1,0,0] neg_lo:[1,0,0] neg_hi:[1,0,0]
  v_pk_fma_f32 v[244:245], v[244:245], s[64:65], v[12:13] op_sel_hi:[1,0,0] neg_lo:[1,0,0] neg_hi:[1,0,0]
  v_pk_fma_f32 v[58:59], v[230:231], s[64:65], v[6:7] op_sel_hi:[1,0,0] neg_lo:[0,0,1] neg_hi:[0,0,1]
  v_pk_fma_f32 v[74:75], v[246:247], s[64:65], v[14:15] op_sel_hi:[1,0,0] neg_lo:[0,0,1] neg_hi:[0,0,1]
  v_pk_fma_f32 v[230:231], v[230:231], s[64:65], v[4:5] op_sel_hi:[1,0,0] neg_lo:[1,0,0] neg_hi:[1,0,0]
  v_pk_fma_f32 v[246:247], v[246:247], s[64:65], v[12:13] op_sel_hi:[1,0,0] neg_lo:[1,0,0] neg_hi:[1,0,0]
  v_pk_fma_f32 v[60:61], v[232:233], s[64:65], v[6:7] op_sel_hi:[1,0,0] neg_lo:[0,0,1] neg_hi:[0,0,1]
  v_pk_fma_f32 v[76:77], v[248:249], s[64:65], v[14:15] op_sel_hi:[1,0,0] neg_lo:[0,0,1] neg_hi:[0,0,1]
  v_pk_fma_f32 v[232:233], v[232:233], s[64:65], v[4:5] op_sel_hi:[1,0,0] neg_lo:[1,0,0] neg_hi:[1,0,0]
  v_pk_fma_f32 v[248:249], v[248:249], s[64:65], v[12:13] op_sel_hi:[1,0,0] neg_lo:[1,0,0] neg_hi:[1,0,0]
  buffer_store_dwordx4 v[24:27], v3, s[48:51], s9 offen offset:1024 sc0 sc1
  v_pk_fma_f32 v[62:63], v[234:235], s[64:65], v[6:7] op_sel_hi:[1,0,0] neg_lo:[0,0,1] neg_hi:[0,0,1]
  v_pk_fma_f32 v[78:79], v[250:251], s[64:65], v[14:15] op_sel_hi:[1,0,0] neg_lo:[0,0,1] neg_hi:[0,0,1]
  v_pk_fma_f32 v[234:235], v[234:235], s[64:65], v[4:5] op_sel_hi:[1,0,0] neg_lo:[1,0,0] neg_hi:[1,0,0]
  v_pk_fma_f32 v[250:251], v[250:251], s[64:65], v[12:13] op_sel_hi:[1,0,0] neg_lo:[1,0,0] neg_hi:[1,0,0]
  v_pk_fma_f32 v[64:65], v[236:237], s[64:65], v[6:7] op_sel_hi:[1,0,0] neg_lo:[0,0,1] neg_hi:[0,0,1]
  v_pk_fma_f32 v[80:81], v[252:253], s[64:65], v[14:15] op_sel_hi:[1,0,0] neg_lo:[0,0,1] neg_hi:[0,0,1]
  v_pk_fma_f32 v[236:237], v[236:237], s[64:65], v[4:5] op_sel_hi:[1,0,0] neg_lo:[1,0,0] neg_hi:[1,0,0]
  v_pk_fma_f32 v[252:253], v[252:253], s[64:65], v[12:13] op_sel_hi:[1,0,0] neg_lo:[1,0,0] neg_hi:[1,0,0]
  v_pk_fma_f32 v[66:67], v[238:239], s[64:65], v[6:7] op_sel_hi:[1,0,0] neg_lo:[0,0,1] neg_hi:[0,0,1]
  v_pk_fma_f32 v[82:83], v[254:255], s[64:65], v[14:15] op_sel_hi:[1,0,0] neg_lo:[0,0,1] neg_hi:[0,0,1]
  v_pk_fma_f32 v[238:239], v[238:239], s[64:65], v[4:5] op_sel_hi:[1,0,0] neg_lo:[1,0,0] neg_hi:[1,0,0]
  v_pk_fma_f32 v[254:255], v[254:255], s[64:65], v[12:13] op_sel_hi:[1,0,0] neg_lo:[1,0,0] neg_hi:[1,0,0]
  v_exp_f32 v52, v52
  v_exp_f32 v68, v68
  v_exp_f32 v224, v224
  v_exp_f32 v240, v240
  v_exp_f32 v53, v53
  v_exp_f32 v69, v69
  v_exp_f32 v225, v225
  v_exp_f32 v241, v241
  v_exp_f32 v54, v54
  v_exp_f32 v70, v70
  v_exp_f32 v226, v226
  v_exp_f32 v242, v242
  v_exp_f32 v55, v55
  v_exp_f32 v71, v71
  v_exp_f32 v227, v227
  v_exp_f32 v243, v243
  buffer_store_dwordx4 v[40:43], v3, s[48:51], s10 offen offset:1024 sc0 sc1
  v_exp_f32 v56, v56
  v_exp_f32 v72, v72
  v_exp_f32 v228, v228
  v_exp_f32 v244, v244
  v_exp_f32 v57, v57
  v_exp_f32 v73, v73
  v_exp_f32 v229, v229
  v_exp_f32 v245, v245
  v_exp_f32 v58, v58
  v_exp_f32 v74, v74
  v_exp_f32 v230, v230
  v_exp_f32 v246, v246
  v_exp_f32 v59, v59
  v_exp_f32 v75, v75
  v_exp_f32 v231, v231
  v_exp_f32 v247, v247
  v_exp_f32 v60, v60
  v_exp_f32 v76, v76
  v_exp_f32 v232, v232
  v_exp_f32 v248, v248
  v_exp_f32 v61, v61
  v_exp_f32 v77, v77
  v_exp_f32 v233, v233
  v_exp_f32 v249, v249
  v_exp_f32 v62, v62
  v_exp_f32 v78, v78
  v_exp_f32 v234, v234
  v_exp_f32 v250, v250
  buffer_store_dwordx4 v[192:195], v3, s[48:51], s9 offen offset:2048 sc0 sc1
  v_exp_f32 v63, v63
  v_exp_f32 v79, v79
  v_exp_f32 v235, v235
  v_exp_f32 v251, v251
  v_exp_f32 v64, v64
  v_exp_f32 v80, v80
  v_exp_f32 v236, v236
  v_exp_f32 v252, v252
  v_exp_f32 v65, v65
  v_exp_f32 v81, v81
  v_exp_f32 v237, v237
  v_exp_f32 v253, v253
  v_exp_f32 v66, v66
  v_exp_f32 v82, v82
  v_exp_f32 v238, v238
  v_exp_f32 v254, v254
  v_exp_f32 v67, v67
  v_exp_f32 v83, v83
  v_exp_f32 v239, v239
  v_exp_f32 v255, v255
  v_pk_add_f32 v[8:9], v[52:53], v[54:55]
  v_pk_add_f32 v[16:17], v[68:69], v[70:71]
  v_pk_add_f32 v[10:11], v[224:225], v[226:227]
  v_pk_add_f32 v[18:19], v[240:241], v[242:243]
  v_pk_add_f32 v[8:9], v[8:9], v[56:57]
  v_pk_add_f32 v[16:17], v[16:17], v[72:73]
  v_pk_add_f32 v[10:11], v[10:11], v[228:229]
  v_pk_add_f32 v[18:19], v[18:19], v[244:245]
  buffer_store_dwordx4 v[208:211], v3, s[48:51], s10 offen offset:2048 sc0 sc1
  v_pk_add_f32 v[8:9], v[8:9], v[58:59]
  v_pk_add_f32 v[16:17], v[16:17], v[74:75]
  v_pk_add_f32 v[10:11], v[10:11], v[230:231]
  v_pk_add_f32 v[18:19], v[18:19], v[246:247]
  v_pk_add_f32 v[8:9], v[8:9], v[60:61]
  v_pk_add_f32 v[16:17], v[16:17], v[76:77]
  v_pk_add_f32 v[10:11], v[10:11], v[232:233]
  v_pk_add_f32 v[18:19], v[18:19], v[248:249]
  v_pk_add_f32 v[8:9], v[8:9], v[62:63]
  v_pk_add_f32 v[16:17], v[16:17], v[78:79]
  v_pk_add_f32 v[10:11], v[10:11], v[234:235]
  v_pk_add_f32 v[18:19], v[18:19], v[250:251]
  v_pk_add_f32 v[8:9], v[8:9], v[64:65]
  v_pk_add_f32 v[16:17], v[16:17], v[80:81]
  v_pk_add_f32 v[10:11], v[10:11], v[236:237]
  v_pk_add_f32 v[18:19], v[18:19], v[252:253]
  v_pk_add_f32 v[8:9], v[8:9], v[66:67]
  v_pk_add_f32 v[16:17], v[16:17], v[82:83]
  v_pk_add_f32 v[10:11], v[10:11], v[238:239]
  v_pk_add_f32 v[18:19], v[18:19], v[254:255]
  v_add_f32 v8, v8, v9
  v_add_f32 v16, v16, v17
  v_add_f32 v10, v10, v11
  v_add_f32 v18, v18, v19
  v_mov_b32 v9, v8
  v_mov_b32 v17, v16
  v_mov_b32 v11, v10
  v_mov_b32 v19, v18
  buffer_store_dwordx4 v[196:199], v3, s[48:51], s9 offen offset:3072 sc0 sc1
  v_permlane32_swap_b32 v8, v9
  v_permlane32_swap_b32 v16, v17
  v_permlane32_swap_b32 v10, v11
  v_permlane32_swap_b32 v18, v19
  v_add_f32 v8, v8, v9
  v_add_f32 v16, v16, v17
  v_add_f32 v10, v10, v11
  v_add_f32 v18, v18, v19
  v_rcp_f32 v8, v8
  v_rcp_f32 v16, v16
  v_rcp_f32 v10, v10
  v_rcp_f32 v18, v18
  v_pk_mul_f32 v[52:53], v[52:53], v[8:9] op_sel_hi:[1,0]
  v_pk_mul_f32 v[68:69], v[68:69], v[16:17] op_sel_hi:[1,0]
  v_pk_mul_f32 v[224:225], v[224:225], v[10:11] op_sel_hi:[1,0]
  v_pk_mul_f32 v[240:241], v[240:241], v[18:19] op_sel_hi:[1,0]
  v_pk_mul_f32 v[54:55], v[54:55], v[8:9] op_sel_hi:[1,0]
  v_pk_mul_f32 v[70:71], v[70:71], v[16:17] op_sel_hi:[1,0]
  v_pk_mul_f32 v[226:227], v[226:227], v[10:11] op_sel_hi:[1,0]
  v_pk_mul_f32 v[242:243], v[242:243], v[18:19] op_sel_hi:[1,0]
  v_pk_mul_f32 v[56:57], v[56:57], v[8:9] op_sel_hi:[1,0]
  v_pk_mul_f32 v[72:73], v[72:73], v[16:17] op_sel_hi:[1,0]
  v_pk_mul_f32 v[228:229], v[228:229], v[10:11] op_sel_hi:[1,0]
  v_pk_mul_f32 v[244:245], v[244:245], v[18:19] op_sel_hi:[1,0]
  v_pk_mul_f32 v[58:59], v[58:59], v[8:9] op_sel_hi:[1,0]
  v_pk_mul_f32 v[74:75], v[74:75], v[16:17] op_sel_hi:[1,0]
  v_pk_mul_f32 v[230:231], v[230:231], v[10:11] op_sel_hi:[1,0]
  v_pk_mul_f32 v[246:247], v[246:247], v[18:19] op_sel_hi:[1,0]
  buffer_store_dwordx4 v[212:215], v3, s[48:51], s10 offen offset:3072 sc0 sc1
  s_add_u32 s9, s9, 4096
  s_add_u32 s10, s10, 4096
  v_pk_mul_f32 v[60:61], v[60:61], v[8:9] op_sel_hi:[1,0]
  v_pk_mul_f32 v[76:77], v[76:77], v[16:17] op_sel_hi:[1,0]
  v_pk_mul_f32 v[232:233], v[232:233], v[10:11] op_sel_hi:[1,0]
  v_pk_mul_f32 v[248:249], v[248:249], v[18:19] op_sel_hi:[1,0]
  v_pk_mul_f32 v[62:63], v[62:63], v[8:9] op_sel_hi:[1,0]
  v_pk_mul_f32 v[78:79], v[78:79], v[16:17] op_sel_hi:[1,0]
  v_pk_mul_f32 v[234:235], v[234:235], v[10:11] op_sel_hi:[1,0]
  v_pk_mul_f32 v[250:251], v[250:251], v[18:19] op_sel_hi:[1,0]
  v_pk_mul_f32 v[64:65], v[64:65], v[8:9] op_sel_hi:[1,0]
  v_pk_mul_f32 v[80:81], v[80:81], v[16:17] op_sel_hi:[1,0]
  v_pk_mul_f32 v[236:237], v[236:237], v[10:11] op_sel_hi:[1,0]
  v_pk_mul_f32 v[252:253], v[252:253], v[18:19] op_sel_hi:[1,0]
  v_pk_mul_f32 v[66:67], v[66:67], v[8:9] op_sel_hi:[1,0]
  v_pk_mul_f32 v[82:83], v[82:83], v[16:17] op_sel_hi:[1,0]
  v_pk_mul_f32 v[238:239], v[238:239], v[10:11] op_sel_hi:[1,0]
  v_pk_mul_f32 v[254:255], v[254:255], v[18:19] op_sel_hi:[1,0]
  v_cvt_pk_bf16_f32 v52, v52, v53
  v_cvt_pk_bf16_f32 v68, v68, v69
  v_cvt_pk_bf16_f32 v224, v224, v225
  v_cvt_pk_bf16_f32 v240, v240, v241
  v_cvt_pk_bf16_f32 v53, v54, v55
  v_cvt_pk_bf16_f32 v69, v70, v71
  v_cvt_pk_bf16_f32 v225, v226, v227
  v_cvt_pk_bf16_f32 v241, v242, v243
  v_cvt_pk_bf16_f32 v54, v56, v57
  v_cvt_pk_bf16_f32 v70, v72, v73
  v_cvt_pk_bf16_f32 v226, v228, v229
  v_cvt_pk_bf16_f32 v242, v244, v245
  v_cvt_pk_bf16_f32 v55, v58, v59
  v_cvt_pk_bf16_f32 v71, v74, v75
  v_cvt_pk_bf16_f32 v227, v230, v231
  v_cvt_pk_bf16_f32 v243, v246, v247
  v_cvt_pk_bf16_f32 v56, v60, v61
  v_cvt_pk_bf16_f32 v72, v76, v77
  v_cvt_pk_bf16_f32 v228, v232, v233
  v_cvt_pk_bf16_f32 v244, v248, v249
  v_cvt_pk_bf16_f32 v57, v62, v63
  v_cvt_pk_bf16_f32 v73, v78, v79
  v_cvt_pk_bf16_f32 v229, v234, v235
  v_cvt_pk_bf16_f32 v245, v250, v251
  v_cvt_pk_bf16_f32 v58, v64, v65
  v_cvt_pk_bf16_f32 v74, v80, v81
  v_cvt_pk_bf16_f32 v230, v236, v237
  v_cvt_pk_bf16_f32 v246, v252, v253
  v_cvt_pk_bf16_f32 v59, v66, v67
  v_cvt_pk_bf16_f32 v75, v82, v83
  v_cvt_pk_bf16_f32 v231, v238, v239
  v_cvt_pk_bf16_f32 v247, v254, v255
  buffer_store_dwordx4 v[52:55], v3, s[48:51], s9 offen offset:0 sc0 sc1
  buffer_store_dwordx4 v[68:71], v3, s[48:51], s10 offen offset:0 sc0 sc1
  buffer_store_dwordx4 v[56:59], v3, s[48:51], s9 offen offset:1024 sc0 sc1
  buffer_store_dwordx4 v[72:75], v3, s[48:51], s10 offen offset:1024 sc0 sc1
  buffer_store_dwordx4 v[224:227], v3, s[48:51], s9 offen offset:2048 sc0 sc1
  buffer_store_dwordx4 v[240:243], v3, s[48:51], s10 offen offset:2048 sc0 sc1
  buffer_store_dwordx4 v[228:231], v3, s[48:51], s9 offen offset:3072 sc0 sc1
  buffer_store_dwordx4 v[244:247], v3, s[48:51], s10 offen offset:3072 sc0 sc1
  s_cbranch_execz K1W_q_ret
  s_endpgm
K1_kv:
  v_mov_b32 v3, 0
  v_mov_b32 v4, 0
  v_mov_b32 v7, 0
  v_mov_b32 v9, 0
  v_mov_b32 v43, 0
  v_mov_b32 v44, 0
  s_mov_b32 s63, 0
  s_mov_b64 exec, 0
  s_and_b32 s9, s5, 3
  s_cmp_eq_u32 s9, 1
  s_cbranch_scc1 K1W_kv_1
  s_and_b32 s9, s5, 3
  s_cmp_eq_u32 s9, 2
  s_cbranch_scc1 K1W_kv_2
  s_and_b32 s9, s5, 3
  s_cmp_eq_u32 s9, 3
  s_cbranch_scc1 K1W_kv_3
  s_branch K1W_kv_0
K1W_kv_ret:
  s_mov_b64 exec, -1
  v_and_b32 v28, 15, v2
  v_lshrrev_b32 v29, 4, v2
  s_lshl_b32 s9, s12, 14
  v_lshlrev_b32 v24, 7, v28
  v_add_u32 v24, s9, v24
  v_lshrrev_b32 v25, 1, v28
  v_xor_b32 v25, v25, v29
  v_xor_b32 v26, 0, v25
  v_lshl_add_u32 v4, v26, 4, v24
  v_add_u32 v6, 0x8000, v4
  v_add_u32 v8, 0x10000, v4
  v_xor_b32 v26, 4, v25
  v_lshl_add_u32 v5, v26, 4, v24
  v_add_u32 v7, 0x8000, v5
  v_add_u32 v9, 0x10000, v5
  v_bfe_u32 v24, v2, 2, 2
  v_lshl_add_u32 v25, v29, 3, v24
  v_and_b32 v26, 1, v29
  v_lshl_add_u32 v24, v26, 2, v24
  v_and_b32 v27, 3, v2
  v_lshlrev_b32 v27, 3, v27
  v_lshl_add_u32 v25, v25, 8, v27
  v_add_u32 v25, 98304, v25
  s_lshl_b32 s9, s13, 2
  v_xor_b32 v24, s9, v24
  v_xor_b32 v26, 0, v24
  v_lshl_add_u32 v16, v26, 5, v25
  v_xor_b32 v26, 1, v24
  v_lshl_add_u32 v17, v26, 5, v25
  v_xor_b32 v26, 2, v24
  v_lshl_add_u32 v18, v26, 5, v25
  v_xor_b32 v26, 3, v24
  v_lshl_add_u32 v19, v26, 5, v25
  v_mov_b32 v128, 0
  v_mov_b32 v129, 0
  v_mov_b32 v130, 0
  v_mov_b32 v131, 0
  v_mov_b32 v132, 0
  v_mov_b32 v133, 0
  v_mov_b32 v134, 0
  v_mov_b32 v135, 0
  v_mov_b32 v136, 0
  v_mov_b32 v137, 0
  v_mov_b32 v138, 0
  v_mov_b32 v139, 0
  v_mov_b32 v140, 0
  v_mov_b32 v141, 0
  v_mov_b32 v142, 0
  v_mov_b32 v143, 0
  v_mov_b32 v144, 0
  v_mov_b32 v145, 0
  v_mov_b32 v146, 0
  v_mov_b32 v147, 0
  v_mov_b32 v148, 0
  v_mov_b32 v149, 0
  v_mov_b32 v150, 0
  v_mov_b32 v151, 0
  v_mov_b32 v152, 0
  v_mov_b32 v153, 0
  v_mov_b32 v154, 0
  v_mov_b32 v155, 0
  v_mov_b32 v156, 0
  v_mov_b32 v157, 0
  v_mov_b32 v158, 0
  v_mov_b32 v159, 0
  v_mov_b32 v160, 0
  v_mov_b32 v161, 0
  v_mov_b32 v162, 0
  v_mov_b32 v163, 0
  v_mov_b32 v164, 0
  v_mov_b32 v165, 0
  v_mov_b32 v166, 0
  v_mov_b32 v167, 0
  v_mov_b32 v168, 0
  v_mov_b32 v169, 0
  v_mov_b32 v170, 0
  v_mov_b32 v171, 0
  v_mov_b32 v172, 0
  v_mov_b32 v173, 0
  v_mov_b32 v174, 0
  v_mov_b32 v175, 0
  v_mov_b32 v176, 0
  v_mov_b32 v177, 0
  v_mov_b32 v178, 0
  v_mov_b32 v179, 0
  v_mov_b32 v180, 0
  v_mov_b32 v181, 0
  v_mov_b32 v182, 0
  v_mov_b32 v183, 0
  v_mov_b32 v184, 0
  v_mov_b32 v185, 0
  v_mov_b32 v186, 0
  v_mov_b32 v187, 0
  v_mov_b32 v188, 0
  v_mov_b32 v189, 0
  v_mov_b32 v190, 0
  v_mov_b32 v191, 0
  v_mov_b32 v192, 0
  v_mov_b32 v193, 0
  v_mov_b32 v194, 0
  v_mov_b32 v195, 0
  v_mov_b32 v196, 0
  v_mov_b32 v197, 0
  v_mov_b32 v198, 0
  v_mov_b32 v199, 0
  v_mov_b32 v200, 0
  v_mov_b32 v201, 0
  v_mov_b32 v202, 0
  v_mov_b32 v203, 0
  v_mov_b32 v204, 0
  v_mov_b32 v205, 0
  v_mov_b32 v206, 0
  v_mov_b32 v207, 0
  v_mov_b32 v208, 0
  v_mov_b32 v209, 0
  v_mov_b32 v210, 0
  v_mov_b32 v211, 0
  v_mov_b32 v212, 0
  v_mov_b32 v213, 0
  v_mov_b32 v214, 0
  v_mov_b32 v215, 0
  v_mov_b32 v216, 0
  v_mov_b32 v217, 0
  v_mov_b32 v218, 0
  v_mov_b32 v219, 0
  v_mov_b32 v220, 0
  v_mov_b32 v221, 0
  v_mov_b32 v222, 0
  v_mov_b32 v223, 0
  v_mov_b32 v224, 0
  v_mov_b32 v225, 0
  v_mov_b32 v226, 0
  v_mov_b32 v227, 0
  v_mov_b32 v228, 0
  v_mov_b32 v229, 0
  v_mov_b32 v230, 0
  v_mov_b32 v231, 0
  v_mov_b32 v232, 0
  v_mov_b32 v233, 0
  v_mov_b32 v234, 0
  v_mov_b32 v235, 0
  v_mov_b32 v236, 0
  v_mov_b32 v237, 0
  v_mov_b32 v238, 0
  v_mov_b32 v239, 0
  v_mov_b32 v240, 0
  v_mov_b32 v241, 0
  v_mov_b32 v242, 0
  v_mov_b32 v243, 0
  v_mov_b32 v244, 0
  v_mov_b32 v245, 0
  v_mov_b32 v246, 0
  v_mov_b32 v247, 0
  v_mov_b32 v248, 0
  v_mov_b32 v249, 0
  v_mov_b32 v250, 0
  v_mov_b32 v251, 0
  v_mov_b32 v252, 0
  v_mov_b32 v253, 0
  v_mov_b32 v254, 0
  v_mov_b32 v255, 0
  s_barrier
  ds_read_b128 v[24:27], v4 offset:0
  ds_read_b128 v[28:31], v4 offset:2048
  ds_read_b64_tr_b16 v[56:57], v16 offset:0
  ds_read_b64_tr_b16 v[58:59], v16 offset:1024
  ds_read_b64_tr_b16 v[60:61], v17 offset:0
  ds_read_b128 v[32:35], v4 offset:4096
  ds_read_b64_tr_b16 v[62:63], v17 offset:1024
  ds_read_b64_tr_b16 v[64:65], v18 offset:0
  ds_read_b64_tr_b16 v[66:67], v18 offset:1024
  ds_read_b128 v[36:39], v4 offset:6144
  ds_read_b64_tr_b16 v[68:69], v19 offset:0
  ds_read_b64_tr_b16 v[70:71], v19 offset:1024
  ds_read_b128 v[40:43], v4 offset:8192
  ds_read_b128 v[44:47], v4 offset:10240
  ds_read_b128 v[48:51], v4 offset:12288
  ds_read_b128 v[52:55], v4 offset:14336
  s_mov_b32 s11, 5
.p2align 6
K1C_21:
  s_cmp_lg_u32 s23, s21
  s_cbranch_scc1 K1XS_22
  buffer_load_dword v0, v1, s[16:19], s20 offen
  s_add_u32 s20, s20, s22
  s_add_u32 s21, s21, 8
  s_cmp_ge_u32 s21, 11
  s_cselect_b32 s21, -1, s21
K1XS_22:
  s_add_u32 s23, s23, 1
  s_waitcnt lgkmcnt(12)
  v_mfma_f32_16x16x32_bf16 v[128:131], v[56:59], v[24:27], v[128:131]
  ds_read_b64_tr_b16 v[72:73], v16 offset:8192
  s_waitcnt lgkmcnt(10)
  v_mfma_f32_16x16x32_bf16 v[132:135], v[60:63], v[24:27], v[132:135]
  ds_read_b64_tr_b16 v[74:75], v16 offset:9216
  s_waitcnt lgkmcnt(9)
  v_mfma_f32_16x16x32_bf16 v[136:139], v[24:27], v[64:67], v[136:139]
  ds_read_b64_tr_b16 v[76:77], v17 offset:8192
  s_waitcnt lgkmcnt(7)
  v_mfma_f32_16x16x32_bf16 v[140:143], v[24:27], v[68:71], v[140:143]
  ds_read_b128 v[24:27], v5 offset:0
  v_mfma_f32_16x16x32_bf16 v[144:147], v[56:59], v[28:31], v[144:147]
  ds_read_b64_tr_b16 v[78:79], v17 offset:9216
  v_mfma_f32_16x16x32_bf16 v[148:151], v[60:63], v[28:31], v[148:151]
  ds_read_b64_tr_b16 v[80:81], v18 offset:8192
  v_mfma_f32_16x16x32_bf16 v[152:155], v[28:31], v[64:67], v[152:155]
  ds_read_b64_tr_b16 v[82:83], v18 offset:9216
  v_mfma_f32_16x16x32_bf16 v[156:159], v[28:31], v[68:71], v[156:159]
  ds_read_b128 v[28:31], v5 offset:2048
  v_mfma_f32_16x16x32_bf16 v[160:163], v[56:59], v[32:35], v[160:163]
  ds_read_b64_tr_b16 v[84:85], v19 offset:8192
  v_mfma_f32_16x16x32_bf16 v[164:167], v[60:63], v[32:35], v[164:167]
  ds_read_b64_tr_b16 v[86:87], v19 offset:9216
  v_mfma_f32_16x16x32_bf16 v[168:171], v[32:35], v[64:67], v[168:171]
  v_mfma_f32_16x16x32_bf16 v[172:175], v[32:35], v[68:71], v[172:175]
  ds_read_b128 v[32:35], v5 offset:4096
  v_mfma_f32_16x16x32_bf16 v[176:179], v[56:59], v[36:39], v[176:179]
  v_mfma_f32_16x16x32_bf16 v[180:183], v[60:63], v[36:39], v[180:183]
  v_mfma_f32_16x16x32_bf16 v[184:187], v[36:39], v[64:67], v[184:187]
  v_mfma_f32_16x16x32_bf16 v[188:191], v[36:39], v[68:71], v[188:191]
  ds_read_b128 v[36:39], v5 offset:6144
  s_waitcnt lgkmcnt(15)
  v_mfma_f32_16x16x32_bf16 v[192:195], v[56:59], v[40:43], v[192:195]
  v_mfma_f32_16x16x32_bf16 v[196:199], v[60:63], v[40:43], v[196:199]
  v_mfma_f32_16x16x32_bf16 v[200:203], v[40:43], v[64:67], v[200:203]
  v_mfma_f32_16x16x32_bf16 v[204:207], v[40:43], v[68:71], v[204:207]
  ds_read_b128 v[40:43], v5 offset:8192
  s_waitcnt lgkmcnt(15)
  v_mfma_f32_16x16x32_bf16 v[208:211], v[56:59], v[44:47], v[208:211]
  v_mfma_f32_16x16x32_bf16 v[212:215], v[60:63], v[44:47], v[212:215]
  v_mfma_f32_16x16x32_bf16 v[216:219], v[44:47], v[64:67], v[216:219]
  v_mfma_f32_16x16x32_bf16 v[220:223], v[44:47], v[68:71], v[220:223]
  ds_read_b128 v[44:47], v5 offset:10240
  s_waitcnt lgkmcnt(15)
  v_mfma_f32_16x16x32_bf16 v[224:227], v[56:59], v[48:51], v[224:227]
  v_mfma_f32_16x16x32_bf16 v[228:231], v[60:63], v[48:51], v[228:231]
  v_mfma_f32_16x16x32_bf16 v[232:235], v[48:51], v[64:67], v[232:235]
  v_mfma_f32_16x16x32_bf16 v[236:239], v[48:51], v[68:71], v[236:239]
  ds_read_b128 v[48:51], v5 offset:12288
  s_waitcnt lgkmcnt(15)
  v_mfma_f32_16x16x32_bf16 v[240:243], v[56:59], v[52:55], v[240:243]
  v_mfma_f32_16x16x32_bf16 v[244:247], v[60:63], v[52:55], v[244:247]
  v_mfma_f32_16x16x32_bf16 v[248:251], v[52:55], v[64:67], v[248:251]
  v_mfma_f32_16x16x32_bf16 v[252:255], v[52:55], v[68:71], v[252:255]
  ds_read_b128 v[52:55], v5 offset:14336
  s_waitcnt lgkmcnt(12)
  v_mfma_f32_16x16x32_bf16 v[128:131], v[72:75], v[24:27], v[128:131]
  s_waitcnt lgkmcnt(11)
  v_mfma_f32_16x16x32_bf16 v[132:135], v[76:79], v[24:27], v[132:135]
  s_waitcnt lgkmcnt(9)
  v_mfma_f32_16x16x32_bf16 v[136:139], v[24:27], v[80:83], v[136:139]
  s_waitcnt lgkmcnt(6)
  v_mfma_f32_16x16x32_bf16 v[140:143], v[24:27], v[84:87], v[140:143]
  v_mfma_f32_16x16x32_bf16 v[144:147], v[72:75], v[28:31], v[144:147]
  v_mfma_f32_16x16x32_bf16 v[148:151], v[76:79], v[28:31], v[148:151]
  s_waitcnt lgkmcnt(0)
  s_barrier
  v_mfma_f32_16x16x32_bf16 v[152:155], v[28:31], v[80:83], v[152:155]
  ds_read_b128 v[24:27], v6 offset:0
  v_mfma_f32_16x16x32_bf16 v[156:159], v[28:31], v[84:87], v[156:159]
  ds_read_b128 v[28:31], v6 offset:2048
  v_mfma_f32_16x16x32_bf16 v[160:163], v[72:75], v[32:35], v[160:163]
  ds_read_b64_tr_b16 v[56:57], v16 offset:16384
  v_mfma_f32_16x16x32_bf16 v[164:167], v[76:79], v[32:35], v[164:167]
  ds_read_b64_tr_b16 v[58:59], v16 offset:17408
  v_mfma_f32_16x16x32_bf16 v[168:171], v[32:35], v[80:83], v[168:171]
  ds_read_b64_tr_b16 v[60:61], v17 offset:16384
  v_mfma_f32_16x16x32_bf16 v[172:175], v[32:35], v[84:87], v[172:175]
  ds_read_b128 v[32:35], v6 offset:4096
  v_mfma_f32_16x16x32_bf16 v[176:179], v[72:75], v[36:39], v[176:179]
  ds_read_b64_tr_b16 v[62:63], v17 offset:17408
  v_mfma_f32_16x16x32_bf16 v[180:183], v[76:79], v[36:39], v[180:183]
  ds_read_b64_tr_b16 v[64:65], v18 offset:16384
  v_mfma_f32_16x16x32_bf16 v[184:187], v[36:39], v[80:83], v[184:187]
  ds_read_b64_tr_b16 v[66:67], v18 offset:17408
  v_mfma_f32_16x16x32_bf16 v[188:191], v[36:39], v[84:87], v[188:191]
  ds_read_b128 v[36:39], v6 offset:6144
  v_mfma_f32_16x16x32_bf16 v[192:195], v[72:75], v[40:43], v[192:195]
  ds_read_b64_tr_b16 v[68:69], v19 offset:16384
  v_mfma_f32_16x16x32_bf16 v[196:199], v[76:79], v[40:43], v[196:199]
  ds_read_b64_tr_b16 v[70:71], v19 offset:17408
  v_mfma_f32_16x16x32_bf16 v[200:203], v[40:43], v[80:83], v[200:203]
  v_mfma_f32_16x16x32_bf16 v[204:207], v[40:43], v[84:87], v[204:207]
  ds_read_b128 v[40:43], v6 offset:8192
  v_mfma_f32_16x16x32_bf16 v[208:211], v[72:75], v[44:47], v[208:211]
  v_mfma_f32_16x16x32_bf16 v[212:215], v[76:79], v[44:47], v[212:215]
  v_mfma_f32_16x16x32_bf16 v[216:219], v[44:47], v[80:83], v[216:219]
  v_mfma_f32_16x16x32_bf16 v[220:223], v[44:47], v[84:87], v[220:223]
  ds_read_b128 v[44:47], v6 offset:10240
  v_mfma_f32_16x16x32_bf16 v[224:227], v[72:75], v[48:51], v[224:227]
  v_mfma_f32_16x16x32_bf16 v[228:231], v[76:79], v[48:51], v[228:231]
  v_mfma_f32_16x16x32_bf16 v[232:235], v[48:51], v[80:83], v[232:235]
  v_mfma_f32_16x16x32_bf16 v[236:239], v[48:51], v[84:87], v[236:239]
  ds_read_b128 v[48:51], v6 offset:12288
  v_mfma_f32_16x16x32_bf16 v[240:243], v[72:75], v[52:55], v[240:243]
  v_mfma_f32_16x16x32_bf16 v[244:247], v[76:79], v[52:55], v[244:247]
  v_mfma_f32_16x16x32_bf16 v[248:251], v[52:55], v[80:83], v[248:251]
  v_mfma_f32_16x16x32_bf16 v[252:255], v[52:55], v[84:87], v[252:255]
  ds_read_b128 v[52:55], v6 offset:14336
  s_cmp_lg_u32 s23, s21
  s_cbranch_scc1 K1XS_23
  buffer_load_dword v0, v1, s[16:19], s20 offen
  s_add_u32 s20, s20, s22
  s_add_u32 s21, s21, 8
  s_cmp_ge_u32 s21, 11
  s_cselect_b32 s21, -1, s21
K1XS_23:
  s_add_u32 s23, s23, 1
  s_waitcnt lgkmcnt(12)
  v_mfma_f32_16x16x32_bf16 v[128:131], v[56:59], v[24:27], v[128:131]
  ds_read_b64_tr_b16 v[72:73], v16 offset:24576
  s_waitcnt lgkmcnt(10)
  v_mfma_f32_16x16x32_bf16 v[132:135], v[60:63], v[24:27], v[132:135]
  ds_read_b64_tr_b16 v[74:75], v16 offset:25600
  s_waitcnt lgkmcnt(9)
  v_mfma_f32_16x16x32_bf16 v[136:139], v[24:27], v[64:67], v[136:139]
  ds_read_b64_tr_b16 v[76:77], v17 offset:24576
  s_waitcnt lgkmcnt(7)
  v_mfma_f32_16x16x32_bf16 v[140:143], v[24:27], v[68:71], v[140:143]
  ds_read_b128 v[24:27], v7 offset:0
  v_mfma_f32_16x16x32_bf16 v[144:147], v[56:59], v[28:31], v[144:147]
  ds_read_b64_tr_b16 v[78:79], v17 offset:25600
  v_mfma_f32_16x16x32_bf16 v[148:151], v[60:63], v[28:31], v[148:151]
  ds_read_b64_tr_b16 v[80:81], v18 offset:24576
  v_mfma_f32_16x16x32_bf16 v[152:155], v[28:31], v[64:67], v[152:155]
  ds_read_b64_tr_b16 v[82:83], v18 offset:25600
  v_mfma_f32_16x16x32_bf16 v[156:159], v[28:31], v[68:71], v[156:159]
  ds_read_b128 v[28:31], v7 offset:2048
  v_mfma_f32_16x16x32_bf16 v[160:163], v[56:59], v[32:35], v[160:163]
  ds_read_b64_tr_b16 v[84:85], v19 offset:24576
  v_mfma_f32_16x16x32_bf16 v[164:167], v[60:63], v[32:35], v[164:167]
  ds_read_b64_tr_b16 v[86:87], v19 offset:25600
  v_mfma_f32_16x16x32_bf16 v[168:171], v[32:35], v[64:67], v[168:171]
  v_mfma_f32_16x16x32_bf16 v[172:175], v[32:35], v[68:71], v[172:175]
  ds_read_b128 v[32:35], v7 offset:4096
  v_mfma_f32_16x16x32_bf16 v[176:179], v[56:59], v[36:39], v[176:179]
  v_mfma_f32_16x16x32_bf16 v[180:183], v[60:63], v[36:39], v[180:183]
  v_mfma_f32_16x16x32_bf16 v[184:187], v[36:39], v[64:67], v[184:187]
  v_mfma_f32_16x16x32_bf16 v[188:191], v[36:39], v[68:71], v[188:191]
  ds_read_b128 v[36:39], v7 offset:6144
  s_waitcnt lgkmcnt(15)
  v_mfma_f32_16x16x32_bf16 v[192:195], v[56:59], v[40:43], v[192:195]
  v_mfma_f32_16x16x32_bf16 v[196:199], v[60:63], v[40:43], v[196:199]
  v_mfma_f32_16x16x32_bf16 v[200:203], v[40:43], v[64:67], v[200:203]
  v_mfma_f32_16x16x32_bf16 v[204:207], v[40:43], v[68:71], v[204:207]
  ds_read_b128 v[40:43], v7 offset:8192
  s_waitcnt lgkmcnt(15)
  v_mfma_f32_16x16x32_bf16 v[208:211], v[56:59], v[44:47], v[208:211]
  v_mfma_f32_16x16x32_bf16 v[212:215], v[60:63], v[44:47], v[212:215]
  v_mfma_f32_16x16x32_bf16 v[216:219], v[44:47], v[64:67], v[216:219]
  v_mfma_f32_16x16x32_bf16 v[220:223], v[44:47], v[68:71], v[220:223]
  ds_read_b128 v[44:47], v7 offset:10240
  s_waitcnt lgkmcnt(15)
  v_mfma_f32_16x16x32_bf16 v[224:227], v[56:59], v[48:51], v[224:227]
  v_mfma_f32_16x16x32_bf16 v[228:231], v[60:63], v[48:51], v[228:231]
  v_mfma_f32_16x16x32_bf16 v[232:235], v[48:51], v[64:67], v[232:235]
  v_mfma_f32_16x16x32_bf16 v[236:239], v[48:51], v[68:71], v[236:239]
  ds_read_b128 v[48:51], v7 offset:12288
  s_waitcnt lgkmcnt(15)
  v_mfma_f32_16x16x32_bf16 v[240:243], v[56:59], v[52:55], v[240:243]
  v_mfma_f32_16x16x32_bf16 v[244:247], v[60:63], v[52:55], v[244:247]
  v_mfma_f32_16x16x32_bf16 v[248:251], v[52:55], v[64:67], v[248:251]
  v_mfma_f32_16x16x32_bf16 v[252:255], v[52:55], v[68:71], v[252:255]
  ds_read_b128 v[52:55], v7 offset:14336
  s_waitcnt lgkmcnt(12)
  v_mfma_f32_16x16x32_bf16 v[128:131], v[72:75], v[24:27], v[128:131]
  s_waitcnt lgkmcnt(11)
  v_mfma_f32_16x16x32_bf16 v[132:135], v[76:79], v[24:27], v[132:135]
  s_waitcnt lgkmcnt(9)
  v_mfma_f32_16x16x32_bf16 v[136:139], v[24:27], v[80:83], v[136:139]
  s_waitcnt lgkmcnt(6)
  v_mfma_f32_16x16x32_bf16 v[140:143], v[24:27], v[84:87], v[140:143]
  v_mfma_f32_16x16x32_bf16 v[144:147], v[72:75], v[28:31], v[144:147]
  v_mfma_f32_16x16x32_bf16 v[148:151], v[76:79], v[28:31], v[148:151]
  s_waitcnt lgkmcnt(0)
  s_barrier
  v_mfma_f32_16x16x32_bf16 v[152:155], v[28:31], v[80:83], v[152:155]
  ds_read_b128 v[24:27], v8 offset:0
  v_mfma_f32_16x16x32_bf16 v[156:159], v[28:31], v[84:87], v[156:159]
  ds_read_b128 v[28:31], v8 offset:2048
  v_mfma_f32_16x16x32_bf16 v[160:163], v[72:75], v[32:35], v[160:163]
  ds_read_b64_tr_b16 v[56:57], v16 offset:32768
  v_mfma_f32_16x16x32_bf16 v[164:167], v[76:79], v[32:35], v[164:167]
  ds_read_b64_tr_b16 v[58:59], v16 offset:33792
  v_mfma_f32_16x16x32_bf16 v[168:171], v[32:35], v[80:83], v[168:171]
  ds_read_b64_tr_b16 v[60:61], v17 offset:32768
  v_mfma_f32_16x16x32_bf16 v[172:175], v[32:35], v[84:87], v[172:175]
  ds_read_b128 v[32:35], v8 offset:4096
  v_mfma_f32_16x16x32_bf16 v[176:179], v[72:75], v[36:39], v[176:179]
  ds_read_b64_tr_b16 v[62:63], v17 offset:33792
  v_mfma_f32_16x16x32_bf16 v[180:183], v[76:79], v[36:39], v[180:183]
  ds_read_b64_tr_b16 v[64:65], v18 offset:32768
  v_mfma_f32_16x16x32_bf16 v[184:187], v[36:39], v[80:83], v[184:187]
  ds_read_b64_tr_b16 v[66:67], v18 offset:33792
  v_mfma_f32_16x16x32_bf16 v[188:191], v[36:39], v[84:87], v[188:191]
  ds_read_b128 v[36:39], v8 offset:6144
  v_mfma_f32_16x16x32_bf16 v[192:195], v[72:75], v[40:43], v[192:195]
  ds_read_b64_tr_b16 v[68:69], v19 offset:32768
  v_mfma_f32_16x16x32_bf16 v[196:199], v[76:79], v[40:43], v[196:199]
  ds_read_b64_tr_b16 v[70:71], v19 offset:33792
  v_mfma_f32_16x16x32_bf16 v[200:203], v[40:43], v[80:83], v[200:203]
  v_mfma_f32_16x16x32_bf16 v[204:207], v[40:43], v[84:87], v[204:207]
  ds_read_b128 v[40:43], v8 offset:8192
  v_mfma_f32_16x16x32_bf16 v[208:211], v[72:75], v[44:47], v[208:211]
  v_mfma_f32_16x16x32_bf16 v[212:215], v[76:79], v[44:47], v[212:215]
  v_mfma_f32_16x16x32_bf16 v[216:219], v[44:47], v[80:83], v[216:219]
  v_mfma_f32_16x16x32_bf16 v[220:223], v[44:47], v[84:87], v[220:223]
  ds_read_b128 v[44:47], v8 offset:10240
  v_mfma_f32_16x16x32_bf16 v[224:227], v[72:75], v[48:51], v[224:227]
  v_mfma_f32_16x16x32_bf16 v[228:231], v[76:79], v[48:51], v[228:231]
  v_mfma_f32_16x16x32_bf16 v[232:235], v[48:51], v[80:83], v[232:235]
  v_mfma_f32_16x16x32_bf16 v[236:239], v[48:51], v[84:87], v[236:239]
  ds_read_b128 v[48:51], v8 offset:12288
  v_mfma_f32_16x16x32_bf16 v[240:243], v[72:75], v[52:55], v[240:243]
  v_mfma_f32_16x16x32_bf16 v[244:247], v[76:79], v[52:55], v[244:247]
  v_mfma_f32_16x16x32_bf16 v[248:251], v[52:55], v[80:83], v[248:251]
  v_mfma_f32_16x16x32_bf16 v[252:255], v[52:55], v[84:87], v[252:255]
  ds_read_b128 v[52:55], v8 offset:14336
  s_cmp_lg_u32 s23, s21
  s_cbranch_scc1 K1XS_24
  buffer_load_dword v0, v1, s[16:19], s20 offen
  s_add_u32 s20, s20, s22
  s_add_u32 s21, s21, 8
  s_cmp_ge_u32 s21, 11
  s_cselect_b32 s21, -1, s21
K1XS_24:
  s_add_u32 s23, s23, 1
  s_waitcnt lgkmcnt(12)
  v_mfma_f32_16x16x32_bf16 v[128:131], v[56:59], v[24:27], v[128:131]
  ds_read_b64_tr_b16 v[72:73], v16 offset:40960
  s_waitcnt lgkmcnt(10)
  v_mfma_f32_16x16x32_bf16 v[132:135], v[60:63], v[24:27], v[132:135]
  ds_read_b64_tr_b16 v[74:75], v16 offset:41984
  s_waitcnt lgkmcnt(9)
  v_mfma_f32_16x16x32_bf16 v[136:139], v[24:27], v[64:67], v[136:139]
  ds_read_b64_tr_b16 v[76:77], v17 offset:40960
  s_waitcnt lgkmcnt(7)
  v_mfma_f32_16x16x32_bf16 v[140:143], v[24:27], v[68:71], v[140:143]
  ds_read_b128 v[24:27], v9 offset:0
  v_mfma_f32_16x16x32_bf16 v[144:147], v[56:59], v[28:31], v[144:147]
  ds_read_b64_tr_b16 v[78:79], v17 offset:41984
  v_mfma_f32_16x16x32_bf16 v[148:151], v[60:63], v[28:31], v[148:151]
  ds_read_b64_tr_b16 v[80:81], v18 offset:40960
  v_mfma_f32_16x16x32_bf16 v[152:155], v[28:31], v[64:67], v[152:155]
  ds_read_b64_tr_b16 v[82:83], v18 offset:41984
  v_mfma_f32_16x16x32_bf16 v[156:159], v[28:31], v[68:71], v[156:159]
  ds_read_b128 v[28:31], v9 offset:2048
  v_mfma_f32_16x16x32_bf16 v[160:163], v[56:59], v[32:35], v[160:163]
  ds_read_b64_tr_b16 v[84:85], v19 offset:40960
  v_mfma_f32_16x16x32_bf16 v[164:167], v[60:63], v[32:35], v[164:167]
  ds_read_b64_tr_b16 v[86:87], v19 offset:41984
  v_mfma_f32_16x16x32_bf16 v[168:171], v[32:35], v[64:67], v[168:171]
  v_mfma_f32_16x16x32_bf16 v[172:175], v[32:35], v[68:71], v[172:175]
  ds_read_b128 v[32:35], v9 offset:4096
  v_mfma_f32_16x16x32_bf16 v[176:179], v[56:59], v[36:39], v[176:179]
  v_mfma_f32_16x16x32_bf16 v[180:183], v[60:63], v[36:39], v[180:183]
  v_mfma_f32_16x16x32_bf16 v[184:187], v[36:39], v[64:67], v[184:187]
  v_mfma_f32_16x16x32_bf16 v[188:191], v[36:39], v[68:71], v[188:191]
  ds_read_b128 v[36:39], v9 offset:6144
  s_waitcnt lgkmcnt(15)
  v_mfma_f32_16x16x32_bf16 v[192:195], v[56:59], v[40:43], v[192:195]
  v_mfma_f32_16x16x32_bf16 v[196:199], v[60:63], v[40:43], v[196:199]
  v_mfma_f32_16x16x32_bf16 v[200:203], v[40:43], v[64:67], v[200:203]
  v_mfma_f32_16x16x32_bf16 v[204:207], v[40:43], v[68:71], v[204:207]
  ds_read_b128 v[40:43], v9 offset:8192
  s_waitcnt lgkmcnt(15)
  v_mfma_f32_16x16x32_bf16 v[208:211], v[56:59], v[44:47], v[208:211]
  v_mfma_f32_16x16x32_bf16 v[212:215], v[60:63], v[44:47], v[212:215]
  v_mfma_f32_16x16x32_bf16 v[216:219], v[44:47], v[64:67], v[216:219]
  v_mfma_f32_16x16x32_bf16 v[220:223], v[44:47], v[68:71], v[220:223]
  ds_read_b128 v[44:47], v9 offset:10240
  s_waitcnt lgkmcnt(15)
  v_mfma_f32_16x16x32_bf16 v[224:227], v[56:59], v[48:51], v[224:227]
  v_mfma_f32_16x16x32_bf16 v[228:231], v[60:63], v[48:51], v[228:231]
  v_mfma_f32_16x16x32_bf16 v[232:235], v[48:51], v[64:67], v[232:235]
  v_mfma_f32_16x16x32_bf16 v[236:239], v[48:51], v[68:71], v[236:239]
  ds_read_b128 v[48:51], v9 offset:12288
  s_waitcnt lgkmcnt(15)
  v_mfma_f32_16x16x32_bf16 v[240:243], v[56:59], v[52:55], v[240:243]
  v_mfma_f32_16x16x32_bf16 v[244:247], v[60:63], v[52:55], v[244:247]
  v_mfma_f32_16x16x32_bf16 v[248:251], v[52:55], v[64:67], v[248:251]
  v_mfma_f32_16x16x32_bf16 v[252:255], v[52:55], v[68:71], v[252:255]
  ds_read_b128 v[52:55], v9 offset:14336
  s_waitcnt lgkmcnt(12)
  v_mfma_f32_16x16x32_bf16 v[128:131], v[72:75], v[24:27], v[128:131]
  s_waitcnt lgkmcnt(11)
  v_mfma_f32_16x16x32_bf16 v[132:135], v[76:79], v[24:27], v[132:135]
  s_waitcnt lgkmcnt(9)
  v_mfma_f32_16x16x32_bf16 v[136:139], v[24:27], v[80:83], v[136:139]
  s_waitcnt lgkmcnt(6)
  v_mfma_f32_16x16x32_bf16 v[140:143], v[24:27], v[84:87], v[140:143]
  v_mfma_f32_16x16x32_bf16 v[144:147], v[72:75], v[28:31], v[144:147]
  v_mfma_f32_16x16x32_bf16 v[148:151], v[76:79], v[28:31], v[148:151]
  s_waitcnt lgkmcnt(0)
  s_barrier
  v_mfma_f32_16x16x32_bf16 v[152:155], v[28:31], v[80:83], v[152:155]
  ds_read_b128 v[24:27], v4 offset:0
  v_mfma_f32_16x16x32_bf16 v[156:159], v[28:31], v[84:87], v[156:159]
  ds_read_b128 v[28:31], v4 offset:2048
  v_mfma_f32_16x16x32_bf16 v[160:163], v[72:75], v[32:35], v[160:163]
  ds_read_b64_tr_b16 v[56:57], v16 offset:0
  v_mfma_f32_16x16x32_bf16 v[164:167], v[76:79], v[32:35], v[164:167]
  ds_read_b64_tr_b16 v[58:59], v16 offset:1024
  v_mfma_f32_16x16x32_bf16 v[168:171], v[32:35], v[80:83], v[168:171]
  ds_read_b64_tr_b16 v[60:61], v17 offset:0
  v_mfma_f32_16x16x32_bf16 v[172:175], v[32:35], v[84:87], v[172:175]
  ds_read_b128 v[32:35], v4 offset:4096
  v_mfma_f32_16x16x32_bf16 v[176:179], v[72:75], v[36:39], v[176:179]
  ds_read_b64_tr_b16 v[62:63], v17 offset:1024
  v_mfma_f32_16x16x32_bf16 v[180:183], v[76:79], v[36:39], v[180:183]
  ds_read_b64_tr_b16 v[64:65], v18 offset:0
  v_mfma_f32_16x16x32_bf16 v[184:187], v[36:39], v[80:83], v[184:187]
  ds_read_b64_tr_b16 v[66:67], v18 offset:1024
  v_mfma_f32_16x16x32_bf16 v[188:191], v[36:39], v[84:87], v[188:191]
  ds_read_b128 v[36:39], v4 offset:6144
  v_mfma_f32_16x16x32_bf16 v[192:195], v[72:75], v[40:43], v[192:195]
  ds_read_b64_tr_b16 v[68:69], v19 offset:0
  v_mfma_f32_16x16x32_bf16 v[196:199], v[76:79], v[40:43], v[196:199]
  ds_read_b64_tr_b16 v[70:71], v19 offset:1024
  v_mfma_f32_16x16x32_bf16 v[200:203], v[40:43], v[80:83], v[200:203]
  v_mfma_f32_16x16x32_bf16 v[204:207], v[40:43], v[84:87], v[204:207]
  ds_read_b128 v[40:43], v4 offset:8192
  v_mfma_f32_16x16x32_bf16 v[208:211], v[72:75], v[44:47], v[208:211]
  v_mfma_f32_16x16x32_bf16 v[212:215], v[76:79], v[44:47], v[212:215]
  v_mfma_f32_16x16x32_bf16 v[216:219], v[44:47], v[80:83], v[216:219]
  v_mfma_f32_16x16x32_bf16 v[220:223], v[44:47], v[84:87], v[220:223]
  ds_read_b128 v[44:47], v4 offset:10240
  v_mfma_f32_16x16x32_bf16 v[224:227], v[72:75], v[48:51], v[224:227]
  v_mfma_f32_16x16x32_bf16 v[228:231], v[76:79], v[48:51], v[228:231]
  v_mfma_f32_16x16x32_bf16 v[232:235], v[48:51], v[80:83], v[232:235]
  v_mfma_f32_16x16x32_bf16 v[236:239], v[48:51], v[84:87], v[236:239]
  ds_read_b128 v[48:51], v4 offset:12288
  v_mfma_f32_16x16x32_bf16 v[240:243], v[72:75], v[52:55], v[240:243]
  v_mfma_f32_16x16x32_bf16 v[244:247], v[76:79], v[52:55], v[244:247]
  v_mfma_f32_16x16x32_bf16 v[248:251], v[52:55], v[80:83], v[248:251]
  v_mfma_f32_16x16x32_bf16 v[252:255], v[52:55], v[84:87], v[252:255]
  ds_read_b128 v[52:55], v4 offset:14336
  s_sub_u32 s11, s11, 1
  s_cmp_lg_u32 s11, 0
  s_cbranch_scc1 K1C_21
  s_waitcnt lgkmcnt(12)
  v_mfma_f32_16x16x32_bf16 v[128:131], v[56:59], v[24:27], v[128:131]
  ds_read_b64_tr_b16 v[72:73], v16 offset:8192
  s_waitcnt lgkmcnt(10)
  v_mfma_f32_16x16x32_bf16 v[132:135], v[60:63], v[24:27], v[132:135]
  ds_read_b64_tr_b16 v[74:75], v16 offset:9216
  s_waitcnt lgkmcnt(9)
  v_mfma_f32_16x16x32_bf16 v[136:139], v[24:27], v[64:67], v[136:139]
  ds_read_b64_tr_b16 v[76:77], v17 offset:8192
  s_waitcnt lgkmcnt(7)
  v_mfma_f32_16x16x32_bf16 v[140:143], v[24:27], v[68:71], v[140:143]
  ds_read_b128 v[24:27], v5 offset:0
  v_mfma_f32_16x16x32_bf16 v[144:147], v[56:59], v[28:31], v[144:147]
  ds_read_b64_tr_b16 v[78:79], v17 offset:9216
  v_mfma_f32_16x16x32_bf16 v[148:151], v[60:63], v[28:31], v[148:151]
  ds_read_b64_tr_b16 v[80:81], v18 offset:8192
  v_mfma_f32_16x16x32_bf16 v[152:155], v[28:31], v[64:67], v[152:155]
  ds_read_b64_tr_b16 v[82:83], v18 offset:9216
  v_mfma_f32_16x16x32_bf16 v[156:159], v[28:31], v[68:71], v[156:159]
  ds_read_b128 v[28:31], v5 offset:2048
  v_mfma_f32_16x16x32_bf16 v[160:163], v[56:59], v[32:35], v[160:163]
  ds_read_b64_tr_b16 v[84:85], v19 offset:8192
  v_mfma_f32_16x16x32_bf16 v[164:167], v[60:63], v[32:35], v[164:167]
  ds_read_b64_tr_b16 v[86:87], v19 offset:9216
  v_mfma_f32_16x16x32_bf16 v[168:171], v[32:35], v[64:67], v[168:171]
  v_mfma_f32_16x16x32_bf16 v[172:175], v[32:35], v[68:71], v[172:175]
  ds_read_b128 v[32:35], v5 offset:4096
  v_mfma_f32_16x16x32_bf16 v[176:179], v[56:59], v[36:39], v[176:179]
  v_mfma_f32_16x16x32_bf16 v[180:183], v[60:63], v[36:39], v[180:183]
  v_mfma_f32_16x16x32_bf16 v[184:187], v[36:39], v[64:67], v[184:187]
  v_mfma_f32_16x16x32_bf16 v[188:191], v[36:39], v[68:71], v[188:191]
  ds_read_b128 v[36:39], v5 offset:6144
  s_waitcnt lgkmcnt(15)
  v_mfma_f32_16x16x32_bf16 v[192:195], v[56:59], v[40:43], v[192:195]
  v_mfma_f32_16x16x32_bf16 v[196:199], v[60:63], v[40:43], v[196:199]
  v_mfma_f32_16x16x32_bf16 v[200:203], v[40:43], v[64:67], v[200:203]
  v_mfma_f32_16x16x32_bf16 v[204:207], v[40:43], v[68:71], v[204:207]
  ds_read_b128 v[40:43], v5 offset:8192
  s_waitcnt lgkmcnt(15)
  v_mfma_f32_16x16x32_bf16 v[208:211], v[56:59], v[44:47], v[208:211]
  v_mfma_f32_16x16x32_bf16 v[212:215], v[60:63], v[44:47], v[212:215]
  v_mfma_f32_16x16x32_bf16 v[216:219], v[44:47], v[64:67], v[216:219]
  v_mfma_f32_16x16x32_bf16 v[220:223], v[44:47], v[68:71], v[220:223]
  ds_read_b128 v[44:47], v5 offset:10240
  s_waitcnt lgkmcnt(15)
  v_mfma_f32_16x16x32_bf16 v[224:227], v[56:59], v[48:51], v[224:227]
  v_mfma_f32_16x16x32_bf16 v[228:231], v[60:63], v[48:51], v[228:231]
  v_mfma_f32_16x16x32_bf16 v[232:235], v[48:51], v[64:67], v[232:235]
  v_mfma_f32_16x16x32_bf16 v[236:239], v[48:51], v[68:71], v[236:239]
  ds_read_b128 v[48:51], v5 offset:12288
  s_waitcnt lgkmcnt(15)
  v_mfma_f32_16x16x32_bf16 v[240:243], v[56:59], v[52:55], v[240:243]
  v_mfma_f32_16x16x32_bf16 v[244:247], v[60:63], v[52:55], v[244:247]
  v_mfma_f32_16x16x32_bf16 v[248:251], v[52:55], v[64:67], v[248:251]
  v_mfma_f32_16x16x32_bf16 v[252:255], v[52:55], v[68:71], v[252:255]
  ds_read_b128 v[52:55], v5 offset:14336
  s_waitcnt lgkmcnt(12)
  v_mfma_f32_16x16x32_bf16 v[128:131], v[72:75], v[24:27], v[128:131]
  s_waitcnt lgkmcnt(11)
  v_mfma_f32_16x16x32_bf16 v[132:135], v[76:79], v[24:27], v[132:135]
  s_waitcnt lgkmcnt(9)
  v_mfma_f32_16x16x32_bf16 v[136:139], v[24:27], v[80:83], v[136:139]
  s_waitcnt lgkmcnt(6)
  v_mfma_f32_16x16x32_bf16 v[140:143], v[24:27], v[84:87], v[140:143]
  v_mfma_f32_16x16x32_bf16 v[144:147], v[72:75], v[28:31], v[144:147]
  v_mfma_f32_16x16x32_bf16 v[148:151], v[76:79], v[28:31], v[148:151]
  s_waitcnt lgkmcnt(0)
  s_barrier
  v_mfma_f32_16x16x32_bf16 v[152:155], v[28:31], v[80:83], v[152:155]
  v_mfma_f32_16x16x32_bf16 v[156:159], v[28:31], v[84:87], v[156:159]
  v_mfma_f32_16x16x32_bf16 v[160:163], v[72:75], v[32:35], v[160:163]
  v_mfma_f32_16x16x32_bf16 v[164:167], v[76:79], v[32:35], v[164:167]
  v_mfma_f32_16x16x32_bf16 v[168:171], v[32:35], v[80:83], v[168:171]
  v_mfma_f32_16x16x32_bf16 v[172:175], v[32:35], v[84:87], v[172:175]
  v_mfma_f32_16x16x32_bf16 v[176:179], v[72:75], v[36:39], v[176:179]
  v_mfma_f32_16x16x32_bf16 v[180:183], v[76:79], v[36:39], v[180:183]
  v_mfma_f32_16x16x32_bf16 v[184:187], v[36:39], v[80:83], v[184:187]
  v_mfma_f32_16x16x32_bf16 v[188:191], v[36:39], v[84:87], v[188:191]
  v_mfma_f32_16x16x32_bf16 v[192:195], v[72:75], v[40:43], v[192:195]
  v_mfma_f32_16x16x32_bf16 v[196:199], v[76:79], v[40:43], v[196:199]
  v_mfma_f32_16x16x32_bf16 v[200:203], v[40:43], v[80:83], v[200:203]
  v_mfma_f32_16x16x32_bf16 v[204:207], v[40:43], v[84:87], v[204:207]
  v_mfma_f32_16x16x32_bf16 v[208:211], v[72:75], v[44:47], v[208:211]
  v_mfma_f32_16x16x32_bf16 v[212:215], v[76:79], v[44:47], v[212:215]
  v_mfma_f32_16x16x32_bf16 v[216:219], v[44:47], v[80:83], v[216:219]
  v_mfma_f32_16x16x32_bf16 v[220:223], v[44:47], v[84:87], v[220:223]
  v_mfma_f32_16x16x32_bf16 v[224:227], v[72:75], v[48:51], v[224:227]
  v_mfma_f32_16x16x32_bf16 v[228:231], v[76:79], v[48:51], v[228:231]
  v_mfma_f32_16x16x32_bf16 v[232:235], v[48:51], v[80:83], v[232:235]
  v_mfma_f32_16x16x32_bf16 v[236:239], v[48:51], v[84:87], v[236:239]
  v_mfma_f32_16x16x32_bf16 v[240:243], v[72:75], v[52:55], v[240:243]
  v_mfma_f32_16x16x32_bf16 v[244:247], v[76:79], v[52:55], v[244:247]
  v_mfma_f32_16x16x32_bf16 v[248:251], v[52:55], v[80:83], v[248:251]
  v_mfma_f32_16x16x32_bf16 v[252:255], v[52:55], v[84:87], v[252:255]
K1W_kv_0:
  s_mov_b32 s64, 1069066811
  s_mov_b32 s65, 1069066811
  v_and_b32 v4, 31, v2
  v_lshrrev_b32 v5, 5, v2
  v_bfe_u32 v44, v2, 2, 2
  v_lshl_add_u32 v45, v5, 3, v44
  v_bfe_u32 v46, v2, 4, 1
  v_and_b32 v47, 3, v2
  v_lshl_add_u32 v47, v46, 2, v47
  v_lshlrev_b32 v42, 3, v47
  v_lshl_add_u32 v42, v45, 6, v42
  s_lshl_b32 s9, s13, 11
  s_add_u32 s9, s9, 147456
  v_add_u32 v42, s9, v42
  ds_read_b64_tr_b16 v[112:113], v42 offset:0
  ds_read_b64_tr_b16 v[114:115], v42 offset:1024
  ds_read_b64_tr_b16 v[116:117], v42 offset:256
  ds_read_b64_tr_b16 v[118:119], v42 offset:1280
  s_lshl_b32 s9, s5, 14
  s_add_u32 s9, s9, 32768
  v_lshrrev_b32 v46, 1, v45
  v_xor_b32 v46, v46, v47
  v_lshlrev_b32 v45, 6, v45
  v_add_u32 v45, s9, v45
  v_lshl_add_u32 v40, v46, 3, v45
  v_xor_b32 v46, 2, v46
  v_lshl_add_u32 v41, v46, 3, v45
  v_add_u32 v41, 256, v41
  v_bfe_u32 v44, v4, 1, 3
  v_xor_b32 v44, v44, v5
  v_lshlrev_b32 v45, 6, v4
  v_add_u32 v45, s9, v45
  v_xor_b32 v46, 0, v44
  v_lshl_add_u32 v36, v46, 3, v45
  v_xor_b32 v46, 2, v44
  v_lshl_add_u32 v37, v46, 3, v45
  v_xor_b32 v46, 4, v44
  v_lshl_add_u32 v38, v46, 3, v45
  v_xor_b32 v46, 6, v44
  v_lshl_add_u32 v39, v46, 3, v45
  v_lshrrev_b32 v44, 4, v2
  v_lshrrev_b32 v45, 2, v2
  v_xor_b32 v44, v44, v45
  v_and_b32 v44, 1, v44
  v_cmp_eq_u32 vcc, 0, v44
  v_mov_b32 v45, 0x3f803f80
  s_nop 0
  v_cndmask_b32 v24, 0, v45, vcc
  v_mov_b32 v25, v24
  v_mov_b32 v26, v24
  v_mov_b32 v27, v24
  v_lshlrev_b32 v43, 4, v2
  v_cvt_pk_bf16_f32 v48, v128, v129
  v_cvt_pk_bf16_f32 v49, v130, v131
  v_cvt_pk_bf16_f32 v50, v132, v133
  v_cvt_pk_bf16_f32 v51, v134, v135
  v_cvt_pk_bf16_f32 v52, v144, v145
  v_cvt_pk_bf16_f32 v53, v146, v147
  v_cvt_pk_bf16_f32 v54, v148, v149
  v_cvt_pk_bf16_f32 v55, v150, v151
  v_cvt_pk_bf16_f32 v80, v136, v137
  v_cvt_pk_bf16_f32 v81, v138, v139
  v_cvt_pk_bf16_f32 v84, v140, v141
  v_cvt_pk_bf16_f32 v85, v142, v143
  v_cvt_pk_bf16_f32 v82, v152, v153
  v_cvt_pk_bf16_f32 v83, v154, v155
  v_cvt_pk_bf16_f32 v86, v156, v157
  v_cvt_pk_bf16_f32 v87, v158, v159
  v_permlane16_swap_b32 v48, v52
  v_permlane16_swap_b32 v49, v53
  v_permlane16_swap_b32 v50, v54
  v_permlane16_swap_b32 v51, v55
  v_permlane16_swap_b32 v80, v84
  v_permlane16_swap_b32 v81, v85
  v_permlane16_swap_b32 v82, v86
  v_permlane16_swap_b32 v83, v87
  s_waitcnt lgkmcnt(2)
  v_mfma_f32_32x32x16_bf16 v[128:143], v[112:115], v[48:51], 0
  s_waitcnt lgkmcnt(0)
  v_mfma_f32_32x32x16_bf16 v[128:143], v[116:119], v[52:55], v[128:143]
  v_cvt_pk_bf16_f32 v56, v160, v161
  v_cvt_pk_bf16_f32 v57, v162, v163
  v_cvt_pk_bf16_f32 v58, v164, v165
  v_cvt_pk_bf16_f32 v59, v166, v167
  v_cvt_pk_bf16_f32 v60, v176, v177
  v_cvt_pk_bf16_f32 v61, v178, v179
  v_cvt_pk_bf16_f32 v62, v180, v181
  v_cvt_pk_bf16_f32 v63, v182, v183
  v_cvt_pk_bf16_f32 v88, v168, v169
  v_cvt_pk_bf16_f32 v89, v170, v171
  v_cvt_pk_bf16_f32 v92, v172, v173
  v_cvt_pk_bf16_f32 v93, v174, v175
  v_cvt_pk_bf16_f32 v90, v184, v185
  v_cvt_pk_bf16_f32 v91, v186, v187
  v_cvt_pk_bf16_f32 v94, v188, v189
  v_cvt_pk_bf16_f32 v95, v190, v191
  v_permlane16_swap_b32 v56, v60
  v_permlane16_swap_b32 v57, v61
  v_permlane16_swap_b32 v58, v62
  v_permlane16_swap_b32 v59, v63
  v_permlane16_swap_b32 v88, v92
  v_permlane16_swap_b32 v89, v93
  v_permlane16_swap_b32 v90, v94
  v_permlane16_swap_b32 v91, v95
  v_mfma_f32_32x32x16_bf16 v[160:175], v[112:115], v[56:59], 0
  v_mfma_f32_32x32x16_bf16 v[160:175], v[116:119], v[60:63], v[160:175]
  v_cvt_pk_bf16_f32 v64, v192, v193
  v_cvt_pk_bf16_f32 v65, v194, v195
  v_cvt_pk_bf16_f32 v66, v196, v197
  v_cvt_pk_bf16_f32 v67, v198, v199
  v_cvt_pk_bf16_f32 v68, v208, v209
  v_cvt_pk_bf16_f32 v69, v210, v211
  v_cvt_pk_bf16_f32 v70, v212, v213
  v_cvt_pk_bf16_f32 v71, v214, v215
  v_cvt_pk_bf16_f32 v96, v200, v201
  v_cvt_pk_bf16_f32 v97, v202, v203
  v_cvt_pk_bf16_f32 v100, v204, v205
  v_cvt_pk_bf16_f32 v101, v206, v207
  v_cvt_pk_bf16_f32 v98, v216, v217
  v_cvt_pk_bf16_f32 v99, v218, v219
  v_cvt_pk_bf16_f32 v102, v220, v221
  v_cvt_pk_bf16_f32 v103, v222, v223
  v_permlane16_swap_b32 v64, v68
  v_permlane16_swap_b32 v65, v69
  v_permlane16_swap_b32 v66, v70
  v_permlane16_swap_b32 v67, v71
  v_permlane16_swap_b32 v96, v100
  v_permlane16_swap_b32 v97, v101
  v_permlane16_swap_b32 v98, v102
  v_permlane16_swap_b32 v99, v103
  v_mfma_f32_32x32x16_bf16 v[192:207], v[112:115], v[64:67], 0
  v_mfma_f32_32x32x16_bf16 v[192:207], v[116:119], v[68:71], v[192:207]
  v_cvt_pk_bf16_f32 v72, v224, v225
  v_cvt_pk_bf16_f32 v73, v226, v227
  v_cvt_pk_bf16_f32 v74, v228, v229
  v_cvt_pk_bf16_f32 v75, v230, v231
  v_cvt_pk_bf16_f32 v76, v240, v241
  v_cvt_pk_bf16_f32 v77, v242, v243
  v_cvt_pk_bf16_f32 v78, v244, v245
  v_cvt_pk_bf16_f32 v79, v246, v247
  v_cvt_pk_bf16_f32 v104, v232, v233
  v_cvt_pk_bf16_f32 v105, v234, v235
  v_cvt_pk_bf16_f32 v108, v236, v237
  v_cvt_pk_bf16_f32 v109, v238, v239
  v_cvt_pk_bf16_f32 v106, v248, v249
  v_cvt_pk_bf16_f32 v107, v250, v251
  v_cvt_pk_bf16_f32 v110, v252, v253
  v_cvt_pk_bf16_f32 v111, v254, v255
  v_permlane16_swap_b32 v72, v76
  v_permlane16_swap_b32 v73, v77
  v_permlane16_swap_b32 v74, v78
  v_permlane16_swap_b32 v75, v79
  v_permlane16_swap_b32 v104, v108
  v_permlane16_swap_b32 v105, v109
  v_permlane16_swap_b32 v106, v110
  v_permlane16_swap_b32 v107, v111
  v_mfma_f32_32x32x16_bf16 v[224:239], v[112:115], v[72:75], 0
  v_mfma_f32_32x32x16_bf16 v[224:239], v[116:119], v[76:79], v[224:239]
  v_max3_f32 v28, v128, v129, v130
  v_min3_f32 v29, v128, v129, v130
  v_max3_f32 v28, v28, v131, v132
  v_min3_f32 v29, v29, v131, v132
  v_max3_f32 v28, v28, v133, v134
  v_min3_f32 v29, v29, v133, v134
  v_max3_f32 v28, v28, v135, v136
  v_min3_f32 v29, v29, v135, v136
  v_max3_f32 v28, v28, v137, v138
  v_min3_f32 v29, v29, v137, v138
  v_max3_f32 v28, v28, v139, v140
  v_min3_f32 v29, v29, v139, v140
  v_max3_f32 v28, v28, v141, v142
  v_min3_f32 v29, v29, v141, v142
  v_max_f32 v28, v28, v143
  v_min_f32 v29, v29, v143
  v_mov_b32 v30, v28
  v_mov_b32 v31, v29
  s_nop 0
  v_permlane32_swap_b32 v28, v30
  v_permlane32_swap_b32 v29, v31
  v_max_f32 v28, v28, v30
  v_min_f32 v29, v29, v31
  v_mul_f32 v30, s64, v28
  v_mul_f32 v28, s64, v29
  v_pk_fma_f32 v[144:145], v[128:129], s[64:65], v[30:31] op_sel_hi:[1,0,0] neg_lo:[0,0,1] neg_hi:[0,0,1]
  v_pk_fma_f32 v[128:129], v[128:129], s[64:65], v[28:29] op_sel_hi:[1,0,0] neg_lo:[1,0,0] neg_hi:[1,0,0]
  v_pk_fma_f32 v[146:147], v[130:131], s[64:65], v[30:31] op_sel_hi:[1,0,0] neg_lo:[0,0,1] neg_hi:[0,0,1]
  v_pk_fma_f32 v[130:131], v[130:131], s[64:65], v[28:29] op_sel_hi:[1,0,0] neg_lo:[1,0,0] neg_hi:[1,0,0]
  v_pk_fma_f32 v[148:149], v[132:133], s[64:65], v[30:31] op_sel_hi:[1,0,0] neg_lo:[0,0,1] neg_hi:[0,0,1]
  v_pk_fma_f32 v[132:133], v[132:133], s[64:65], v[28:29] op_sel_hi:[1,0,0] neg_lo:[1,0,0] neg_hi:[1,0,0]
  v_pk_fma_f32 v[150:151], v[134:135], s[64:65], v[30:31] op_sel_hi:[1,0,0] neg_lo:[0,0,1] neg_hi:[0,0,1]
  v_pk_fma_f32 v[134:135], v[134:135], s[64:65], v[28:29] op_sel_hi:[1,0,0] neg_lo:[1,0,0] neg_hi:[1,0,0]
  v_pk_fma_f32 v[152:153], v[136:137], s[64:65], v[30:31] op_sel_hi:[1,0,0] neg_lo:[0,0,1] neg_hi:[0,0,1]
  v_pk_fma_f32 v[136:137], v[136:137], s[64:65], v[28:29] op_sel_hi:[1,0,0] neg_lo:[1,0,0] neg_hi:[1,0,0]
  v_pk_fma_f32 v[154:155], v[138:139], s[64:65], v[30:31] op_sel_hi:[1,0,0] neg_lo:[0,0,1] neg_hi:[0,0,1]
  v_pk_fma_f32 v[138:139], v[138:139], s[64:65], v[28:29] op_sel_hi:[1,0,0] neg_lo:[1,0,0] neg_hi:[1,0,0]
  v_pk_fma_f32 v[156:157], v[140:141], s[64:65], v[30:31] op_sel_hi:[1,0,0] neg_lo:[0,0,1] neg_hi:[0,0,1]
  v_pk_fma_f32 v[140:141], v[140:141], s[64:65], v[28:29] op_sel_hi:[1,0,0] neg_lo:[1,0,0] neg_hi:[1,0,0]
  v_pk_fma_f32 v[158:159], v[142:143], s[64:65], v[30:31] op_sel_hi:[1,0,0] neg_lo:[0,0,1] neg_hi:[0,0,1]
  v_pk_fma_f32 v[142:143], v[142:143], s[64:65], v[28:29] op_sel_hi:[1,0,0] neg_lo:[1,0,0] neg_hi:[1,0,0]
  s_cbranch_execz K1W_kv_ret
K1W_kv_1:
  v_exp_f32 v144, v144
  v_exp_f32 v128, v128
  v_exp_f32 v145, v145
  v_exp_f32 v129, v129
  v_exp_f32 v146, v146
  v_exp_f32 v130, v130
  v_exp_f32 v147, v147
  v_exp_f32 v131, v131
  v_exp_f32 v148, v148
  v_exp_f32 v132, v132
  v_exp_f32 v149, v149
  v_exp_f32 v133, v133
  v_exp_f32 v150, v150
  v_exp_f32 v134, v134
  v_exp_f32 v151, v151
  v_exp_f32 v135, v135
  v_exp_f32 v152, v152
  v_exp_f32 v136, v136
  v_exp_f32 v153, v153
  v_exp_f32 v137, v137
  v_exp_f32 v154, v154
  v_exp_f32 v138, v138
  v_exp_f32 v155, v155
  v_exp_f32 v139, v139
  v_exp_f32 v156, v156
  v_exp_f32 v140, v140
  v_exp_f32 v157, v157
  v_exp_f32 v141, v141
  v_exp_f32 v158, v158
  v_exp_f32 v142, v142
  v_exp_f32 v159, v159
  v_exp_f32 v143, v143
  v_pk_add_f32 v[32:33], v[144:145], v[146:147]
  v_pk_add_f32 v[34:35], v[128:129], v[130:131]
  v_pk_add_f32 v[32:33], v[32:33], v[148:149]
  v_pk_add_f32 v[34:35], v[34:35], v[132:133]
  v_pk_add_f32 v[32:33], v[32:33], v[150:151]
  v_pk_add_f32 v[34:35], v[34:35], v[134:135]
  v_pk_add_f32 v[32:33], v[32:33], v[152:153]
  v_pk_add_f32 v[34:35], v[34:35], v[136:137]
  v_pk_add_f32 v[32:33], v[32:33], v[154:155]
  v_pk_add_f32 v[34:35], v[34:35], v[138:139]
  v_pk_add_f32 v[32:33], v[32:33], v[156:157]
  v_pk_add_f32 v[34:35], v[34:35], v[140:141]
  v_pk_add_f32 v[32:33], v[32:33], v[158:159]
  v_pk_add_f32 v[34:35], v[34:35], v[142:143]
  v_add_f32 v32, v32, v33
  v_add_f32 v34, v34, v35
  v_mov_b32 v33, v32
  v_mov_b32 v35, v34
  s_nop 0
  v_permlane32_swap_b32 v32, v33
  v_permlane32_swap_b32 v34, v35
  v_add_f32 v32, v32, v33
  v_add_f32 v34, v34, v35
  v_rcp_f32 v32, v32
  v_rcp_f32 v34, v34
  v_pk_mul_f32 v[144:145], v[144:145], v[32:33] op_sel_hi:[1,0]
  v_pk_mul_f32 v[128:129], v[128:129], v[34:35] op_sel_hi:[1,0]
  v_pk_mul_f32 v[146:147], v[146:147], v[32:33] op_sel_hi:[1,0]
  v_pk_mul_f32 v[130:131], v[130:131], v[34:35] op_sel_hi:[1,0]
  v_pk_mul_f32 v[148:149], v[148:149], v[32:33] op_sel_hi:[1,0]
  v_pk_mul_f32 v[132:133], v[132:133], v[34:35] op_sel_hi:[1,0]
  v_pk_mul_f32 v[150:151], v[150:151], v[32:33] op_sel_hi:[1,0]
  v_pk_mul_f32 v[134:135], v[134:135], v[34:35] op_sel_hi:[1,0]
  v_pk_mul_f32 v[152:153], v[152:153], v[32:33] op_sel_hi:[1,0]
  v_pk_mul_f32 v[136:137], v[136:137], v[34:35] op_sel_hi:[1,0]
  v_pk_mul_f32 v[154:155], v[154:155], v[32:33] op_sel_hi:[1,0]
  v_pk_mul_f32 v[138:139], v[138:139], v[34:35] op_sel_hi:[1,0]
  v_pk_mul_f32 v[156:157], v[156:157], v[32:33] op_sel_hi:[1,0]
  v_pk_mul_f32 v[140:141], v[140:141], v[34:35] op_sel_hi:[1,0]
  v_pk_mul_f32 v[158:159], v[158:159], v[32:33] op_sel_hi:[1,0]
  v_pk_mul_f32 v[142:143], v[142:143], v[34:35] op_sel_hi:[1,0]
  v_cvt_pk_bf16_f32 v48, v144, v145
  v_cvt_pk_bf16_f32 v56, v128, v129
  v_cvt_pk_bf16_f32 v49, v146, v147
  v_cvt_pk_bf16_f32 v57, v130, v131
  v_cvt_pk_bf16_f32 v50, v148, v149
  v_cvt_pk_bf16_f32 v58, v132, v133
  v_cvt_pk_bf16_f32 v51, v150, v151
  v_cvt_pk_bf16_f32 v59, v134, v135
  v_cvt_pk_bf16_f32 v52, v152, v153
  v_cvt_pk_bf16_f32 v60, v136, v137
  v_cvt_pk_bf16_f32 v53, v154, v155
  v_cvt_pk_bf16_f32 v61, v138, v139
  v_cvt_pk_bf16_f32 v54, v156, v157
  v_cvt_pk_bf16_f32 v62, v140, v141
  v_cvt_pk_bf16_f32 v55, v158, v159
  v_cvt_pk_bf16_f32 v63, v142, v143
  ds_write_b64 v36, v[48:49] offset:0
  ds_write_b64 v37, v[50:51] offset:0
  ds_write_b64 v38, v[52:53] offset:0
  ds_write_b64 v39, v[54:55] offset:0
  ds_write_b64 v36, v[56:57] offset:2048
  ds_write_b64 v37, v[58:59] offset:2048
  ds_write_b64 v38, v[60:61] offset:2048
  ds_write_b64 v39, v[62:63] offset:2048
  ds_read_b64_tr_b16 v[64:65], v40 offset:0
  ds_read_b64_tr_b16 v[66:67], v40 offset:1024
  ds_read_b64_tr_b16 v[68:69], v41 offset:0
  ds_read_b64_tr_b16 v[70:71], v41 offset:1024
  ds_read_b64_tr_b16 v[72:73], v40 offset:2048
  ds_read_b64_tr_b16 v[74:75], v40 offset:3072
  ds_read_b64_tr_b16 v[76:77], v41 offset:2048
  ds_read_b64_tr_b16 v[78:79], v41 offset:3072
  s_waitcnt lgkmcnt(6)
  v_mfma_f32_32x32x16_bf16 v[176:191], v[64:67], v[80:83], 0
  v_mfma_f32_16x16x32_bf16 v[16:19], v[24:27], v[64:67], 0
  s_waitcnt lgkmcnt(4)
  v_mfma_f32_32x32x16_bf16 v[176:191], v[68:71], v[84:87], v[176:191]
  v_mfma_f32_16x16x32_bf16 v[16:19], v[24:27], v[68:71], v[16:19]
  s_waitcnt lgkmcnt(2)
  v_mfma_f32_32x32x16_bf16 v[208:223], v[72:75], v[80:83], 0
  v_mfma_f32_16x16x32_bf16 v[20:23], v[24:27], v[72:75], 0
  s_waitcnt lgkmcnt(0)
  v_mfma_f32_32x32x16_bf16 v[208:223], v[76:79], v[84:87], v[208:223]
  v_mfma_f32_16x16x32_bf16 v[20:23], v[24:27], v[76:79], v[20:23]
  v_max3_f32 v28, v160, v161, v162
  v_min3_f32 v29, v160, v161, v162
  v_max3_f32 v28, v28, v163, v164
  v_min3_f32 v29, v29, v163, v164
  v_max3_f32 v28, v28, v165, v166
  v_min3_f32 v29, v29, v165, v166
  v_max3_f32 v28, v28, v167, v168
  v_min3_f32 v29, v29, v167, v168
  v_max3_f32 v28, v28, v169, v170
  v_min3_f32 v29, v29, v169, v170
  v_max3_f32 v28, v28, v171, v172
  v_min3_f32 v29, v29, v171, v172
  v_max3_f32 v28, v28, v173, v174
  v_min3_f32 v29, v29, v173, v174
  v_max_f32 v28, v28, v175
  v_min_f32 v29, v29, v175
  v_mov_b32 v30, v28
  v_mov_b32 v31, v29
  s_nop 0
  v_permlane32_swap_b32 v28, v30
  v_permlane32_swap_b32 v29, v31
  v_max_f32 v28, v28, v30
  v_min_f32 v29, v29, v31
  v_mul_f32 v30, s64, v28
  v_mul_f32 v28, s64, v29
  v_pk_fma_f32 v[144:145], v[160:161], s[64:65], v[30:31] op_sel_hi:[1,0,0] neg_lo:[0,0,1] neg_hi:[0,0,1]
  v_pk_fma_f32 v[160:161], v[160:161], s[64:65], v[28:29] op_sel_hi:[1,0,0] neg_lo:[1,0,0] neg_hi:[1,0,0]
  v_pk_fma_f32 v[146:147], v[162:163], s[64:65], v[30:31] op_sel_hi:[1,0,0] neg_lo:[0,0,1] neg_hi:[0,0,1]
  v_pk_fma_f32 v[162:163], v[162:163], s[64:65], v[28:29] op_sel_hi:[1,0,0] neg_lo:[1,0,0] neg_hi:[1,0,0]
  v_pk_fma_f32 v[148:149], v[164:165], s[64:65], v[30:31] op_sel_hi:[1,0,0] neg_lo:[0,0,1] neg_hi:[0,0,1]
  v_pk_fma_f32 v[164:165], v[164:165], s[64:65], v[28:29] op_sel_hi:[1,0,0] neg_lo:[1,0,0] neg_hi:[1,0,0]
  v_pk_fma_f32 v[150:151], v[166:167], s[64:65], v[30:31] op_sel_hi:[1,0,0] neg_lo:[0,0,1] neg_hi:[0,0,1]
  v_pk_fma_f32 v[166:167], v[166:167], s[64:65], v[28:29] op_sel_hi:[1,0,0] neg_lo:[1,0,0] neg_hi:[1,0,0]
  v_pk_fma_f32 v[152:153], v[168:169], s[64:65], v[30:31] op_sel_hi:[1,0,0] neg_lo:[0,0,1] neg_hi:[0,0,1]
  v_pk_fma_f32 v[168:169], v[168:169], s[64:65], v[28:29] op_sel_hi:[1,0,0] neg_lo:[1,0,0] neg_hi:[1,0,0]
  v_pk_fma_f32 v[154:155], v[170:171], s[64:65], v[30:31] op_sel_hi:[1,0,0] neg_lo:[0,0,1] neg_hi:[0,0,1]
  v_pk_fma_f32 v[170:171], v[170:171], s[64:65], v[28:29] op_sel_hi:[1,0,0] neg_lo:[1,0,0] neg_hi:[1,0,0]
  v_pk_fma_f32 v[156:157], v[172:173], s[64:65], v[30:31] op_sel_hi:[1,0,0] neg_lo:[0,0,1] neg_hi:[0,0,1]
  v_pk_fma_f32 v[172:173], v[172:173], s[64:65], v[28:29] op_sel_hi:[1,0,0] neg_lo:[1,0,0] neg_hi:[1,0,0]
  v_pk_fma_f32 v[158:159], v[174:175], s[64:65], v[30:31] op_sel_hi:[1,0,0] neg_lo:[0,0,1] neg_hi:[0,0,1]
  v_pk_fma_f32 v[174:175], v[174:175], s[64:65], v[28:29] op_sel_hi:[1,0,0] neg_lo:[1,0,0] neg_hi:[1,0,0]
  v_exp_f32 v144, v144
  v_exp_f32 v160, v160
  v_exp_f32 v145, v145
  v_exp_f32 v161, v161
  v_exp_f32 v146, v146
  v_exp_f32 v162, v162
  v_exp_f32 v147, v147
  v_exp_f32 v163, v163
  v_exp_f32 v148, v148
  v_exp_f32 v164, v164
  v_exp_f32 v149, v149
  v_exp_f32 v165, v165
  v_exp_f32 v150, v150
  v_exp_f32 v166, v166
  v_exp_f32 v151, v151
  v_exp_f32 v167, v167
  v_exp_f32 v152, v152
  v_exp_f32 v168, v168
  v_exp_f32 v153, v153
  v_exp_f32 v169, v169
  v_exp_f32 v154, v154
  v_exp_f32 v170, v170
  v_exp_f32 v155, v155
  v_exp_f32 v171, v171
  v_exp_f32 v156, v156
  v_exp_f32 v172, v172
  v_exp_f32 v157, v157
  v_exp_f32 v173, v173
  v_exp_f32 v158, v158
  v_exp_f32 v174, v174
  v_exp_f32 v159, v159
  v_exp_f32 v175, v175
  v_pk_add_f32 v[32:33], v[144:145], v[146:147]
  v_pk_add_f32 v[34:35], v[160:161], v[162:163]
  v_pk_add_f32 v[32:33], v[32:33], v[148:149]
  v_pk_add_f32 v[34:35], v[34:35], v[164:165]
  v_pk_add_f32 v[32:33], v[32:33], v[150:151]
  v_pk_add_f32 v[34:35], v[34:35], v[166:167]
  v_pk_add_f32 v[32:33], v[32:33], v[152:153]
  v_pk_add_f32 v[34:35], v[34:35], v[168:169]
  v_pk_add_f32 v[32:33], v[32:33], v[154:155]
  v_pk_add_f32 v[34:35], v[34:35], v[170:171]
  v_pk_add_f32 v[32:33], v[32:33], v[156:157]
  v_pk_add_f32 v[34:35], v[34:35], v[172:173]
  s_cbranch_execz K1W_kv_ret
K1W_kv_2:
  v_pk_add_f32 v[32:33], v[32:33], v[158:159]
  v_pk_add_f32 v[34:35], v[34:35], v[174:175]
  v_add_f32 v32, v32, v33
  v_add_f32 v34, v34, v35
  v_mov_b32 v33, v32
  v_mov_b32 v35, v34
  s_nop 0
  v_permlane32_swap_b32 v32, v33
  v_permlane32_swap_b32 v34, v35
  v_add_f32 v32, v32, v33
  v_add_f32 v34, v34, v35
  v_rcp_f32 v32, v32
  v_rcp_f32 v34, v34
  v_pk_mul_f32 v[144:145], v[144:145], v[32:33] op_sel_hi:[1,0]
  v_pk_mul_f32 v[160:161], v[160:161], v[34:35] op_sel_hi:[1,0]
  v_pk_mul_f32 v[146:147], v[146:147], v[32:33] op_sel_hi:[1,0]
  v_pk_mul_f32 v[162:163], v[162:163], v[34:35] op_sel_hi:[1,0]
  v_pk_mul_f32 v[148:149], v[148:149], v[32:33] op_sel_hi:[1,0]
  v_pk_mul_f32 v[164:165], v[164:165], v[34:35] op_sel_hi:[1,0]
  v_pk_mul_f32 v[150:151], v[150:151], v[32:33] op_sel_hi:[1,0]
  v_pk_mul_f32 v[166:167], v[166:167], v[34:35] op_sel_hi:[1,0]
  v_pk_mul_f32 v[152:153], v[152:153], v[32:33] op_sel_hi:[1,0]
  v_pk_mul_f32 v[168:169], v[168:169], v[34:35] op_sel_hi:[1,0]
  v_pk_mul_f32 v[154:155], v[154:155], v[32:33] op_sel_hi:[1,0]
  v_pk_mul_f32 v[170:171], v[170:171], v[34:35] op_sel_hi:[1,0]
  v_pk_mul_f32 v[156:157], v[156:157], v[32:33] op_sel_hi:[1,0]
  v_pk_mul_f32 v[172:173], v[172:173], v[34:35] op_sel_hi:[1,0]
  v_pk_mul_f32 v[158:159], v[158:159], v[32:33] op_sel_hi:[1,0]
  v_pk_mul_f32 v[174:175], v[174:175], v[34:35] op_sel_hi:[1,0]
  v_cvt_pk_bf16_f32 v48, v144, v145
  v_cvt_pk_bf16_f32 v56, v160, v161
  v_cvt_pk_bf16_f32 v49, v146, v147
  v_cvt_pk_bf16_f32 v57, v162, v163
  v_cvt_pk_bf16_f32 v50, v148, v149
  v_cvt_pk_bf16_f32 v58, v164, v165
  v_cvt_pk_bf16_f32 v51, v150, v151
  v_cvt_pk_bf16_f32 v59, v166, v167
  v_cvt_pk_bf16_f32 v52, v152, v153
  v_cvt_pk_bf16_f32 v60, v168, v169
  v_cvt_pk_bf16_f32 v53, v154, v155
  v_cvt_pk_bf16_f32 v61, v170, v171
  v_cvt_pk_bf16_f32 v54, v156, v157
  v_cvt_pk_bf16_f32 v62, v172, v173
  v_cvt_pk_bf16_f32 v55, v158, v159
  v_cvt_pk_bf16_f32 v63, v174, v175
  ds_write_b64 v36, v[48:49] offset:4096
  ds_write_b64 v37, v[50:51] offset:4096
  ds_write_b64 v38, v[52:53] offset:4096
  ds_write_b64 v39, v[54:55] offset:4096
  ds_write_b64 v36, v[56:57] offset:6144
  ds_write_b64 v37, v[58:59] offset:6144
  ds_write_b64 v38, v[60:61] offset:6144
  ds_write_b64 v39, v[62:63] offset:6144
  ds_read_b64_tr_b16 v[64:65], v40 offset:4096
  ds_read_b64_tr_b16 v[66:67], v40 offset:5120
  ds_read_b64_tr_b16 v[68:69], v41 offset:4096
  ds_read_b64_tr_b16 v[70:71], v41 offset:5120
  ds_read_b64_tr_b16 v[72:73], v40 offset:6144
  ds_read_b64_tr_b16 v[74:75], v40 offset:7168
  ds_read_b64_tr_b16 v[76:77], v41 offset:6144
  ds_read_b64_tr_b16 v[78:79], v41 offset:7168
  s_waitcnt lgkmcnt(6)
  v_mfma_f32_32x32x16_bf16 v[176:191], v[64:67], v[88:91], v[176:191]
  v_mfma_f32_16x16x32_bf16 v[16:19], v[24:27], v[64:67], v[16:19]
  s_waitcnt lgkmcnt(4)
  v_mfma_f32_32x32x16_bf16 v[176:191], v[68:71], v[92:95], v[176:191]
  v_mfma_f32_16x16x32_bf16 v[16:19], v[24:27], v[68:71], v[16:19]
  s_waitcnt lgkmcnt(2)
  v_mfma_f32_32x32x16_bf16 v[208:223], v[72:75], v[88:91], v[208:223]
  v_mfma_f32_16x16x32_bf16 v[20:23], v[24:27], v[72:75], v[20:23]
  s_waitcnt lgkmcnt(0)
  v_mfma_f32_32x32x16_bf16 v[208:223], v[76:79], v[92:95], v[208:223]
  v_mfma_f32_16x16x32_bf16 v[20:23], v[24:27], v[76:79], v[20:23]
  v_max3_f32 v28, v192, v193, v194
  v_min3_f32 v29, v192, v193, v194
  v_max3_f32 v28, v28, v195, v196
  v_min3_f32 v29, v29, v195, v196
  v_max3_f32 v28, v28, v197, v198
  v_min3_f32 v29, v29, v197, v198
  v_max3_f32 v28, v28, v199, v200
  v_min3_f32 v29, v29, v199, v200
  v_max3_f32 v28, v28, v201, v202
  v_min3_f32 v29, v29, v201, v202
  v_max3_f32 v28, v28, v203, v204
  v_min3_f32 v29, v29, v203, v204
  v_max3_f32 v28, v28, v205, v206
  v_min3_f32 v29, v29, v205, v206
  v_max_f32 v28, v28, v207
  v_min_f32 v29, v29, v207
  v_mov_b32 v30, v28
  v_mov_b32 v31, v29
  s_nop 0
  v_permlane32_swap_b32 v28, v30
  v_permlane32_swap_b32 v29, v31
  v_max_f32 v28, v28, v30
  v_min_f32 v29, v29, v31
  v_mul_f32 v30, s64, v28
  v_mul_f32 v28, s64, v29
  v_pk_fma_f32 v[144:145], v[192:193], s[64:65], v[30:31] op_sel_hi:[1,0,0] neg_lo:[0,0,1] neg_hi:[0,0,1]
  v_pk_fma_f32 v[192:193], v[192:193], s[64:65], v[28:29] op_sel_hi:[1,0,0] neg_lo:[1,0,0] neg_hi:[1,0,0]
  v_pk_fma_f32 v[146:147], v[194:195], s[64:65], v[30:31] op_sel_hi:[1,0,0] neg_lo:[0,0,1] neg_hi:[0,0,1]
  v_pk_fma_f32 v[194:195], v[194:195], s[64:65], v[28:29] op_sel_hi:[1,0,0] neg_lo:[1,0,0] neg_hi:[1,0,0]
  v_pk_fma_f32 v[148:149], v[196:197], s[64:65], v[30:31] op_sel_hi:[1,0,0] neg_lo:[0,0,1] neg_hi:[0,0,1]
  v_pk_fma_f32 v[196:197], v[196:197], s[64:65], v[28:29] op_sel_hi:[1,0,0] neg_lo:[1,0,0] neg_hi:[1,0,0]
  v_pk_fma_f32 v[150:151], v[198:199], s[64:65], v[30:31] op_sel_hi:[1,0,0] neg_lo:[0,0,1] neg_hi:[0,0,1]
  v_pk_fma_f32 v[198:199], v[198:199], s[64:65], v[28:29] op_sel_hi:[1,0,0] neg_lo:[1,0,0] neg_hi:[1,0,0]
  v_pk_fma_f32 v[152:153], v[200:201], s[64:65], v[30:31] op_sel_hi:[1,0,0] neg_lo:[0,0,1] neg_hi:[0,0,1]
  v_pk_fma_f32 v[200:201], v[200:201], s[64:65], v[28:29] op_sel_hi:[1,0,0] neg_lo:[1,0,0] neg_hi:[1,0,0]
  v_pk_fma_f32 v[154:155], v[202:203], s[64:65], v[30:31] op_sel_hi:[1,0,0] neg_lo:[0,0,1] neg_hi:[0,0,1]
  v_pk_fma_f32 v[202:203], v[202:203], s[64:65], v[28:29] op_sel_hi:[1,0,0] neg_lo:[1,0,0] neg_hi:[1,0,0]
  v_pk_fma_f32 v[156:157], v[204:205], s[64:65], v[30:31] op_sel_hi:[1,0,0] neg_lo:[0,0,1] neg_hi:[0,0,1]
  v_pk_fma_f32 v[204:205], v[204:205], s[64:65], v[28:29] op_sel_hi:[1,0,0] neg_lo:[1,0,0] neg_hi:[1,0,0]
  v_pk_fma_f32 v[158:159], v[206:207], s[64:65], v[30:31] op_sel_hi:[1,0,0] neg_lo:[0,0,1] neg_hi:[0,0,1]
  v_pk_fma_f32 v[206:207], v[206:207], s[64:65], v[28:29] op_sel_hi:[1,0,0] neg_lo:[1,0,0] neg_hi:[1,0,0]
  v_exp_f32 v144, v144
  v_exp_f32 v192, v192
  v_exp_f32 v145, v145
  v_exp_f32 v193, v193
  v_exp_f32 v146, v146
  v_exp_f32 v194, v194
  v_exp_f32 v147, v147
  v_exp_f32 v195, v195
  v_exp_f32 v148, v148
  v_exp_f32 v196, v196
  v_exp_f32 v149, v149
  v_exp_f32 v197, v197
  v_exp_f32 v150, v150
  v_exp_f32 v198, v198
  v_exp_f32 v151, v151
  v_exp_f32 v199, v199
  v_exp_f32 v152, v152
  v_exp_f32 v200, v200
  v_exp_f32 v153, v153
  v_exp_f32 v201, v201
  v_exp_f32 v154, v154
  v_exp_f32 v202, v202
  v_exp_f32 v155, v155
  v_exp_f32 v203, v203
  v_exp_f32 v156, v156
  v_exp_f32 v204, v204
  v_exp_f32 v157, v157
  v_exp_f32 v205, v205
  v_exp_f32 v158, v158
  v_exp_f32 v206, v206
  v_exp_f32 v159, v159
  v_exp_f32 v207, v207
  v_pk_add_f32 v[32:33], v[144:145], v[146:147]
  v_pk_add_f32 v[34:35], v[192:193], v[194:195]
  v_pk_add_f32 v[32:33], v[32:33], v[148:149]
  v_pk_add_f32 v[34:35], v[34:35], v[196:197]
  v_pk_add_f32 v[32:33], v[32:33], v[150:151]
  v_pk_add_f32 v[34:35], v[34:35], v[198:199]
  v_pk_add_f32 v[32:33], v[32:33], v[152:153]
  v_pk_add_f32 v[34:35], v[34:35], v[200:201]
  v_pk_add_f32 v[32:33], v[32:33], v[154:155]
  v_pk_add_f32 v[34:35], v[34:35], v[202:203]
  v_pk_add_f32 v[32:33], v[32:33], v[156:157]
  v_pk_add_f32 v[34:35], v[34:35], v[204:205]
  v_pk_add_f32 v[32:33], v[32:33], v[158:159]
  v_pk_add_f32 v[34:35], v[34:35], v[206:207]
  v_add_f32 v32, v32, v33
  v_add_f32 v34, v34, v35
  v_mov_b32 v33, v32
  v_mov_b32 v35, v34
  s_nop 0
  v_permlane32_swap_b32 v32, v33
  v_permlane32_swap_b32 v34, v35
  v_add_f32 v32, v32, v33
  v_add_f32 v34, v34, v35
  v_rcp_f32 v32, v32
  v_rcp_f32 v34, v34
  v_pk_mul_f32 v[144:145], v[144:145], v[32:33] op_sel_hi:[1,0]
  v_pk_mul_f32 v[192:193], v[192:193], v[34:35] op_sel_hi:[1,0]
  v_pk_mul_f32 v[146:147], v[146:147], v[32:33] op_sel_hi:[1,0]
  v_pk_mul_f32 v[194:195], v[194:195], v[34:35] op_sel_hi:[1,0]
  v_pk_mul_f32 v[148:149], v[148:149], v[32:33] op_sel_hi:[1,0]
  v_pk_mul_f32 v[196:197], v[196:197], v[34:35] op_sel_hi:[1,0]
  v_pk_mul_f32 v[150:151], v[150:151], v[32:33] op_sel_hi:[1,0]
  v_pk_mul_f32 v[198:199], v[198:199], v[34:35] op_sel_hi:[1,0]
  v_pk_mul_f32 v[152:153], v[152:153], v[32:33] op_sel_hi:[1,0]
  v_pk_mul_f32 v[200:201], v[200:201], v[34:35] op_sel_hi:[1,0]
  v_pk_mul_f32 v[154:155], v[154:155], v[32:33] op_sel_hi:[1,0]
  v_pk_mul_f32 v[202:203], v[202:203], v[34:35] op_sel_hi:[1,0]
  v_pk_mul_f32 v[156:157], v[156:157], v[32:33] op_sel_hi:[1,0]
  v_pk_mul_f32 v[204:205], v[204:205], v[34:35] op_sel_hi:[1,0]
  v_pk_mul_f32 v[158:159], v[158:159], v[32:33] op_sel_hi:[1,0]
  v_pk_mul_f32 v[206:207], v[206:207], v[34:35] op_sel_hi:[1,0]
  v_cvt_pk_bf16_f32 v48, v144, v145
  v_cvt_pk_bf16_f32 v56, v192, v193
  v_cvt_pk_bf16_f32 v49, v146, v147
  v_cvt_pk_bf16_f32 v57, v194, v195
  v_cvt_pk_bf16_f32 v50, v148, v149
  v_cvt_pk_bf16_f32 v58, v196, v197
  v_cvt_pk_bf16_f32 v51, v150, v151
  v_cvt_pk_bf16_f32 v59, v198, v199
  v_cvt_pk_bf16_f32 v52, v152, v153
  v_cvt_pk_bf16_f32 v60, v200, v201
  v_cvt_pk_bf16_f32 v53, v154, v155
  v_cvt_pk_bf16_f32 v61, v202, v203
  v_cvt_pk_bf16_f32 v54, v156, v157
  v_cvt_pk_bf16_f32 v62, v204, v205
  v_cvt_pk_bf16_f32 v55, v158, v159
  v_cvt_pk_bf16_f32 v63, v206, v207
  s_cbranch_execz K1W_kv_ret
K1W_kv_3:
  ds_write_b64 v36, v[48:49] offset:8192
  ds_write_b64 v37, v[50:51] offset:8192
  ds_write_b64 v38, v[52:53] offset:8192
  ds_write_b64 v39, v[54:55] offset:8192
  ds_write_b64 v36, v[56:57] offset:10240
  ds_write_b64 v37, v[58:59] offset:10240
  ds_write_b64 v38, v[60:61] offset:10240
  ds_write_b64 v39, v[62:63] offset:10240
  ds_read_b64_tr_b16 v[64:65], v40 offset:8192
  ds_read_b64_tr_b16 v[66:67], v40 offset:9216
  ds_read_b64_tr_b16 v[68:69], v41 offset:8192
  ds_read_b64_tr_b16 v[70:71], v41 offset:9216
  ds_read_b64_tr_b16 v[72:73], v40 offset:10240
  ds_read_b64_tr_b16 v[74:75], v40 offset:11264
  ds_read_b64_tr_b16 v[76:77], v41 offset:10240
  ds_read_b64_tr_b16 v[78:79], v41 offset:11264
  s_waitcnt lgkmcnt(6)
  v_mfma_f32_32x32x16_bf16 v[176:191], v[64:67], v[96:99], v[176:191]
  v_mfma_f32_16x16x32_bf16 v[16:19], v[24:27], v[64:67], v[16:19]
  s_waitcnt lgkmcnt(4)
  v_mfma_f32_32x32x16_bf16 v[176:191], v[68:71], v[100:103], v[176:191]
  v_mfma_f32_16x16x32_bf16 v[16:19], v[24:27], v[68:71], v[16:19]
  s_waitcnt lgkmcnt(2)
  v_mfma_f32_32x32x16_bf16 v[208:223], v[72:75], v[96:99], v[208:223]
  v_mfma_f32_16x16x32_bf16 v[20:23], v[24:27], v[72:75], v[20:23]
  s_waitcnt lgkmcnt(0)
  v_mfma_f32_32x32x16_bf16 v[208:223], v[76:79], v[100:103], v[208:223]
  v_mfma_f32_16x16x32_bf16 v[20:23], v[24:27], v[76:79], v[20:23]
  v_max3_f32 v28, v224, v225, v226
  v_min3_f32 v29, v224, v225, v226
  v_max3_f32 v28, v28, v227, v228
  v_min3_f32 v29, v29, v227, v228
  v_max3_f32 v28, v28, v229, v230
  v_min3_f32 v29, v29, v229, v230
  v_max3_f32 v28, v28, v231, v232
  v_min3_f32 v29, v29, v231, v232
  v_max3_f32 v28, v28, v233, v234
  v_min3_f32 v29, v29, v233, v234
  v_max3_f32 v28, v28, v235, v236
  v_min3_f32 v29, v29, v235, v236
  v_max3_f32 v28, v28, v237, v238
  v_min3_f32 v29, v29, v237, v238
  v_max_f32 v28, v28, v239
  v_min_f32 v29, v29, v239
  v_mov_b32 v30, v28
  v_mov_b32 v31, v29
  s_nop 0
  v_permlane32_swap_b32 v28, v30
  v_permlane32_swap_b32 v29, v31
  v_max_f32 v28, v28, v30
  v_min_f32 v29, v29, v31
  v_mul_f32 v30, s64, v28
  v_mul_f32 v28, s64, v29
  v_pk_fma_f32 v[144:145], v[224:225], s[64:65], v[30:31] op_sel_hi:[1,0,0] neg_lo:[0,0,1] neg_hi:[0,0,1]
  v_pk_fma_f32 v[224:225], v[224:225], s[64:65], v[28:29] op_sel_hi:[1,0,0] neg_lo:[1,0,0] neg_hi:[1,0,0]
  v_pk_fma_f32 v[146:147], v[226:227], s[64:65], v[30:31] op_sel_hi:[1,0,0] neg_lo:[0,0,1] neg_hi:[0,0,1]
  v_pk_fma_f32 v[226:227], v[226:227], s[64:65], v[28:29] op_sel_hi:[1,0,0] neg_lo:[1,0,0] neg_hi:[1,0,0]
  v_pk_fma_f32 v[148:149], v[228:229], s[64:65], v[30:31] op_sel_hi:[1,0,0] neg_lo:[0,0,1] neg_hi:[0,0,1]
  v_pk_fma_f32 v[228:229], v[228:229], s[64:65], v[28:29] op_sel_hi:[1,0,0] neg_lo:[1,0,0] neg_hi:[1,0,0]
  v_pk_fma_f32 v[150:151], v[230:231], s[64:65], v[30:31] op_sel_hi:[1,0,0] neg_lo:[0,0,1] neg_hi:[0,0,1]
  v_pk_fma_f32 v[230:231], v[230:231], s[64:65], v[28:29] op_sel_hi:[1,0,0] neg_lo:[1,0,0] neg_hi:[1,0,0]
  v_pk_fma_f32 v[152:153], v[232:233], s[64:65], v[30:31] op_sel_hi:[1,0,0] neg_lo:[0,0,1] neg_hi:[0,0,1]
  v_pk_fma_f32 v[232:233], v[232:233], s[64:65], v[28:29] op_sel_hi:[1,0,0] neg_lo:[1,0,0] neg_hi:[1,0,0]
  v_pk_fma_f32 v[154:155], v[234:235], s[64:65], v[30:31] op_sel_hi:[1,0,0] neg_lo:[0,0,1] neg_hi:[0,0,1]
  v_pk_fma_f32 v[234:235], v[234:235], s[64:65], v[28:29] op_sel_hi:[1,0,0] neg_lo:[1,0,0] neg_hi:[1,0,0]
  v_pk_fma_f32 v[156:157], v[236:237], s[64:65], v[30:31] op_sel_hi:[1,0,0] neg_lo:[0,0,1] neg_hi:[0,0,1]
  v_pk_fma_f32 v[236:237], v[236:237], s[64:65], v[28:29] op_sel_hi:[1,0,0] neg_lo:[1,0,0] neg_hi:[1,0,0]
  v_pk_fma_f32 v[158:159], v[238:239], s[64:65], v[30:31] op_sel_hi:[1,0,0] neg_lo:[0,0,1] neg_hi:[0,0,1]
  v_pk_fma_f32 v[238:239], v[238:239], s[64:65], v[28:29] op_sel_hi:[1,0,0] neg_lo:[1,0,0] neg_hi:[1,0,0]
  v_exp_f32 v144, v144
  v_exp_f32 v224, v224
  v_exp_f32 v145, v145
  v_exp_f32 v225, v225
  v_exp_f32 v146, v146
  v_exp_f32 v226, v226
  v_exp_f32 v147, v147
  v_exp_f32 v227, v227
  v_exp_f32 v148, v148
  v_exp_f32 v228, v228
  v_exp_f32 v149, v149
  v_exp_f32 v229, v229
  v_exp_f32 v150, v150
  v_exp_f32 v230, v230
  v_exp_f32 v151, v151
  v_exp_f32 v231, v231
  v_exp_f32 v152, v152
  v_exp_f32 v232, v232
  v_exp_f32 v153, v153
  v_exp_f32 v233, v233
  v_exp_f32 v154, v154
  v_exp_f32 v234, v234
  v_exp_f32 v155, v155
  v_exp_f32 v235, v235
  v_exp_f32 v156, v156
  v_exp_f32 v236, v236
  v_exp_f32 v157, v157
  v_exp_f32 v237, v237
  v_exp_f32 v158, v158
  v_exp_f32 v238, v238
  v_exp_f32 v159, v159
  v_exp_f32 v239, v239
  v_pk_add_f32 v[32:33], v[144:145], v[146:147]
  v_pk_add_f32 v[34:35], v[224:225], v[226:227]
  v_pk_add_f32 v[32:33], v[32:33], v[148:149]
  v_pk_add_f32 v[34:35], v[34:35], v[228:229]
  v_pk_add_f32 v[32:33], v[32:33], v[150:151]
  v_pk_add_f32 v[34:35], v[34:35], v[230:231]
  v_pk_add_f32 v[32:33], v[32:33], v[152:153]
  v_pk_add_f32 v[34:35], v[34:35], v[232:233]
  v_pk_add_f32 v[32:33], v[32:33], v[154:155]
  v_pk_add_f32 v[34:35], v[34:35], v[234:235]
  v_pk_add_f32 v[32:33], v[32:33], v[156:157]
  v_pk_add_f32 v[34:35], v[34:35], v[236:237]
  v_pk_add_f32 v[32:33], v[32:33], v[158:159]
  v_pk_add_f32 v[34:35], v[34:35], v[238:239]
  v_add_f32 v32, v32, v33
  v_add_f32 v34, v34, v35
  v_mov_b32 v33, v32
  v_mov_b32 v35, v34
  s_nop 0
  v_permlane32_swap_b32 v32, v33
  v_permlane32_swap_b32 v34, v35
  v_add_f32 v32, v32, v33
  v_add_f32 v34, v34, v35
  v_rcp_f32 v32, v32
  v_rcp_f32 v34, v34
  v_pk_mul_f32 v[144:145], v[144:145], v[32:33] op_sel_hi:[1,0]
  v_pk_mul_f32 v[224:225], v[224:225], v[34:35] op_sel_hi:[1,0]
  v_pk_mul_f32 v[146:147], v[146:147], v[32:33] op_sel_hi:[1,0]
  v_pk_mul_f32 v[226:227], v[226:227], v[34:35] op_sel_hi:[1,0]
  v_pk_mul_f32 v[148:149], v[148:149], v[32:33] op_sel_hi:[1,0]
  v_pk_mul_f32 v[228:229], v[228:229], v[34:35] op_sel_hi:[1,0]
  v_pk_mul_f32 v[150:151], v[150:151], v[32:33] op_sel_hi:[1,0]
  v_pk_mul_f32 v[230:231], v[230:231], v[34:35] op_sel_hi:[1,0]
  v_pk_mul_f32 v[152:153], v[152:153], v[32:33] op_sel_hi:[1,0]
  v_pk_mul_f32 v[232:233], v[232:233], v[34:35] op_sel_hi:[1,0]
  v_pk_mul_f32 v[154:155], v[154:155], v[32:33] op_sel_hi:[1,0]
  v_pk_mul_f32 v[234:235], v[234:235], v[34:35] op_sel_hi:[1,0]
  v_pk_mul_f32 v[156:157], v[156:157], v[32:33] op_sel_hi:[1,0]
  v_pk_mul_f32 v[236:237], v[236:237], v[34:35] op_sel_hi:[1,0]
  v_pk_mul_f32 v[158:159], v[158:159], v[32:33] op_sel_hi:[1,0]
  v_pk_mul_f32 v[238:239], v[238:239], v[34:35] op_sel_hi:[1,0]
  v_cvt_pk_bf16_f32 v48, v144, v145
  v_cvt_pk_bf16_f32 v56, v224, v225
  v_cvt_pk_bf16_f32 v49, v146, v147
  v_cvt_pk_bf16_f32 v57, v226, v227
  v_cvt_pk_bf16_f32 v50, v148, v149
  v_cvt_pk_bf16_f32 v58, v228, v229
  v_cvt_pk_bf16_f32 v51, v150, v151
  v_cvt_pk_bf16_f32 v59, v230, v231
  v_cvt_pk_bf16_f32 v52, v152, v153
  v_cvt_pk_bf16_f32 v60, v232, v233
  v_cvt_pk_bf16_f32 v53, v154, v155
  v_cvt_pk_bf16_f32 v61, v234, v235
  v_cvt_pk_bf16_f32 v54, v156, v157
  v_cvt_pk_bf16_f32 v62, v236, v237
  v_cvt_pk_bf16_f32 v55, v158, v159
  v_cvt_pk_bf16_f32 v63, v238, v239
  ds_write_b64 v36, v[48:49] offset:12288
  ds_write_b64 v37, v[50:51] offset:12288
  ds_write_b64 v38, v[52:53] offset:12288
  ds_write_b64 v39, v[54:55] offset:12288
  ds_write_b64 v36, v[56:57] offset:14336
  ds_write_b64 v37, v[58:59] offset:14336
  ds_write_b64 v38, v[60:61] offset:14336
  ds_write_b64 v39, v[62:63] offset:14336
  ds_read_b64_tr_b16 v[64:65], v40 offset:12288
  ds_read_b64_tr_b16 v[66:67], v40 offset:13312
  ds_read_b64_tr_b16 v[68:69], v41 offset:12288
  ds_read_b64_tr_b16 v[70:71], v41 offset:13312
  ds_read_b64_tr_b16 v[72:73], v40 offset:14336
  ds_read_b64_tr_b16 v[74:75], v40 offset:15360
  ds_read_b64_tr_b16 v[76:77], v41 offset:14336
  ds_read_b64_tr_b16 v[78:79], v41 offset:15360
  s_waitcnt lgkmcnt(6)
  v_mfma_f32_32x32x16_bf16 v[176:191], v[64:67], v[104:107], v[176:191]
  v_mfma_f32_16x16x32_bf16 v[16:19], v[24:27], v[64:67], v[16:19]
  s_waitcnt lgkmcnt(4)
  v_mfma_f32_32x32x16_bf16 v[176:191], v[68:71], v[108:111], v[176:191]
  v_mfma_f32_16x16x32_bf16 v[16:19], v[24:27], v[68:71], v[16:19]
  s_waitcnt lgkmcnt(2)
  v_mfma_f32_32x32x16_bf16 v[208:223], v[72:75], v[104:107], v[208:223]
  v_mfma_f32_16x16x32_bf16 v[20:23], v[24:27], v[72:75], v[20:23]
  s_waitcnt lgkmcnt(0)
  v_mfma_f32_32x32x16_bf16 v[208:223], v[76:79], v[108:111], v[208:223]
  v_mfma_f32_16x16x32_bf16 v[20:23], v[24:27], v[76:79], v[20:23]
  s_lshl_b32 s9, s7, 1
  s_add_u32 s9, s9, s13
  s_lshl_b32 s9, s9, 4
  s_lshl_b32 s10, s6, 1
  s_add_u32 s9, s9, s10
  s_add_u32 s9, s9, s12
  s_lshl_b32 s10, s9, 13
  s_add_u32 s10, s10, 9437184
  buffer_store_dwordx4 v[176:179], v43, s[48:51], s10 offen offset:0 sc0 sc1
  buffer_store_dwordx4 v[180:183], v43, s[48:51], s10 offen offset:1024 sc0 sc1
  buffer_store_dwordx4 v[184:187], v43, s[48:51], s10 offen offset:2048 sc0 sc1
  buffer_store_dwordx4 v[188:191], v43, s[48:51], s10 offen offset:3072 sc0 sc1
  s_add_u32 s10, s10, 4096
  buffer_store_dwordx4 v[208:211], v43, s[48:51], s10 offen offset:0 sc0 sc1
  buffer_store_dwordx4 v[212:215], v43, s[48:51], s10 offen offset:1024 sc0 sc1
  buffer_store_dwordx4 v[216:219], v43, s[48:51], s10 offen offset:2048 sc0 sc1
  buffer_store_dwordx4 v[220:223], v43, s[48:51], s10 offen offset:3072 sc0 sc1
  s_lshl_b32 s10, s9, 8
  s_add_u32 s10, s10, 13631488
  v_lshlrev_b32 v44, 2, v2
  s_cbranch_execz K1W_kv_ret
  s_mov_b32 exec_hi, 0
  buffer_store_dword v16, v44, s[48:51], s10 offen offset:0
  buffer_store_dword v20, v44, s[48:51], s10 offen offset:128
  s_mov_b64 exec, -1
  s_endpgm
K1_loader:
  s_cmp_ge_u32 s7, 24
  s_cbranch_scc1 K1_loaderB
  s_sub_u32 s5, s5, 4
  v_lshrrev_b32 v10, 3, v2
  s_lshl_b32 s9, s5, 6
  v_add_u32 v10, s9, v10
  v_lshlrev_b32 v10, 11, v10
  v_lshrrev_b32 v11, 4, v2
  v_and_b32 v12, 7, v2
  v_xor_b32 v12, v12, v11
  v_lshl_add_u32 v4, v12, 4, v10
  v_xor_b32 v12, 4, v12
  v_lshl_add_u32 v5, v12, 4, v10
  v_bfe_u32 v10, v2, 1, 3
  v_xor_b32 v10, v10, v11
  v_mul_lo_u32 v6, v11, s35
  v_bfe_u32 v12, v10, 1, 1
  v_mul_lo_u32 v12, v12, s15
  v_add_u32 v6, v6, v12
  v_lshrrev_b32 v12, 2, v10
  v_mul_lo_u32 v12, v12, s34
  v_add_u32 v6, v6, v12
  v_and_b32 v12, 1, v10
  v_lshl_add_u32 v6, v12, 5, v6
  v_and_b32 v12, 1, v2
  v_lshl_add_u32 v6, v12, 4, v6
  v_add_u32 v6, s14, v6
  v_bfe_u32 v10, v2, 1, 3
  v_xor_b32 v10, v10, v11
  v_xor_b32 v10, 4, v10
  v_mul_lo_u32 v7, v11, s35
  v_bfe_u32 v12, v10, 1, 1
  v_mul_lo_u32 v12, v12, s15
  v_add_u32 v7, v7, v12
  v_lshrrev_b32 v12, 2, v10
  v_mul_lo_u32 v12, v12, s34
  v_add_u32 v7, v7, v12
  v_and_b32 v12, 1, v10
  v_lshl_add_u32 v7, v12, 5, v7
  v_and_b32 v12, 1, v2
  v_lshl_add_u32 v7, v12, 4, v7
  v_add_u32 v7, s14, v7
  v_lshlrev_b32 v8, 4, v2
  s_lshl_b32 s52, s5, 13
  s_lshl_b32 s53, s5, 12
  s_add_u32 s53, s53, 98304
  s_lshl_b32 s54, s5, 10
  s_mov_b32 s57, s54
  s_add_u32 s54, s54, 147456
  s_mov_b32 s55, 0
  s_lshl_b32 s59, s35, 2
  s_lshl_b32 s60, s35, 6
  s_lshl_b32 s56, s59, 2
  s_mul_i32 s56, s56, s5
  s_mov_b32 m0, s54
  s_nop 0
  buffer_load_dwordx4 v8, s[44:47], s57 offen lds
  s_add_u32 m0, s54, 4096
  s_add_u32 s57, s57, 4096
  buffer_load_dwordx4 v8, s[44:47], s57 offen lds
  s_add_u32 m0, s52, 0
  s_add_u32 s58, s55, 0
  buffer_load_dwordx4 v4, s[36:39], s58 offen lds
  s_add_u32 m0, s53, 0
  s_mov_b32 s61, s56
  buffer_load_dwordx4 v6, s[40:43], s61 offen lds
  s_add_u32 m0, s52, 1024
  s_add_u32 s58, s55, 16384
  buffer_load_dwordx4 v5, s[36:39], s58 offen lds
  s_add_u32 m0, s52, 2048
  s_add_u32 s58, s55, 32768
  buffer_load_dwordx4 v4, s[36:39], s58 offen lds
  s_add_u32 m0, s53, 1024
  s_add_u32 s61, s61, s59
  buffer_load_dwordx4 v6, s[40:43], s61 offen lds
  s_add_u32 m0, s52, 3072
  s_add_u32 s58, s55, 49152
  buffer_load_dwordx4 v5, s[36:39], s58 offen lds
  s_add_u32 m0, s52, 4096
  s_add_u32 s58, s55, 65536
  buffer_load_dwordx4 v4, s[36:39], s58 offen lds
  s_add_u32 m0, s53, 2048
  s_add_u32 s61, s61, s59
  buffer_load_dwordx4 v7, s[40:43], s61 offen lds
  s_add_u32 m0, s52, 5120
  s_add_u32 s58, s55, 81920
  buffer_load_dwordx4 v5, s[36:39], s58 offen lds
  s_add_u32 m0, s52, 6144
  s_add_u32 s58, s55, 98304
  buffer_load_dwordx4 v4, s[36:39], s58 offen lds
  s_add_u32 m0, s53, 3072
  s_add_u32 s61, s61, s59
  buffer_load_dwordx4 v7, s[40:43], s61 offen lds
  s_add_u32 m0, s52, 7168
  s_add_u32 s58, s55, 114688
  buffer_load_dwordx4 v5, s[36:39], s58 offen lds
  s_add_u32 s55, s55, 128
  s_add_u32 s56, s56, s60
  s_add_u32 s52, s52, 32768
  s_add_u32 s53, s53, 16384
  s_add_u32 s54, s54, 4096
  s_cmp_ge_u32 s52, 98304
  s_cselect_b32 s58, 98304, 0
  s_cselect_b32 s61, 49152, 0
  s_cselect_b32 s62, 12288, 0
  s_sub_u32 s52, s52, s58
  s_sub_u32 s53, s53, s61
  s_sub_u32 s54, s54, s62
  s_add_u32 m0, s52, 0
  s_add_u32 s58, s55, 0
  buffer_load_dwordx4 v4, s[36:39], s58 offen lds
  s_add_u32 m0, s53, 0
  s_mov_b32 s61, s56
  buffer_load_dwordx4 v6, s[40:43], s61 offen lds
  s_add_u32 m0, s52, 1024
  s_add_u32 s58, s55, 16384
  buffer_load_dwordx4 v5, s[36:39], s58 offen lds
  s_add_u32 m0, s52, 2048
  s_add_u32 s58, s55, 32768
  buffer_load_dwordx4 v4, s[36:39], s58 offen lds
  s_add_u32 m0, s53, 1024
  s_add_u32 s61, s61, s59
  buffer_load_dwordx4 v6, s[40:43], s61 offen lds
  s_add_u32 m0, s52, 3072
  s_add_u32 s58, s55, 49152
  buffer_load_dwordx4 v5, s[36:39], s58 offen lds
  s_add_u32 m0, s52, 4096
  s_add_u32 s58, s55, 65536
  buffer_load_dwordx4 v4, s[36:39], s58 offen lds
  s_add_u32 m0, s53, 2048
  s_add_u32 s61, s61, s59
  buffer_load_dwordx4 v7, s[40:43], s61 offen lds
  s_add_u32 m0, s52, 5120
  s_add_u32 s58, s55, 81920
  buffer_load_dwordx4 v5, s[36:39], s58 offen lds
  s_add_u32 m0, s52, 6144
  s_add_u32 s58, s55, 98304
  buffer_load_dwordx4 v4, s[36:39], s58 offen lds
  s_add_u32 m0, s53, 3072
  s_add_u32 s61, s61, s59
  buffer_load_dwordx4 v7, s[40:43], s61 offen lds
  s_add_u32 m0, s52, 7168
  s_add_u32 s58, s55, 114688
  buffer_load_dwordx4 v5, s[36:39], s58 offen lds
  s_add_u32 s55, s55, 128
  s_add_u32 s56, s56, s60
  s_add_u32 s52, s52, 32768
  s_add_u32 s53, s53, 16384
  s_add_u32 s54, s54, 4096
  s_cmp_ge_u32 s52, 98304
  s_cselect_b32 s58, 98304, 0
  s_cselect_b32 s61, 49152, 0
  s_cselect_b32 s62, 12288, 0
  s_sub_u32 s52, s52, s58
  s_sub_u32 s53, s53, s61
  s_sub_u32 s54, s54, s62
  s_waitcnt vmcnt(12)
  s_barrier
  s_add_u32 m0, s52, 0
  s_add_u32 s58, s55, 0
  buffer_load_dwordx4 v4, s[36:39], s58 offen lds
  s_add_u32 m0, s53, 0
  s_mov_b32 s61, s56
  buffer_load_dwordx4 v6, s[40:43], s61 offen lds
  s_add_u32 m0, s52, 1024
  s_add_u32 s58, s55, 16384
  buffer_load_dwordx4 v5, s[36:39], s58 offen lds
  s_add_u32 m0, s52, 2048
  s_add_u32 s58, s55, 32768
  buffer_load_dwordx4 v4, s[36:39], s58 offen lds
  s_add_u32 m0, s53, 1024
  s_add_u32 s61, s61, s59
  buffer_load_dwordx4 v6, s[40:43], s61 offen lds
  s_add_u32 m0, s52, 3072
  s_add_u32 s58, s55, 49152
  buffer_load_dwordx4 v5, s[36:39], s58 offen lds
  s_add_u32 m0, s52, 4096
  s_add_u32 s58, s55, 65536
  buffer_load_dwordx4 v4, s[36:39], s58 offen lds
  s_add_u32 m0, s53, 2048
  s_add_u32 s61, s61, s59
  buffer_load_dwordx4 v7, s[40:43], s61 offen lds
  s_add_u32 m0, s52, 5120
  s_add_u32 s58, s55, 81920
  buffer_load_dwordx4 v5, s[36:39], s58 offen lds
  s_add_u32 m0, s52, 6144
  s_add_u32 s58, s55, 98304
  buffer_load_dwordx4 v4, s[36:39], s58 offen lds
  s_add_u32 m0, s53, 3072
  s_add_u32 s61, s61, s59
  buffer_load_dwordx4 v7, s[40:43], s61 offen lds
  s_add_u32 m0, s52, 7168
  s_add_u32 s58, s55, 114688
  buffer_load_dwordx4 v5, s[36:39], s58 offen lds
  s_add_u32 s55, s55, 128
  s_add_u32 s56, s56, s60
  s_add_u32 s52, s52, 32768
  s_add_u32 s53, s53, 16384
  s_add_u32 s54, s54, 4096
  s_cmp_ge_u32 s52, 98304
  s_cselect_b32 s58, 98304, 0
  s_cselect_b32 s61, 49152, 0
  s_cselect_b32 s62, 12288, 0
  s_sub_u32 s52, s52, s58
  s_sub_u32 s53, s53, s61
  s_sub_u32 s54, s54, s62
  s_mov_b32 s11, 13
K1LD_25:
  s_waitcnt vmcnt(12)
  s_barrier
  s_add_u32 m0, s52, 0
  s_add_u32 s58, s55, 0
  buffer_load_dwordx4 v4, s[36:39], s58 offen lds
  s_add_u32 m0, s53, 0
  s_mov_b32 s61, s56
  buffer_load_dwordx4 v6, s[40:43], s61 offen lds
  s_add_u32 m0, s52, 1024
  s_add_u32 s58, s55, 16384
  buffer_load_dwordx4 v5, s[36:39], s58 offen lds
  s_add_u32 m0, s52, 2048
  s_add_u32 s58, s55, 32768
  buffer_load_dwordx4 v4, s[36:39], s58 offen lds
  s_add_u32 m0, s53, 1024
  s_add_u32 s61, s61, s59
  buffer_load_dwordx4 v6, s[40:43], s61 offen lds
  s_add_u32 m0, s52, 3072
  s_add_u32 s58, s55, 49152
  buffer_load_dwordx4 v5, s[36:39], s58 offen lds
  s_add_u32 m0, s52, 4096
  s_add_u32 s58, s55, 65536
  buffer_load_dwordx4 v4, s[36:39], s58 offen lds
  s_add_u32 m0, s53, 2048
  s_add_u32 s61, s61, s59
  buffer_load_dwordx4 v7, s[40:43], s61 offen lds
  s_add_u32 m0, s52, 5120
  s_add_u32 s58, s55, 81920
  buffer_load_dwordx4 v5, s[36:39], s58 offen lds
  s_add_u32 m0, s52, 6144
  s_add_u32 s58, s55, 98304
  buffer_load_dwordx4 v4, s[36:39], s58 offen lds
  s_add_u32 m0, s53, 3072
  s_add_u32 s61, s61, s59
  buffer_load_dwordx4 v7, s[40:43], s61 offen lds
  s_add_u32 m0, s52, 7168
  s_add_u32 s58, s55, 114688
  buffer_load_dwordx4 v5, s[36:39], s58 offen lds
  s_add_u32 s55, s55, 128
  s_add_u32 s56, s56, s60
  s_add_u32 s52, s52, 32768
  s_add_u32 s53, s53, 16384
  s_add_u32 s54, s54, 4096
  s_cmp_ge_u32 s52, 98304
  s_cselect_b32 s58, 98304, 0
  s_cselect_b32 s61, 49152, 0
  s_cselect_b32 s62, 12288, 0
  s_sub_u32 s52, s52, s58
  s_sub_u32 s53, s53, s61
  s_sub_u32 s54, s54, s62
  s_sub_u32 s11, s11, 1
  s_cmp_lg_u32 s11, 0
  s_cbranch_scc1 K1LD_25
  s_waitcnt vmcnt(12)
  s_barrier
  s_waitcnt vmcnt(0)
  s_lshl_b32 s9, s2, 7
  s_lshl_b32 s10, s5, 5
  s_add_u32 s9, s9, s10
  s_add_u32 s9, s9, 14680064
  v_lshlrev_b32 v10, 2, v2
  v_mov_b32 v11, 0
  s_mov_b64 exec, 0xff
  buffer_store_dword v11, v10, s[48:51], s9 offen sc0 sc1
  s_mov_b64 exec, -1
  s_barrier
  s_barrier
  s_endpgm
K1_loaderB:
  s_sub_u32 s5, s5, 4
  v_lshrrev_b32 v10, 3, v2
  s_lshl_b32 s9, s5, 6
  v_add_u32 v10, s9, v10
  v_lshlrev_b32 v10, 11, v10
  v_lshrrev_b32 v11, 4, v2
  v_and_b32 v12, 7, v2
  v_xor_b32 v12, v12, v11
  v_lshl_add_u32 v4, v12, 4, v10
  v_xor_b32 v12, 4, v12
  v_lshl_add_u32 v5, v12, 4, v10
  v_bfe_u32 v10, v2, 1, 3
  v_xor_b32 v10, v10, v11
  v_mul_lo_u32 v6, v11, s35
  v_bfe_u32 v12, v10, 1, 1
  v_mul_lo_u32 v12, v12, s15
  v_add_u32 v6, v6, v12
  v_lshrrev_b32 v12, 2, v10
  v_mul_lo_u32 v12, v12, s34
  v_add_u32 v6, v6, v12
  v_and_b32 v12, 1, v10
  v_lshl_add_u32 v6, v12, 5, v6
  v_and_b32 v12, 1, v2
  v_lshl_add_u32 v6, v12, 4, v6
  v_add_u32 v6, s14, v6
  v_bfe_u32 v10, v2, 1, 3
  v_xor_b32 v10, v10, v11
  v_xor_b32 v10, 4, v10
  v_mul_lo_u32 v7, v11, s35
  v_bfe_u32 v12, v10, 1, 1
  v_mul_lo_u32 v12, v12, s15
  v_add_u32 v7, v7, v12
  v_lshrrev_b32 v12, 2, v10
  v_mul_lo_u32 v12, v12, s34
  v_add_u32 v7, v7, v12
  v_and_b32 v12, 1, v10
  v_lshl_add_u32 v7, v12, 5, v7
  v_and_b32 v12, 1, v2
  v_lshl_add_u32 v7, v12, 4, v7
  v_add_u32 v7, s14, v7
  v_lshlrev_b32 v8, 4, v2
  v_and_b32 v12, 32, v2
  v_xor_b32 v8, v8, v12
  s_lshl_b32 s52, s5, 13
  s_lshl_b32 s53, s5, 12
  s_add_u32 s53, s53, 98304
  s_lshl_b32 s54, s5, 10
  s_mov_b32 s57, s54
  s_add_u32 s54, s54, 147456
  s_mov_b32 s55, 0
  s_lshl_b32 s59, s35, 2
  s_lshl_b32 s60, s35, 6
  s_lshl_b32 s56, s59, 2
  s_mul_i32 s56, s56, s5
  s_add_u32 m0, s52, 0
  s_add_u32 s58, s55, 0
  buffer_load_dwordx4 v4, s[36:39], s58 offen lds
  s_add_u32 m0, s53, 0
  s_mov_b32 s61, s56
  buffer_load_dwordx4 v6, s[40:43], s61 offen lds
  s_add_u32 m0, s52, 1024
  s_add_u32 s58, s55, 16384
  buffer_load_dwordx4 v5, s[36:39], s58 offen lds
  s_add_u32 m0, s52, 2048
  s_add_u32 s58, s55, 32768
  buffer_load_dwordx4 v4, s[36:39], s58 offen lds
  s_add_u32 m0, s53, 1024
  s_add_u32 s61, s61, s59
  buffer_load_dwordx4 v6, s[40:43], s61 offen lds
  s_add_u32 m0, s52, 3072
  s_add_u32 s58, s55, 49152
  buffer_load_dwordx4 v5, s[36:39], s58 offen lds
  s_add_u32 m0, s52, 4096
  s_add_u32 s58, s55, 65536
  buffer_load_dwordx4 v4, s[36:39], s58 offen lds
  s_add_u32 m0, s53, 2048
  s_add_u32 s61, s61, s59
  buffer_load_dwordx4 v7, s[40:43], s61 offen lds
  s_add_u32 m0, s52, 5120
  s_add_u32 s58, s55, 81920
  buffer_load_dwordx4 v5, s[36:39], s58 offen lds
  s_add_u32 m0, s52, 6144
  s_add_u32 s58, s55, 98304
  buffer_load_dwordx4 v4, s[36:39], s58 offen lds
  s_add_u32 m0, s53, 3072
  s_add_u32 s61, s61, s59
  buffer_load_dwordx4 v7, s[40:43], s61 offen lds
  s_add_u32 m0, s52, 7168
  s_add_u32 s58, s55, 114688
  buffer_load_dwordx4 v5, s[36:39], s58 offen lds
  s_mov_b32 m0, s54
  s_nop 0
  buffer_load_dwordx4 v8, s[44:47], s57 offen lds
  s_add_u32 s57, s57, 4096
  s_add_u32 s55, s55, 128
  s_add_u32 s56, s56, s60
  s_add_u32 s52, s52, 32768
  s_add_u32 s53, s53, 16384
  s_add_u32 s54, s54, 4096
  s_cmp_ge_u32 s52, 98304
  s_cselect_b32 s58, 98304, 0
  s_cselect_b32 s61, 49152, 0
  s_cselect_b32 s62, 12288, 0
  s_sub_u32 s52, s52, s58
  s_sub_u32 s53, s53, s61
  s_sub_u32 s54, s54, s62
  s_add_u32 m0, s52, 0
  s_add_u32 s58, s55, 0
  buffer_load_dwordx4 v4, s[36:39], s58 offen lds
  s_add_u32 m0, s53, 0
  s_mov_b32 s61, s56
  buffer_load_dwordx4 v6, s[40:43], s61 offen lds
  s_add_u32 m0, s52, 1024
  s_add_u32 s58, s55, 16384
  buffer_load_dwordx4 v5, s[36:39], s58 offen lds
  s_add_u32 m0, s52, 2048
  s_add_u32 s58, s55, 32768
  buffer_load_dwordx4 v4, s[36:39], s58 offen lds
  s_add_u32 m0, s53, 1024
  s_add_u32 s61, s61, s59
  buffer_load_dwordx4 v6, s[40:43], s61 offen lds
  s_add_u32 m0, s52, 3072
  s_add_u32 s58, s55, 49152
  buffer_load_dwordx4 v5, s[36:39], s58 offen lds
  s_add_u32 m0, s52, 4096
  s_add_u32 s58, s55, 65536
  buffer_load_dwordx4 v4, s[36:39], s58 offen lds
  s_add_u32 m0, s53, 2048
  s_add_u32 s61, s61, s59
  buffer_load_dwordx4 v7, s[40:43], s61 offen lds
  s_add_u32 m0, s52, 5120
  s_add_u32 s58, s55, 81920
  buffer_load_dwordx4 v5, s[36:39], s58 offen lds
  s_add_u32 m0, s52, 6144
  s_add_u32 s58, s55, 98304
  buffer_load_dwordx4 v4, s[36:39], s58 offen lds
  s_add_u32 m0, s53, 3072
  s_add_u32 s61, s61, s59
  buffer_load_dwordx4 v7, s[40:43], s61 offen lds
  s_add_u32 m0, s52, 7168
  s_add_u32 s58, s55, 114688
  buffer_load_dwordx4 v5, s[36:39], s58 offen lds
  s_mov_b32 m0, s54
  s_nop 0
  buffer_load_dwordx4 v8, s[44:47], s57 offen lds
  s_add_u32 s57, s57, 4096
  s_add_u32 s55, s55, 128
  s_add_u32 s56, s56, s60
  s_add_u32 s52, s52, 32768
  s_add_u32 s53, s53, 16384
  s_add_u32 s54, s54, 4096
  s_cmp_ge_u32 s52, 98304
  s_cselect_b32 s58, 98304, 0
  s_cselect_b32 s61, 49152, 0
  s_cselect_b32 s62, 12288, 0
  s_sub_u32 s52, s52, s58
  s_sub_u32 s53, s53, s61
  s_sub_u32 s54, s54, s62
  s_waitcnt vmcnt(13)
  s_barrier
  s_add_u32 m0, s52, 0
  s_add_u32 s58, s55, 0
  buffer_load_dwordx4 v4, s[36:39], s58 offen lds
  s_add_u32 m0, s53, 0
  s_mov_b32 s61, s56
  buffer_load_dwordx4 v6, s[40:43], s61 offen lds
  s_add_u32 m0, s52, 1024
  s_add_u32 s58, s55, 16384
  buffer_load_dwordx4 v5, s[36:39], s58 offen lds
  s_add_u32 m0, s52, 2048
  s_add_u32 s58, s55, 32768
  buffer_load_dwordx4 v4, s[36:39], s58 offen lds
  s_add_u32 m0, s53, 1024
  s_add_u32 s61, s61, s59
  buffer_load_dwordx4 v6, s[40:43], s61 offen lds
  s_add_u32 m0, s52, 3072
  s_add_u32 s58, s55, 49152
  buffer_load_dwordx4 v5, s[36:39], s58 offen lds
  s_add_u32 m0, s52, 4096
  s_add_u32 s58, s55, 65536
  buffer_load_dwordx4 v4, s[36:39], s58 offen lds
  s_add_u32 m0, s53, 2048
  s_add_u32 s61, s61, s59
  buffer_load_dwordx4 v7, s[40:43], s61 offen lds
  s_add_u32 m0, s52, 5120
  s_add_u32 s58, s55, 81920
  buffer_load_dwordx4 v5, s[36:39], s58 offen lds
  s_add_u32 m0, s52, 6144
  s_add_u32 s58, s55, 98304
  buffer_load_dwordx4 v4, s[36:39], s58 offen lds
  s_add_u32 m0, s53, 3072
  s_add_u32 s61, s61, s59
  buffer_load_dwordx4 v7, s[40:43], s61 offen lds
  s_add_u32 m0, s52, 7168
  s_add_u32 s58, s55, 114688
  buffer_load_dwordx4 v5, s[36:39], s58 offen lds
  s_mov_b32 m0, s54
  s_nop 0
  buffer_load_dwordx4 v8, s[44:47], s57 offen lds
  s_add_u32 s57, s57, 4096
  s_add_u32 s55, s55, 128
  s_add_u32 s56, s56, s60
  s_add_u32 s52, s52, 32768
  s_add_u32 s53, s53, 16384
  s_add_u32 s54, s54, 4096
  s_cmp_ge_u32 s52, 98304
  s_cselect_b32 s58, 98304, 0
  s_cselect_b32 s61, 49152, 0
  s_cselect_b32 s62, 12288, 0
  s_sub_u32 s52, s52, s58
  s_sub_u32 s53, s53, s61
  s_sub_u32 s54, s54, s62
  s_mov_b32 s11, 13
K1LD_26:
  s_waitcnt vmcnt(13)
  s_barrier
  s_add_u32 m0, s52, 0
  s_add_u32 s58, s55, 0
  buffer_load_dwordx4 v4, s[36:39], s58 offen lds
  s_add_u32 m0, s53, 0
  s_mov_b32 s61, s56
  buffer_load_dwordx4 v6, s[40:43], s61 offen lds
  s_add_u32 m0, s52, 1024
  s_add_u32 s58, s55, 16384
  buffer_load_dwordx4 v5, s[36:39], s58 offen lds
  s_add_u32 m0, s52, 2048
  s_add_u32 s58, s55, 32768
  buffer_load_dwordx4 v4, s[36:39], s58 offen lds
  s_add_u32 m0, s53, 1024
  s_add_u32 s61, s61, s59
  buffer_load_dwordx4 v6, s[40:43], s61 offen lds
  s_add_u32 m0, s52, 3072
  s_add_u32 s58, s55, 49152
  buffer_load_dwordx4 v5, s[36:39], s58 offen lds
  s_add_u32 m0, s52, 4096
  s_add_u32 s58, s55, 65536
  buffer_load_dwordx4 v4, s[36:39], s58 offen lds
  s_add_u32 m0, s53, 2048
  s_add_u32 s61, s61, s59
  buffer_load_dwordx4 v7, s[40:43], s61 offen lds
  s_add_u32 m0, s52, 5120
  s_add_u32 s58, s55, 81920
  buffer_load_dwordx4 v5, s[36:39], s58 offen lds
  s_add_u32 m0, s52, 6144
  s_add_u32 s58, s55, 98304
  buffer_load_dwordx4 v4, s[36:39], s58 offen lds
  s_add_u32 m0, s53, 3072
  s_add_u32 s61, s61, s59
  buffer_load_dwordx4 v7, s[40:43], s61 offen lds
  s_add_u32 m0, s52, 7168
  s_add_u32 s58, s55, 114688
  buffer_load_dwordx4 v5, s[36:39], s58 offen lds
  s_mov_b32 m0, s54
  s_nop 0
  buffer_load_dwordx4 v8, s[44:47], s57 offen lds
  s_add_u32 s57, s57, 4096
  s_add_u32 s55, s55, 128
  s_add_u32 s56, s56, s60
  s_add_u32 s52, s52, 32768
  s_add_u32 s53, s53, 16384
  s_add_u32 s54, s54, 4096
  s_cmp_ge_u32 s52, 98304
  s_cselect_b32 s58, 98304, 0
  s_cselect_b32 s61, 49152, 0
  s_cselect_b32 s62, 12288, 0
  s_sub_u32 s52, s52, s58
  s_sub_u32 s53, s53, s61
  s_sub_u32 s54, s54, s62
  s_sub_u32 s11, s11, 1
  s_cmp_lg_u32 s11, 0
  s_cbranch_scc1 K1LD_26
  s_waitcnt vmcnt(13)
  s_barrier
  s_waitcnt vmcnt(0)
  s_lshl_b32 s9, s2, 7
  s_lshl_b32 s10, s5, 5
  s_add_u32 s9, s9, s10
  s_add_u32 s9, s9, 14680064
  v_lshlrev_b32 v10, 2, v2
  v_mov_b32 v11, 0
  s_mov_b64 exec, 0xff
  buffer_store_dword v11, v10, s[48:51], s9 offen sc0 sc1
  s_mov_b64 exec, -1
  s_barrier
  s_barrier
  s_endpgm
.section .rodata,"a"
.p2align 6
.amdhsa_kernel k1_kernel
  .amdhsa_next_free_vgpr 256
  .amdhsa_next_free_sgpr 96
  .amdhsa_accum_offset 256
  .amdhsa_group_segment_fixed_size 0
  .amdhsa_kernarg_size 96
  .amdhsa_user_sgpr_count 2
  .amdhsa_user_sgpr_kernarg_segment_ptr 1
  .amdhsa_system_sgpr_workgroup_id_x 1
.end_amdhsa_kernel
.text
.globl k2_kernel
.p2align 8
.type k2_kernel,@function
k2_kernel:
  s_cmp_ge_u32 s2, 256
  s_cbranch_scc0 K2_go
  s_endpgm
K2_go:
  s_load_dwordx2 s[32:33], s[0:1], 88
  s_load_dwordx2 s[24:25], s[0:1], 24
  s_load_dwordx4 s[28:31], s[0:1], 64
  v_lshrrev_b32 v1, 6, v0
  v_and_b32 v2, 63, v0
  v_readfirstlane_b32 s5, v1
  v_lshlrev_b32 v3, 4, v2
  v_lshlrev_b32 v6, 2, v2
  s_and_b32 s3, s2, 7
  s_lshl_b32 s7, s3, 2
  s_bfe_u32 s4, s2, 0x20003
  s_add_u32 s7, s7, s4
  s_lshr_b32 s6, s2, 5
  s_lshl_b32 s8, s7, 6
  s_lshl_b32 s9, s6, 3
  s_add_u32 s8, s8, s9
  s_add_u32 s9, s8, s5
  s_lshr_b32 s27, s2, 3
  s_lshl_b32 s12, s27, 3
  s_add_u32 s12, s12, s3
  s_lshl_b32 s12, s12, 3
  s_add_u32 s12, s12, s5
  s_lshl_b32 s12, s12, 11
  s_mov_b32 s26, s3
  s_add_u32 s12, s12, 4194304
  s_add_u32 s13, s12, 1024
  s_lshl_b32 s58, s9, 12
  s_add_u32 s58, s58, 33554432
  s_lshl_b32 s14, s5, 11
  s_add_u32 s14, s14, 98304
  s_mov_b32 s15, 13893632
  s_lshl_b32 s53, s5, 12
  s_add_u32 s52, s53, 8388608
  s_mov_b32 s66, 0x07060302
  s_mov_b32 m0, s14
  s_waitcnt lgkmcnt(0)
  s_mov_b32 s48, s32
  s_and_b32 s49, s33, 0xffff
  s_mov_b32 s50, 268435456
  s_mov_b32 s51, 0x00020000
  buffer_load_dwordx4 v3, s[48:51], s12 offen lds
  s_add_u32 m0, s14, 1024
  s_nop 0
  buffer_load_dwordx4 v3, s[48:51], s13 offen lds
  s_add_u32 m0, s53, 0
  s_add_u32 s54, s52, 0
  buffer_load_dwordx4 v3, s[48:51], s54 offen lds
  s_add_u32 m0, s53, 1024
  s_add_u32 s54, s52, 1024
  buffer_load_dwordx4 v3, s[48:51], s54 offen lds
  s_add_u32 m0, s53, 2048
  s_add_u32 s54, s52, 2048
  buffer_load_dwordx4 v3, s[48:51], s54 offen lds
  s_add_u32 m0, s53, 3072
  s_add_u32 s54, s52, 3072
  buffer_load_dwordx4 v3, s[48:51], s54 offen lds
  buffer_load_dword v232, v6, s[48:51], s15 offen
  buffer_load_dword v233, v6, s[48:51], s15 offen offset:256
  s_add_u32 m0, s53, 32768
  s_add_u32 s54, s52, 32768
  buffer_load_dwordx4 v3, s[48:51], s54 offen lds
  s_add_u32 m0, s53, 33792
  s_add_u32 s54, s52, 33792
  buffer_load_dwordx4 v3, s[48:51], s54 offen lds
  s_add_u32 m0, s53, 34816
  s_add_u32 s54, s52, 34816
  buffer_load_dwordx4 v3, s[48:51], s54 offen lds
  s_add_u32 m0, s53, 35840
  s_add_u32 s54, s52, 35840
  buffer_load_dwordx4 v3, s[48:51], s54 offen lds
  s_and_b32 s3, s5, 1
  s_lshl_b32 s3, s3, 13
  v_add_u32 v4, s3, v3
  v_add_u32 v5, 0x10000, v4
  v_mov_b32 v104, 0
  v_mov_b32 v105, 0
  v_mov_b32 v106, 0
  v_mov_b32 v107, 0
  v_mov_b32 v108, 0
  v_mov_b32 v109, 0
  v_mov_b32 v110, 0
  v_mov_b32 v111, 0
  v_mov_b32 v112, 0
  v_mov_b32 v113, 0
  v_mov_b32 v114, 0
  v_mov_b32 v115, 0
  v_mov_b32 v116, 0
  v_mov_b32 v117, 0
  v_mov_b32 v118, 0
  v_mov_b32 v119, 0
  v_mov_b32 v120, 0
  v_mov_b32 v121, 0
  v_mov_b32 v122, 0
  v_mov_b32 v123, 0
  v_mov_b32 v124, 0
  v_mov_b32 v125, 0
  v_mov_b32 v126, 0
  v_mov_b32 v127, 0
  v_mov_b32 v128, 0
  v_mov_b32 v129, 0
  v_mov_b32 v130, 0
  v_mov_b32 v131, 0
  v_mov_b32 v132, 0
  v_mov_b32 v133, 0
  v_mov_b32 v134, 0
  v_mov_b32 v135, 0
  v_mov_b32 v136, 0
  v_mov_b32 v137, 0
  v_mov_b32 v138, 0
  v_mov_b32 v139, 0
  v_mov_b32 v140, 0
  v_mov_b32 v141, 0
  v_mov_b32 v142, 0
  v_mov_b32 v143, 0
  v_mov_b32 v96, 0
  v_mov_b32 v97, 0
  v_mov_b32 v98, 0
  v_mov_b32 v99, 0
  v_mov_b32 v100, 0
  v_mov_b32 v101, 0
  v_mov_b32 v102, 0
  v_mov_b32 v103, 0
  v_mov_b32 v48, 0
  v_mov_b32 v49, 0
  v_mov_b32 v50, 0
  v_mov_b32 v51, 0
  v_mov_b32 v52, 0
  v_mov_b32 v53, 0
  v_mov_b32 v54, 0
  v_mov_b32 v55, 0
  v_lshrrev_b32 v56, 4, v2
  v_lshrrev_b32 v57, 2, v2
  v_xor_b32 v56, v56, v57
  v_and_b32 v56, 1, v56
  v_cmp_eq_u32 vcc, 0, v56
  v_mov_b32 v57, 0x3f803f80
  s_nop 0
  v_cndmask_b32 v144, 0, v57, vcc
  v_mov_b32 v145, v144
  v_mov_b32 v146, v144
  v_mov_b32 v147, v144
  s_lshl_b32 s3, s5, 12
  s_add_u32 s4, s3, 147456
  s_cmp_ge_u32 s5, 4
  s_cselect_b32 s4, s3, s4
  s_add_u32 s3, s3, 32768
  s_bitcmp1_b32 s2, 3
  s_cselect_b32 s3, s4, s3
  v_add_u32 v248, s3, v3
  v_xor_b32 v249, 4096, v248
  s_lshl_b32 s3, s5, 8
  s_add_u32 s3, s3, 81920
  v_add_u32 v250, s3, v6
  v_xor_b32 v251, 256, v250
  s_xor_b32 s10, s5, 1
  s_lshr_b32 s3, s5, 1
  s_lshl_b32 s3, s3, 10
  s_and_b32 s4, s5, 1
  s_lshl_b32 s4, s4, 3
  s_add_u32 s3, s3, s4
  s_add_u32 s3, s3, 131072
  v_add_u32 v252, s3, v3
  s_lshr_b32 s3, s5, 1
  s_lshl_b32 s3, s3, 5
  s_add_u32 s3, s3, s4
  s_add_u32 s3, s3, 135168
  v_and_b32 v56, 2, v2
  v_lshlrev_b32 v56, 3, v56
  v_and_b32 v57, 1, v2
  v_lshl_add_u32 v56, v57, 2, v56
  v_bfe_u32 v57, v2, 4, 1
  v_lshl_add_u32 v56, v57, 1, v56
  v_add_u32 v253, s3, v56
  v_lshrrev_b32 v56, 5, v2
  v_lshlrev_b32 v56, 4, v56
  v_add_u32 v254, 135168, v56
  s_lshl_b32 s3, s6, 3
  s_add_u32 s3, s3, s5
  s_lshl_b32 s3, s3, 16
  s_lshl_b32 s4, s7, 11
  s_add_u32 s3, s3, s4
  s_add_u32 s59, s3, 16777216
  s_lshr_b32 s3, s3, 9
  s_add_u32 s64, s3, 14680064
  s_lshl_b32 s3, s26, 3
  s_add_u32 s3, s3, s5
  s_lshl_b32 s3, s3, 16
  s_lshl_b32 s4, s27, 11
  s_add_u32 s3, s3, s4
  s_add_u32 s60, s3, 20971520
  s_lshr_b32 s3, s3, 9
  s_add_u32 s65, s3, 14688256
  s_and_b32 s3, s2, 7
  s_bfe_u32 s63, s2, 0x10003
  s_lshr_b32 s4, s2, 4
  s_lshl_b32 s8, s3, 1
  s_and_b32 s9, s4, 1
  s_add_u32 s8, s8, s9
  s_lshr_b32 s9, s4, 1
  s_lshr_b32 s16, s3, 1
  s_lshl_b32 s16, s16, 2
  s_and_b32 s11, s4, 3
  s_add_u32 s16, s16, s11
  s_and_b32 s11, s3, 1
  s_lshl_b32 s11, s11, 2
  s_lshr_b32 s4, s4, 2
  s_add_u32 s11, s11, s4
  s_cmp_eq_u32 s63, 0
  s_cselect_b32 s61, s16, s8
  s_cselect_b32 s62, s11, s9
  s_mov_b32 s44, s30
  s_and_b32 s45, s31, 0xffff
  s_mov_b32 s46, 8388608
  s_mov_b32 s47, 0x00020000
  s_mov_b32 s24, s24
  s_and_b32 s25, s25, 0xffff
  s_mov_b32 s26, 2097152
  s_mov_b32 s27, 0x00020000
  s_mov_b32 s28, s28
  s_and_b32 s29, s29, 0xffff
  s_mov_b32 s30, 2097152
  s_mov_b32 s31, 0x00020000
  s_cmp_eq_u32 s63, 0
  s_cselect_b32 s8, s24, s28
  s_cselect_b32 s9, s25, s29
  s_mov_b32 s40, s8
  s_and_b32 s41, s9, 0xffff
  s_mov_b32 s42, 2097152
  s_mov_b32 s43, 0x00020000
  s_lshl_b32 s8, s61, 18
  s_lshl_b32 s9, s63, 22
  s_add_u32 s8, s8, s9
  s_add_u32 s8, s8, 16777216
  s_add_u32 s8, s32, s8
  s_addc_u32 s9, s33, 0
  s_mov_b32 s36, s8
  s_and_b32 s37, s9, 0xffff
  s_mov_b32 s38, 262144
  s_mov_b32 s39, 0x00020000
  s_lshl_b32 s8, s61, 2
  s_and_b32 s9, s5, 3
  s_add_u32 s8, s8, s9
  s_lshl_b32 s8, s8, 7
  s_lshl_b32 s9, s63, 13
  s_add_u32 s8, s8, s9
  s_add_u32 s34, s8, 14680064
  s_mov_b32 s35, s5
  s_getreg_b32 s8, hwreg(HW_REG_XCC_ID, 0, 4)
  s_add_u32 s69, s8, 1
  s_and_b32 s8, s2, 7
  s_lshl_b32 s8, s8, 7
  s_add_u32 s68, s8, 14696448
  s_lshr_b32 s8, s2, 3
  s_lshl_b32 s8, s8, 2
  s_add_u32 s8, s8, s68
  v_mov_b32 v56, s69
  v_mov_b32 v57, 0
  s_cmp_eq_u32 s5, 7
  s_cselect_b64 exec, 1, 0
  buffer_store_dword v56, v57, s[48:51], s8 offen sc0 sc1
  s_mov_b64 exec, -1
  s_lshl_b32 s3, s7, 17
  s_lshl_b32 s4, s5, 10
  s_add_u32 s3, s3, s4
  s_add_u32 s56, s3, 9437184
  v_lshrrev_b32 v56, 2, v2
  v_lshlrev_b32 v56, 8, v56
  v_and_b32 v57, 3, v2
  v_lshl_add_u32 v7, v57, 3, v56
  s_lshl_b32 s3, s7, 12
  s_lshl_b32 s4, s5, 5
  s_add_u32 s3, s3, s4
  s_add_u32 s57, s3, 13631488
  v_add_u32 v72, s14, v3
  s_lshl_b32 s10, s10, 11
  s_add_u32 s10, s10, 98304
  v_add_u32 v73, s10, v3
  s_waitcnt vmcnt(7)
  s_barrier
  ds_read_b128 v[8:11], v73 offset:0
  ds_read_b128 v[24:27], v4 offset:0
  ds_read_b128 v[12:15], v73 offset:1024
  ds_read_b128 v[28:31], v4 offset:1024
  ds_read_b128 v[16:19], v72 offset:0
  ds_read_b128 v[20:23], v72 offset:1024
  ds_read_b128 v[40:43], v4 offset:16384
  ds_read_b128 v[44:47], v4 offset:17408
  ds_read_b128 v[32:35], v4 offset:2048
  ds_read_b128 v[36:39], v4 offset:3072
  v_mov_b32 v234, 0
  v_mov_b32 v235, 0
  s_waitcnt vmcnt(6)
  v_max_f32_dpp v232, v232, v232 row_shr:1
  s_waitcnt vmcnt(5)
  v_max_f32_dpp v233, v233, v233 row_shr:1
  v_max_f32_dpp v232, v232, v232 row_shr:2
  s_nop 0
  v_max_f32_dpp v233, v233, v233 row_shr:2
  v_max_f32_dpp v232, v232, v232 row_shr:4
  s_nop 0
  v_max_f32_dpp v233, v233, v233 row_shr:4
  v_max_f32_dpp v232, v232, v232 row_shr:8
  s_nop 0
  v_max_f32_dpp v233, v233, v233 row_shr:8
  v_max_f32_dpp v232, v232, v232 row_bcast:15 row_mask:0xa
  s_nop 0
  v_max_f32_dpp v233, v233, v233 row_bcast:15 row_mask:0xa
  v_max_f32_dpp v232, v232, v232 row_bcast:31 row_mask:0xc
  s_nop 0
  v_max_f32_dpp v233, v233, v233 row_bcast:31 row_mask:0xc
  s_waitcnt lgkmcnt(8)
  v_mfma_f32_32x32x16_bf16 v[56:71], v[24:27], v[8:11], 0
  s_waitcnt lgkmcnt(6)
  v_mfma_f32_32x32x16_bf16 v[56:71], v[28:31], v[12:15], v[56:71]
  v_dot2c_f32_bf16 v234, v8, v8
  s_waitcnt lgkmcnt(5)
  v_dot2c_f32_bf16 v235, v16, v16
  v_dot2c_f32_bf16 v234, v9, v9
  v_dot2c_f32_bf16 v235, v17, v17
  v_dot2c_f32_bf16 v234, v10, v10
  v_dot2c_f32_bf16 v235, v18, v18
  v_dot2c_f32_bf16 v234, v11, v11
  v_dot2c_f32_bf16 v235, v19, v19
  v_dot2c_f32_bf16 v234, v12, v12
  s_waitcnt lgkmcnt(4)
  v_dot2c_f32_bf16 v235, v20, v20
  v_dot2c_f32_bf16 v234, v13, v13
  v_dot2c_f32_bf16 v235, v21, v21
  v_dot2c_f32_bf16 v234, v14, v14
  v_dot2c_f32_bf16 v235, v22, v22
  v_dot2c_f32_bf16 v234, v15, v15
  v_dot2c_f32_bf16 v235, v23, v23
  v_readlane_b32 s3, v232, 63
  v_readlane_b32 s4, v233, 63
  v_mov_b32 v236, v234
  v_mov_b32 v237, v235
  s_mov_b32 s8, 1163165696
  s_mov_b32 s9, 1484783616
  v_permlane32_swap_b32 v234, v236
  v_permlane32_swap_b32 v235, v237
  v_add_f32 v234, v234, v236
  v_add_f32 v235, v235, v237
  v_mov_b32 v236, s4
  v_mul_f32 v234, s3, v234
  v_mul_f32 v235, s3, v235
  s_mov_b32 s10, 813694976
  v_cmp_nge_f32 s[20:21], s9, v236
  v_cmp_nle_f32 s[22:23], s10, v236
  v_cmp_nge_f32 s[16:17], s8, v234
  v_cmp_nge_f32 s[18:19], s8, v235
  s_or_b64 s[20:21], s[20:21], s[22:23]
  s_or_b64 s[16:17], s[16:17], s[18:19]
  s_or_b64 s[16:17], s[16:17], s[20:21]
  s_or_b32 s67, s16, s17
  s_setprio 2
  v_mfma_f32_32x32x16_bf16 v[72:87], v[24:27], v[16:19], 0
  v_exp_f32 v56, v56
  v_exp_f32 v57, v57
  v_exp_f32 v58, v58
  v_exp_f32 v59, v59
  v_perm_b32 v88, v57, v56, s66
  v_mfma_f32_32x32x16_bf16 v[120:135], v[48:51], v[96:99], v[120:135]
  v_exp_f32 v60, v60
  v_exp_f32 v61, v61
  v_perm_b32 v89, v59, v58, s66
  v_exp_f32 v62, v62
  v_exp_f32 v63, v63
  s_add_u32 m0, s53, 65536
  s_add_u32 s54, s52, 65536
  buffer_load_dwordx4 v3, s[48:51], s54 offen lds
  v_mfma_f32_32x32x16_bf16 v[72:87], v[28:31], v[20:23], v[72:87]
  v_perm_b32 v90, v61, v60, s66
  v_exp_f32 v64, v64
  v_exp_f32 v65, v65
  v_perm_b32 v91, v63, v62, s66
  v_exp_f32 v66, v66
  v_mfma_f32_16x16x32_bf16 v[140:143], v[144:147], v[96:99], v[140:143]
  v_exp_f32 v67, v67
  v_perm_b32 v92, v65, v64, s66
  v_mfma_f32_32x32x16_bf16 v[120:135], v[52:55], v[100:103], v[120:135]
  v_exp_f32 v68, v68
  v_exp_f32 v69, v69
  v_perm_b32 v93, v67, v66, s66
  v_exp_f32 v70, v70
  v_exp_f32 v71, v71
  v_mfma_f32_16x16x32_bf16 v[140:143], v[144:147], v[100:103], v[140:143]
  v_perm_b32 v94, v69, v68, s66
  v_perm_b32 v95, v71, v70, s66
  s_setprio 1
  s_waitcnt lgkmcnt(1)
  v_mfma_f32_32x32x16_bf16 v[56:71], v[32:35], v[8:11], 0
  v_exp_f32 v72, v72
  v_exp_f32 v73, v73
  v_exp_f32 v74, v74
  v_exp_f32 v75, v75
  v_perm_b32 v96, v73, v72, s66
  v_mfma_f32_32x32x16_bf16 v[104:119], v[40:43], v[88:91], v[104:119]
  v_exp_f32 v76, v76
  v_exp_f32 v77, v77
  v_perm_b32 v97, v75, v74, s66
  v_exp_f32 v78, v78
  v_exp_f32 v79, v79
  s_add_u32 m0, s53, 66560
  s_add_u32 s54, s52, 66560
  buffer_load_dwordx4 v3, s[48:51], s54 offen lds
  s_waitcnt lgkmcnt(0)
  v_mfma_f32_32x32x16_bf16 v[56:71], v[36:39], v[12:15], v[56:71]
  v_perm_b32 v98, v77, v76, s66
  v_exp_f32 v80, v80
  v_exp_f32 v81, v81
  v_perm_b32 v99, v79, v78, s66
  v_exp_f32 v82, v82
  ds_read_b128 v[48:51], v4 offset:18432
  v_mfma_f32_16x16x32_bf16 v[136:139], v[144:147], v[88:91], v[136:139]
  v_exp_f32 v83, v83
  v_perm_b32 v100, v81, v80, s66
  ds_read_b128 v[52:55], v4 offset:19456
  v_mfma_f32_32x32x16_bf16 v[104:119], v[44:47], v[92:95], v[104:119]
  v_exp_f32 v84, v84
  v_exp_f32 v85, v85
  v_perm_b32 v101, v83, v82, s66
  v_exp_f32 v86, v86
  v_exp_f32 v87, v87
  ds_read_b128 v[24:27], v4 offset:4096
  v_mfma_f32_16x16x32_bf16 v[136:139], v[144:147], v[92:95], v[136:139]
  v_perm_b32 v102, v85, v84, s66
  v_perm_b32 v103, v87, v86, s66
  ds_read_b128 v[28:31], v4 offset:5120
  v_mfma_f32_32x32x16_bf16 v[72:87], v[32:35], v[16:19], 0
  v_exp_f32 v56, v56
  v_exp_f32 v57, v57
  v_exp_f32 v58, v58
  v_exp_f32 v59, v59
  v_perm_b32 v88, v57, v56, s66
  v_mfma_f32_32x32x16_bf16 v[120:135], v[40:43], v[96:99], v[120:135]
  v_exp_f32 v60, v60
  v_exp_f32 v61, v61
  v_perm_b32 v89, v59, v58, s66
  v_exp_f32 v62, v62
  v_exp_f32 v63, v63
  s_add_u32 m0, s53, 67584
  s_add_u32 s54, s52, 67584
  buffer_load_dwordx4 v3, s[48:51], s54 offen lds
  v_mfma_f32_32x32x16_bf16 v[72:87], v[36:39], v[20:23], v[72:87]
  v_perm_b32 v90, v61, v60, s66
  v_exp_f32 v64, v64
  v_exp_f32 v65, v65
  v_perm_b32 v91, v63, v62, s66
  v_exp_f32 v66, v66
  v_mfma_f32_16x16x32_bf16 v[140:143], v[144:147], v[96:99], v[140:143]
  v_exp_f32 v67, v67
  v_perm_b32 v92, v65, v64, s66
  v_mfma_f32_32x32x16_bf16 v[120:135], v[44:47], v[100:103], v[120:135]
  v_exp_f32 v68, v68
  v_exp_f32 v69, v69
  v_perm_b32 v93, v67, v66, s66
  v_exp_f32 v70, v70
  v_exp_f32 v71, v71
  v_mfma_f32_16x16x32_bf16 v[140:143], v[144:147], v[100:103], v[140:143]
  v_perm_b32 v94, v69, v68, s66
  v_perm_b32 v95, v71, v70, s66
  s_setprio 0
  s_waitcnt lgkmcnt(1)
  v_mfma_f32_32x32x16_bf16 v[56:71], v[24:27], v[8:11], 0
  v_exp_f32 v72, v72
  v_exp_f32 v73, v73
  v_exp_f32 v74, v74
  v_exp_f32 v75, v75
  v_perm_b32 v96, v73, v72, s66
  v_mfma_f32_32x32x16_bf16 v[104:119], v[48:51], v[88:91], v[104:119]
  v_exp_f32 v76, v76
  v_exp_f32 v77, v77
  v_perm_b32 v97, v75, v74, s66
  v_exp_f32 v78, v78
  v_exp_f32 v79, v79
  s_add_u32 m0, s53, 68608
  s_add_u32 s54, s52, 68608
  buffer_load_dwordx4 v3, s[48:51], s54 offen lds
  s_waitcnt lgkmcnt(0)
  v_mfma_f32_32x32x16_bf16 v[56:71], v[28:31], v[12:15], v[56:71]
  v_perm_b32 v98, v77, v76, s66
  v_exp_f32 v80, v80
  v_exp_f32 v81, v81
  v_perm_b32 v99, v79, v78, s66
  v_exp_f32 v82, v82
  ds_read_b128 v[40:43], v4 offset:20480
  v_mfma_f32_16x16x32_bf16 v[136:139], v[144:147], v[88:91], v[136:139]
  v_exp_f32 v83, v83
  v_perm_b32 v100, v81, v80, s66
  ds_read_b128 v[44:47], v4 offset:21504
  v_mfma_f32_32x32x16_bf16 v[104:119], v[52:55], v[92:95], v[104:119]
  v_exp_f32 v84, v84
  v_exp_f32 v85, v85
  v_perm_b32 v101, v83, v82, s66
  v_exp_f32 v86, v86
  v_exp_f32 v87, v87
  ds_read_b128 v[32:35], v4 offset:6144
  v_mfma_f32_16x16x32_bf16 v[136:139], v[144:147], v[92:95], v[136:139]
  v_perm_b32 v102, v85, v84, s66
  v_perm_b32 v103, v87, v86, s66
  ds_read_b128 v[36:39], v4 offset:7168
  v_mfma_f32_32x32x16_bf16 v[72:87], v[24:27], v[16:19], 0
  v_exp_f32 v56, v56
  v_exp_f32 v57, v57
  v_exp_f32 v58, v58
  v_exp_f32 v59, v59
  v_perm_b32 v88, v57, v56, s66
  buffer_load_dwordx4 v[164:167], v3, s[48:51], s56 offen
  s_add_u32 s56, s56, 8192
  v_mfma_f32_32x32x16_bf16 v[120:135], v[48:51], v[96:99], v[120:135]
  v_exp_f32 v60, v60
  v_exp_f32 v61, v61
  v_perm_b32 v89, v59, v58, s66
  v_exp_f32 v62, v62
  v_exp_f32 v63, v63
  v_mfma_f32_32x32x16_bf16 v[72:87], v[28:31], v[20:23], v[72:87]
  v_perm_b32 v90, v61, v60, s66
  v_exp_f32 v64, v64
  v_exp_f32 v65, v65
  v_perm_b32 v91, v63, v62, s66
  v_exp_f32 v66, v66
  v_mfma_f32_16x16x32_bf16 v[140:143], v[144:147], v[96:99], v[140:143]
  v_exp_f32 v67, v67
  v_perm_b32 v92, v65, v64, s66
  v_mfma_f32_32x32x16_bf16 v[120:135], v[52:55], v[100:103], v[120:135]
  v_exp_f32 v68, v68
  v_exp_f32 v69, v69
  v_perm_b32 v93, v67, v66, s66
  v_exp_f32 v70, v70
  v_exp_f32 v71, v71
  buffer_load_dwordx4 v[168:171], v3, s[48:51], s56 offen
  s_add_u32 s56, s56, 8192
  v_mfma_f32_16x16x32_bf16 v[140:143], v[144:147], v[100:103], v[140:143]
  v_perm_b32 v94, v69, v68, s66
  v_perm_b32 v95, v71, v70, s66
  s_waitcnt vmcnt(7)
  s_barrier
  s_setprio 3
  s_waitcnt lgkmcnt(1)
  v_mfma_f32_32x32x16_bf16 v[56:71], v[32:35], v[8:11], 0
  v_exp_f32 v72, v72
  v_exp_f32 v73, v73
  v_exp_f32 v74, v74
  v_exp_f32 v75, v75
  v_perm_b32 v96, v73, v72, s66
  buffer_load_dwordx4 v[172:175], v3, s[48:51], s56 offen
  s_add_u32 s56, s56, 8192
  v_mfma_f32_32x32x16_bf16 v[104:119], v[40:43], v[88:91], v[104:119]
  v_exp_f32 v76, v76
  v_exp_f32 v77, v77
  v_perm_b32 v97, v75, v74, s66
  v_exp_f32 v78, v78
  v_exp_f32 v79, v79
  s_add_u32 m0, s53, 98304
  s_add_u32 s54, s52, 98304
  buffer_load_dwordx4 v3, s[48:51], s54 offen lds
  s_waitcnt lgkmcnt(0)
  v_mfma_f32_32x32x16_bf16 v[56:71], v[36:39], v[12:15], v[56:71]
  v_perm_b32 v98, v77, v76, s66
  v_exp_f32 v80, v80
  v_exp_f32 v81, v81
  v_perm_b32 v99, v79, v78, s66
  v_exp_f32 v82, v82
  ds_read_b128 v[48:51], v4 offset:22528
  v_mfma_f32_16x16x32_bf16 v[136:139], v[144:147], v[88:91], v[136:139]
  v_exp_f32 v83, v83
  v_perm_b32 v100, v81, v80, s66
  ds_read_b128 v[52:55], v4 offset:23552
  v_mfma_f32_32x32x16_bf16 v[104:119], v[44:47], v[92:95], v[104:119]
  v_exp_f32 v84, v84
  v_exp_f32 v85, v85
  v_perm_b32 v101, v83, v82, s66
  v_exp_f32 v86, v86
  v_exp_f32 v87, v87
  ds_read_b128 v[24:27], v4 offset:32768
  buffer_load_dwordx4 v[176:179], v3, s[48:51], s56 offen
  s_add_u32 s56, s56, 8192
  v_mfma_f32_16x16x32_bf16 v[136:139], v[144:147], v[92:95], v[136:139]
  v_perm_b32 v102, v85, v84, s66
  v_perm_b32 v103, v87, v86, s66
  ds_read_b128 v[28:31], v4 offset:33792
  v_mfma_f32_32x32x16_bf16 v[72:87], v[32:35], v[16:19], 0
  v_exp_f32 v56, v56
  v_exp_f32 v57, v57
  v_exp_f32 v58, v58
  v_exp_f32 v59, v59
  v_perm_b32 v88, v57, v56, s66
  buffer_load_dwordx4 v[180:183], v3, s[48:51], s56 offen
  s_add_u32 s56, s56, 8192
  v_mfma_f32_32x32x16_bf16 v[120:135], v[40:43], v[96:99], v[120:135]
  v_exp_f32 v60, v60
  v_exp_f32 v61, v61
  v_perm_b32 v89, v59, v58, s66
  v_exp_f32 v62, v62
  v_exp_f32 v63, v63
  s_add_u32 m0, s53, 99328
  s_add_u32 s54, s52, 99328
  buffer_load_dwordx4 v3, s[48:51], s54 offen lds
  v_mfma_f32_32x32x16_bf16 v[72:87], v[36:39], v[20:23], v[72:87]
  v_perm_b32 v90, v61, v60, s66
  v_exp_f32 v64, v64
  v_exp_f32 v65, v65
  v_perm_b32 v91, v63, v62, s66
  v_exp_f32 v66, v66
  v_mfma_f32_16x16x32_bf16 v[140:143], v[144:147], v[96:99], v[140:143]
  v_exp_f32 v67, v67
  v_perm_b32 v92, v65, v64, s66
  v_mfma_f32_32x32x16_bf16 v[120:135], v[44:47], v[100:103], v[120:135]
  v_exp_f32 v68, v68
  v_exp_f32 v69, v69
  v_perm_b32 v93, v67, v66, s66
  v_exp_f32 v70, v70
  v_exp_f32 v71, v71
  buffer_load_dwordx4 v[184:187], v3, s[48:51], s56 offen
  s_add_u32 s56, s56, 8192
  v_mfma_f32_16x16x32_bf16 v[140:143], v[144:147], v[100:103], v[140:143]
  v_perm_b32 v94, v69, v68, s66
  v_perm_b32 v95, v71, v70, s66
  s_setprio 2
  s_waitcnt lgkmcnt(1)
  v_mfma_f32_32x32x16_bf16 v[56:71], v[24:27], v[8:11], 0
  v_exp_f32 v72, v72
  v_exp_f32 v73, v73
  v_exp_f32 v74, v74
  v_exp_f32 v75, v75
  v_perm_b32 v96, v73, v72, s66
  buffer_load_dwordx4 v[188:191], v3, s[48:51], s56 offen
  s_add_u32 s56, s56, 8192
  v_mfma_f32_32x32x16_bf16 v[104:119], v[48:51], v[88:91], v[104:119]
  v_exp_f32 v76, v76
  v_exp_f32 v77, v77
  v_perm_b32 v97, v75, v74, s66
  v_exp_f32 v78, v78
  v_exp_f32 v79, v79
  s_waitcnt lgkmcnt(0)
  v_mfma_f32_32x32x16_bf16 v[56:71], v[28:31], v[12:15], v[56:71]
  v_perm_b32 v98, v77, v76, s66
  v_exp_f32 v80, v80
  v_exp_f32 v81, v81
  v_perm_b32 v99, v79, v78, s66
  v_exp_f32 v82, v82
  ds_read_b128 v[40:43], v4 offset:49152
  v_mfma_f32_16x16x32_bf16 v[136:139], v[144:147], v[88:91], v[136:139]
  v_exp_f32 v83, v83
  v_perm_b32 v100, v81, v80, s66
  ds_read_b128 v[44:47], v4 offset:50176
  v_mfma_f32_32x32x16_bf16 v[104:119], v[52:55], v[92:95], v[104:119]
  v_exp_f32 v84, v84
  v_exp_f32 v85, v85
  v_perm_b32 v101, v83, v82, s66
  v_exp_f32 v86, v86
  v_exp_f32 v87, v87
  ds_read_b128 v[32:35], v4 offset:34816
  buffer_load_dwordx4 v[192:195], v3, s[48:51], s56 offen
  s_add_u32 s56, s56, 8192
  v_mfma_f32_16x16x32_bf16 v[136:139], v[144:147], v[92:95], v[136:139]
  v_perm_b32 v102, v85, v84, s66
  v_perm_b32 v103, v87, v86, s66
  ds_read_b128 v[36:39], v4 offset:35840
  v_mfma_f32_32x32x16_bf16 v[72:87], v[24:27], v[16:19], 0
  v_exp_f32 v56, v56
  v_exp_f32 v57, v57
  v_exp_f32 v58, v58
  v_exp_f32 v59, v59
  v_perm_b32 v88, v57, v56, s66
  buffer_load_dwordx4 v[196:199], v3, s[48:51], s56 offen
  s_add_u32 s56, s56, 8192
  v_mfma_f32_32x32x16_bf16 v[120:135], v[48:51], v[96:99], v[120:135]
  v_exp_f32 v60, v60
  v_exp_f32 v61, v61
  v_perm_b32 v89, v59, v58, s66
  v_exp_f32 v62, v62
  v_exp_f32 v63, v63
  s_add_u32 m0, s53, 100352
  s_add_u32 s54, s52, 100352
  buffer_load_dwordx4 v3, s[48:51], s54 offen lds
  v_mfma_f32_32x32x16_bf16 v[72:87], v[28:31], v[20:23], v[72:87]
  v_perm_b32 v90, v61, v60, s66
  v_exp_f32 v64, v64
  v_exp_f32 v65, v65
  v_perm_b32 v91, v63, v62, s66
  v_exp_f32 v66, v66
  v_mfma_f32_16x16x32_bf16 v[140:143], v[144:147], v[96:99], v[140:143]
  v_exp_f32 v67, v67
  v_perm_b32 v92, v65, v64, s66
  v_mfma_f32_32x32x16_bf16 v[120:135], v[52:55], v[100:103], v[120:135]
  v_exp_f32 v68, v68
  v_exp_f32 v69, v69
  v_perm_b32 v93, v67, v66, s66
  v_exp_f32 v70, v70
  v_exp_f32 v71, v71
  buffer_load_dwordx4 v[200:203], v3, s[48:51], s56 offen
  s_add_u32 s56, s56, 8192
  v_mfma_f32_16x16x32_bf16 v[140:143], v[144:147], v[100:103], v[140:143]
  v_perm_b32 v94, v69, v68, s66
  v_perm_b32 v95, v71, v70, s66
  s_setprio 1
  s_waitcnt lgkmcnt(1)
  v_mfma_f32_32x32x16_bf16 v[56:71], v[32:35], v[8:11], 0
  v_exp_f32 v72, v72
  v_exp_f32 v73, v73
  v_exp_f32 v74, v74
  v_exp_f32 v75, v75
  v_perm_b32 v96, v73, v72, s66
  buffer_load_dwordx4 v[204:207], v3, s[48:51], s56 offen
  s_add_u32 s56, s56, 8192
  v_mfma_f32_32x32x16_bf16 v[104:119], v[40:43], v[88:91], v[104:119]
  v_exp_f32 v76, v76
  v_exp_f32 v77, v77
  v_perm_b32 v97, v75, v74, s66
  v_exp_f32 v78, v78
  v_exp_f32 v79, v79
  s_waitcnt lgkmcnt(0)
  v_mfma_f32_32x32x16_bf16 v[56:71], v[36:39], v[12:15], v[56:71]
  v_perm_b32 v98, v77, v76, s66
  v_exp_f32 v80, v80
  v_exp_f32 v81, v81
  v_perm_b32 v99, v79, v78, s66
  v_exp_f32 v82, v82
  ds_read_b128 v[48:51], v4 offset:51200
  v_mfma_f32_16x16x32_bf16 v[136:139], v[144:147], v[88:91], v[136:139]
  v_exp_f32 v83, v83
  v_perm_b32 v100, v81, v80, s66
  ds_read_b128 v[52:55], v4 offset:52224
  v_mfma_f32_32x32x16_bf16 v[104:119], v[44:47], v[92:95], v[104:119]
  v_exp_f32 v84, v84
  v_exp_f32 v85, v85
  v_perm_b32 v101, v83, v82, s66
  v_exp_f32 v86, v86
  v_exp_f32 v87, v87
  ds_read_b128 v[24:27], v4 offset:36864
  buffer_load_dwordx4 v[208:211], v3, s[48:51], s56 offen
  s_add_u32 s56, s56, 8192
  v_mfma_f32_16x16x32_bf16 v[136:139], v[144:147], v[92:95], v[136:139]
  v_perm_b32 v102, v85, v84, s66
  v_perm_b32 v103, v87, v86, s66
  ds_read_b128 v[28:31], v4 offset:37888
  v_mfma_f32_32x32x16_bf16 v[72:87], v[32:35], v[16:19], 0
  v_exp_f32 v56, v56
  v_exp_f32 v57, v57
  v_exp_f32 v58, v58
  v_exp_f32 v59, v59
  v_perm_b32 v88, v57, v56, s66
  buffer_load_dwordx4 v[212:215], v3, s[48:51], s56 offen
  s_add_u32 s56, s56, 8192
  v_mfma_f32_32x32x16_bf16 v[120:135], v[40:43], v[96:99], v[120:135]
  v_exp_f32 v60, v60
  v_exp_f32 v61, v61
  v_perm_b32 v89, v59, v58, s66
  v_exp_f32 v62, v62
  v_exp_f32 v63, v63
  s_add_u32 m0, s53, 101376
  s_add_u32 s54, s52, 101376
  buffer_load_dwordx4 v3, s[48:51], s54 offen lds
  v_mfma_f32_32x32x16_bf16 v[72:87], v[36:39], v[20:23], v[72:87]
  v_perm_b32 v90, v61, v60, s66
  v_exp_f32 v64, v64
  v_exp_f32 v65, v65
  v_perm_b32 v91, v63, v62, s66
  v_exp_f32 v66, v66
  v_mfma_f32_16x16x32_bf16 v[140:143], v[144:147], v[96:99], v[140:143]
  v_exp_f32 v67, v67
  v_perm_b32 v92, v65, v64, s66
  v_mfma_f32_32x32x16_bf16 v[120:135], v[44:47], v[100:103], v[120:135]
  v_exp_f32 v68, v68
  v_exp_f32 v69, v69
  v_perm_b32 v93, v67, v66, s66
  v_exp_f32 v70, v70
  v_exp_f32 v71, v71
  buffer_load_dwordx4 v[216:219], v3, s[48:51], s56 offen
  s_add_u32 s56, s56, 8192
  v_mfma_f32_16x16x32_bf16 v[140:143], v[144:147], v[100:103], v[140:143]
  v_perm_b32 v94, v69, v68, s66
  v_perm_b32 v95, v71, v70, s66
  s_setprio 0
  s_waitcnt lgkmcnt(1)
  v_mfma_f32_32x32x16_bf16 v[56:71], v[24:27], v[8:11], 0
  v_exp_f32 v72, v72
  v_exp_f32 v73, v73
  v_exp_f32 v74, v74
  v_exp_f32 v75, v75
  v_perm_b32 v96, v73, v72, s66
  buffer_load_dwordx4 v[220:223], v3, s[48:51], s56 offen
  s_add_u32 s56, s56, 8192
  v_mfma_f32_32x32x16_bf16 v[104:119], v[48:51], v[88:91], v[104:119]
  v_exp_f32 v76, v76
  v_exp_f32 v77, v77
  v_perm_b32 v97, v75, v74, s66
  v_exp_f32 v78, v78
  v_exp_f32 v79, v79
  s_waitcnt lgkmcnt(0)
  v_mfma_f32_32x32x16_bf16 v[56:71], v[28:31], v[12:15], v[56:71]
  v_perm_b32 v98, v77, v76, s66
  v_exp_f32 v80, v80
  v_exp_f32 v81, v81
  v_perm_b32 v99, v79, v78, s66
  v_exp_f32 v82, v82
  ds_read_b128 v[40:43], v4 offset:53248
  v_mfma_f32_16x16x32_bf16 v[136:139], v[144:147], v[88:91], v[136:139]
  v_exp_f32 v83, v83
  v_perm_b32 v100, v81, v80, s66
  ds_read_b128 v[44:47], v4 offset:54272
  v_mfma_f32_32x32x16_bf16 v[104:119], v[52:55], v[92:95], v[104:119]
  v_exp_f32 v84, v84
  v_exp_f32 v85, v85
  v_perm_b32 v101, v83, v82, s66
  v_exp_f32 v86, v86
  v_exp_f32 v87, v87
  ds_read_b128 v[32:35], v4 offset:38912
  buffer_load_dwordx4 v[224:227], v3, s[48:51], s56 offen
  v_mfma_f32_16x16x32_bf16 v[136:139], v[144:147], v[92:95], v[136:139]
  v_perm_b32 v102, v85, v84, s66
  v_perm_b32 v103, v87, v86, s66
  ds_read_b128 v[36:39], v4 offset:39936
  v_mfma_f32_32x32x16_bf16 v[72:87], v[24:27], v[16:19], 0
  v_exp_f32 v56, v56
  v_exp_f32 v57, v57
  v_exp_f32 v58, v58
  v_exp_f32 v59, v59
  v_perm_b32 v88, v57, v56, s66
  buffer_load_dwordx2 v[228:229], v7, s[48:51], s57 offen
  v_mfma_f32_32x32x16_bf16 v[120:135], v[48:51], v[96:99], v[120:135]
  v_exp_f32 v60, v60
  v_exp_f32 v61, v61
  v_perm_b32 v89, v59, v58, s66
  v_exp_f32 v62, v62
  v_exp_f32 v63, v63
  v_mfma_f32_32x32x16_bf16 v[72:87], v[28:31], v[20:23], v[72:87]
  v_perm_b32 v90, v61, v60, s66
  v_exp_f32 v64, v64
  v_exp_f32 v65, v65
  v_perm_b32 v91, v63, v62, s66
  v_exp_f32 v66, v66
  v_mfma_f32_16x16x32_bf16 v[140:143], v[144:147], v[96:99], v[140:143]
  v_exp_f32 v67, v67
  v_perm_b32 v92, v65, v64, s66
  v_mfma_f32_32x32x16_bf16 v[120:135], v[52:55], v[100:103], v[120:135]
  v_exp_f32 v68, v68
  v_exp_f32 v69, v69
  v_perm_b32 v93, v67, v66, s66
  v_exp_f32 v70, v70
  v_exp_f32 v71, v71
  buffer_load_dwordx4 v[148:151], v3, s[48:51], s58 offen offset:0
  v_mfma_f32_16x16x32_bf16 v[140:143], v[144:147], v[100:103], v[140:143]
  v_perm_b32 v94, v69, v68, s66
  v_perm_b32 v95, v71, v70, s66
  s_waitcnt vmcnt(22)
  s_barrier
  s_setprio 3
  s_waitcnt lgkmcnt(1)
  v_mfma_f32_32x32x16_bf16 v[56:71], v[32:35], v[8:11], 0
  v_exp_f32 v72, v72
  v_exp_f32 v73, v73
  v_exp_f32 v74, v74
  v_exp_f32 v75, v75
  v_perm_b32 v96, v73, v72, s66
  buffer_load_dwordx4 v[152:155], v3, s[48:51], s58 offen offset:1024
  v_mfma_f32_32x32x16_bf16 v[104:119], v[40:43], v[88:91], v[104:119]
  v_exp_f32 v76, v76
  v_exp_f32 v77, v77
  v_perm_b32 v97, v75, v74, s66
  v_exp_f32 v78, v78
  v_exp_f32 v79, v79
  s_add_u32 m0, s53, 0
  s_add_u32 s54, s52, 131072
  buffer_load_dwordx4 v3, s[48:51], s54 offen lds
  s_waitcnt lgkmcnt(0)
  v_mfma_f32_32x32x16_bf16 v[56:71], v[36:39], v[12:15], v[56:71]
  v_perm_b32 v98, v77, v76, s66
  v_exp_f32 v80, v80
  v_exp_f32 v81, v81
  v_perm_b32 v99, v79, v78, s66
  v_exp_f32 v82, v82
  ds_read_b128 v[48:51], v4 offset:55296
  v_mfma_f32_16x16x32_bf16 v[136:139], v[144:147], v[88:91], v[136:139]
  v_exp_f32 v83, v83
  v_perm_b32 v100, v81, v80, s66
  ds_read_b128 v[52:55], v4 offset:56320
  v_mfma_f32_32x32x16_bf16 v[104:119], v[44:47], v[92:95], v[104:119]
  v_exp_f32 v84, v84
  v_exp_f32 v85, v85
  v_perm_b32 v101, v83, v82, s66
  v_exp_f32 v86, v86
  v_exp_f32 v87, v87
  ds_read_b128 v[24:27], v5 offset:0
  buffer_load_dwordx4 v[156:159], v3, s[48:51], s58 offen offset:2048
  v_mfma_f32_16x16x32_bf16 v[136:139], v[144:147], v[92:95], v[136:139]
  v_perm_b32 v102, v85, v84, s66
  v_perm_b32 v103, v87, v86, s66
  ds_read_b128 v[28:31], v5 offset:1024
  v_mfma_f32_32x32x16_bf16 v[72:87], v[32:35], v[16:19], 0
  v_exp_f32 v56, v56
  v_exp_f32 v57, v57
  v_exp_f32 v58, v58
  v_exp_f32 v59, v59
  v_perm_b32 v88, v57, v56, s66
  buffer_load_dwordx4 v[160:163], v3, s[48:51], s58 offen offset:3072
  v_mfma_f32_32x32x16_bf16 v[120:135], v[40:43], v[96:99], v[120:135]
  v_exp_f32 v60, v60
  v_exp_f32 v61, v61
  v_perm_b32 v89, v59, v58, s66
  v_exp_f32 v62, v62
  v_exp_f32 v63, v63
  s_add_u32 m0, s53, 1024
  s_add_u32 s54, s52, 132096
  buffer_load_dwordx4 v3, s[48:51], s54 offen lds
  v_mfma_f32_32x32x16_bf16 v[72:87], v[36:39], v[20:23], v[72:87]
  v_perm_b32 v90, v61, v60, s66
  v_exp_f32 v64, v64
  v_exp_f32 v65, v65
  v_perm_b32 v91, v63, v62, s66
  v_exp_f32 v66, v66
  v_mfma_f32_16x16x32_bf16 v[140:143], v[144:147], v[96:99], v[140:143]
  v_exp_f32 v67, v67
  v_perm_b32 v92, v65, v64, s66
  v_mfma_f32_32x32x16_bf16 v[120:135], v[44:47], v[100:103], v[120:135]
  v_exp_f32 v68, v68
  v_exp_f32 v69, v69
  v_perm_b32 v93, v67, v66, s66
  v_exp_f32 v70, v70
  v_exp_f32 v71, v71
  v_mfma_f32_16x16x32_bf16 v[140:143], v[144:147], v[100:103], v[140:143]
  v_perm_b32 v94, v69, v68, s66
  v_perm_b32 v95, v71, v70, s66
  s_setprio 2
  s_waitcnt lgkmcnt(1)
  v_mfma_f32_32x32x16_bf16 v[56:71], v[24:27], v[8:11], 0
  v_exp_f32 v72, v72
  v_exp_f32 v73, v73
  v_exp_f32 v74, v74
  v_exp_f32 v75, v75
  v_perm_b32 v96, v73, v72, s66
  v_mfma_f32_32x32x16_bf16 v[104:119], v[48:51], v[88:91], v[104:119]
  v_exp_f32 v76, v76
  v_exp_f32 v77, v77
  v_perm_b32 v97, v75, v74, s66
  v_exp_f32 v78, v78
  v_exp_f32 v79, v79
  s_waitcnt lgkmcnt(0)
  v_mfma_f32_32x32x16_bf16 v[56:71], v[28:31], v[12:15], v[56:71]
  v_perm_b32 v98, v77, v76, s66
  v_exp_f32 v80, v80
  v_exp_f32 v81, v81
  v_perm_b32 v99, v79, v78, s66
  v_exp_f32 v82, v82
  ds_read_b128 v[40:43], v5 offset:16384
  v_mfma_f32_16x16x32_bf16 v[136:139], v[144:147], v[88:91], v[136:139]
  v_exp_f32 v83, v83
  v_perm_b32 v100, v81, v80, s66
  ds_read_b128 v[44:47], v5 offset:17408
  v_mfma_f32_32x32x16_bf16 v[104:119], v[52:55], v[92:95], v[104:119]
  v_exp_f32 v84, v84
  v_exp_f32 v85, v85
  v_perm_b32 v101, v83, v82, s66
  v_exp_f32 v86, v86
  v_exp_f32 v87, v87
  ds_read_b128 v[32:35], v5 offset:2048
  v_mfma_f32_16x16x32_bf16 v[136:139], v[144:147], v[92:95], v[136:139]
  v_perm_b32 v102, v85, v84, s66
  v_perm_b32 v103, v87, v86, s66
  ds_read_b128 v[36:39], v5 offset:3072
  v_mfma_f32_32x32x16_bf16 v[72:87], v[24:27], v[16:19], 0
  v_exp_f32 v56, v56
  v_exp_f32 v57, v57
  v_exp_f32 v58, v58
  v_exp_f32 v59, v59
  v_perm_b32 v88, v57, v56, s66
  v_mfma_f32_32x32x16_bf16 v[120:135], v[48:51], v[96:99], v[120:135]
  v_exp_f32 v60, v60
  v_exp_f32 v61, v61
  v_perm_b32 v89, v59, v58, s66
  v_exp_f32 v62, v62
  v_exp_f32 v63, v63
  s_add_u32 m0, s53, 2048
  s_add_u32 s54, s52, 133120
  buffer_load_dwordx4 v3, s[48:51], s54 offen lds
  v_mfma_f32_32x32x16_bf16 v[72:87], v[28:31], v[20:23], v[72:87]
  v_perm_b32 v90, v61, v60, s66
  v_exp_f32 v64, v64
  v_exp_f32 v65, v65
  v_perm_b32 v91, v63, v62, s66
  v_exp_f32 v66, v66
  v_mfma_f32_16x16x32_bf16 v[140:143], v[144:147], v[96:99], v[140:143]
  v_exp_f32 v67, v67
  v_perm_b32 v92, v65, v64, s66
  v_mfma_f32_32x32x16_bf16 v[120:135], v[52:55], v[100:103], v[120:135]
  v_exp_f32 v68, v68
  v_exp_f32 v69, v69
  v_perm_b32 v93, v67, v66, s66
  v_exp_f32 v70, v70
  v_exp_f32 v71, v71
  v_mfma_f32_16x16x32_bf16 v[140:143], v[144:147], v[100:103], v[140:143]
  v_perm_b32 v94, v69, v68, s66
  v_perm_b32 v95, v71, v70, s66
  s_setprio 1
  s_waitcnt lgkmcnt(1)
  v_mfma_f32_32x32x16_bf16 v[56:71], v[32:35], v[8:11], 0
  v_exp_f32 v72, v72
  v_exp_f32 v73, v73
  v_exp_f32 v74, v74
  v_exp_f32 v75, v75
  v_perm_b32 v96, v73, v72, s66
  v_mfma_f32_32x32x16_bf16 v[104:119], v[40:43], v[88:91], v[104:119]
  v_exp_f32 v76, v76
  v_exp_f32 v77, v77
  v_perm_b32 v97, v75, v74, s66
  v_exp_f32 v78, v78
  v_exp_f32 v79, v79
  s_waitcnt lgkmcnt(0)
  v_mfma_f32_32x32x16_bf16 v[56:71], v[36:39], v[12:15], v[56:71]
  v_perm_b32 v98, v77, v76, s66
  v_exp_f32 v80, v80
  v_exp_f32 v81, v81
  v_perm_b32 v99, v79, v78, s66
  v_exp_f32 v82, v82
  ds_read_b128 v[48:51], v5 offset:18432
  v_mfma_f32_16x16x32_bf16 v[136:139], v[144:147], v[88:91], v[136:139]
  v_exp_f32 v83, v83
  v_perm_b32 v100, v81, v80, s66
  ds_read_b128 v[52:55], v5 offset:19456
  v_mfma_f32_32x32x16_bf16 v[104:119], v[44:47], v[92:95], v[104:119]
  v_exp_f32 v84, v84
  v_exp_f32 v85, v85
  v_perm_b32 v101, v83, v82, s66
  v_exp_f32 v86, v86
  v_exp_f32 v87, v87
  ds_read_b128 v[24:27], v5 offset:4096
  v_mfma_f32_16x16x32_bf16 v[136:139], v[144:147], v[92:95], v[136:139]
  v_perm_b32 v102, v85, v84, s66
  v_perm_b32 v103, v87, v86, s66
  ds_read_b128 v[28:31], v5 offset:5120
  v_mfma_f32_32x32x16_bf16 v[72:87], v[32:35], v[16:19], 0
  v_exp_f32 v56, v56
  v_exp_f32 v57, v57
  v_exp_f32 v58, v58
  v_exp_f32 v59, v59
  v_perm_b32 v88, v57, v56, s66
  s_waitcnt vmcnt(17)
  v_pk_add_f32 v[164:165], v[164:165], v[196:197]
  v_mfma_f32_32x32x16_bf16 v[120:135], v[40:43], v[96:99], v[120:135]
  v_exp_f32 v60, v60
  v_exp_f32 v61, v61
  v_perm_b32 v89, v59, v58, s66
  v_exp_f32 v62, v62
  v_exp_f32 v63, v63
  s_add_u32 m0, s53, 3072
  s_add_u32 s54, s52, 134144
  buffer_load_dwordx4 v3, s[48:51], s54 offen lds
  v_pk_add_f32 v[166:167], v[166:167], v[198:199]
  v_mfma_f32_32x32x16_bf16 v[72:87], v[36:39], v[20:23], v[72:87]
  v_perm_b32 v90, v61, v60, s66
  v_exp_f32 v64, v64
  v_exp_f32 v65, v65
  v_perm_b32 v91, v63, v62, s66
  v_exp_f32 v66, v66
  s_waitcnt vmcnt(16)
  v_pk_add_f32 v[168:169], v[168:169], v[200:201]
  v_mfma_f32_16x16x32_bf16 v[140:143], v[144:147], v[96:99], v[140:143]
  v_exp_f32 v67, v67
  v_perm_b32 v92, v65, v64, s66
  v_pk_add_f32 v[170:171], v[170:171], v[202:203]
  v_mfma_f32_32x32x16_bf16 v[120:135], v[44:47], v[100:103], v[120:135]
  v_exp_f32 v68, v68
  v_exp_f32 v69, v69
  v_perm_b32 v93, v67, v66, s66
  v_exp_f32 v70, v70
  v_exp_f32 v71, v71
  s_waitcnt vmcnt(15)
  v_pk_add_f32 v[172:173], v[172:173], v[204:205]
  v_mfma_f32_16x16x32_bf16 v[140:143], v[144:147], v[100:103], v[140:143]
  v_perm_b32 v94, v69, v68, s66
  v_perm_b32 v95, v71, v70, s66
  s_setprio 0
  s_waitcnt lgkmcnt(1)
  v_mfma_f32_32x32x16_bf16 v[56:71], v[24:27], v[8:11], 0
  v_exp_f32 v72, v72
  v_exp_f32 v73, v73
  v_exp_f32 v74, v74
  v_exp_f32 v75, v75
  v_perm_b32 v96, v73, v72, s66
  v_pk_add_f32 v[174:175], v[174:175], v[206:207]
  v_mfma_f32_32x32x16_bf16 v[104:119], v[48:51], v[88:91], v[104:119]
  v_exp_f32 v76, v76
  v_exp_f32 v77, v77
  v_perm_b32 v97, v75, v74, s66
  v_exp_f32 v78, v78
  v_exp_f32 v79, v79
  s_waitcnt vmcnt(14)
  v_pk_add_f32 v[176:177], v[176:177], v[208:209]
  s_waitcnt lgkmcnt(0)
  v_mfma_f32_32x32x16_bf16 v[56:71], v[28:31], v[12:15], v[56:71]
  v_perm_b32 v98, v77, v76, s66
  v_exp_f32 v80, v80
  v_exp_f32 v81, v81
  v_perm_b32 v99, v79, v78, s66
  v_exp_f32 v82, v82
  ds_read_b128 v[40:43], v5 offset:20480
  v_pk_add_f32 v[178:179], v[178:179], v[210:211]
  v_mfma_f32_16x16x32_bf16 v[136:139], v[144:147], v[88:91], v[136:139]
  v_exp_f32 v83, v83
  v_perm_b32 v100, v81, v80, s66
  ds_read_b128 v[44:47], v5 offset:21504
  s_waitcnt vmcnt(13)
  v_pk_add_f32 v[180:181], v[180:181], v[212:213]
  v_mfma_f32_32x32x16_bf16 v[104:119], v[52:55], v[92:95], v[104:119]
  v_exp_f32 v84, v84
  v_exp_f32 v85, v85
  v_perm_b32 v101, v83, v82, s66
  v_exp_f32 v86, v86
  v_exp_f32 v87, v87
  ds_read_b128 v[32:35], v5 offset:6144
  v_pk_add_f32 v[182:183], v[182:183], v[214:215]
  v_mfma_f32_16x16x32_bf16 v[136:139], v[144:147], v[92:95], v[136:139]
  v_perm_b32 v102, v85, v84, s66
  v_perm_b32 v103, v87, v86, s66
  ds_read_b128 v[36:39], v5 offset:7168
  v_mfma_f32_32x32x16_bf16 v[72:87], v[24:27], v[16:19], 0
  v_exp_f32 v56, v56
  v_exp_f32 v57, v57
  v_exp_f32 v58, v58
  v_exp_f32 v59, v59
  v_perm_b32 v88, v57, v56, s66
  s_waitcnt vmcnt(11)
  v_pk_add_f32 v[184:185], v[184:185], v[216:217]
  v_mfma_f32_32x32x16_bf16 v[120:135], v[48:51], v[96:99], v[120:135]
  v_exp_f32 v60, v60
  v_exp_f32 v61, v61
  v_perm_b32 v89, v59, v58, s66
  v_exp_f32 v62, v62
  v_exp_f32 v63, v63
  v_pk_add_f32 v[186:187], v[186:187], v[218:219]
  v_mfma_f32_32x32x16_bf16 v[72:87], v[28:31], v[20:23], v[72:87]
  v_perm_b32 v90, v61, v60, s66
  v_exp_f32 v64, v64
  v_exp_f32 v65, v65
  v_perm_b32 v91, v63, v62, s66
  v_exp_f32 v66, v66
  s_waitcnt vmcnt(10)
  v_pk_add_f32 v[188:189], v[188:189], v[220:221]
  v_mfma_f32_16x16x32_bf16 v[140:143], v[144:147], v[96:99], v[140:143]
  v_exp_f32 v67, v67
  v_perm_b32 v92, v65, v64, s66
  v_pk_add_f32 v[190:191], v[190:191], v[222:223]
  v_mfma_f32_32x32x16_bf16 v[120:135], v[52:55], v[100:103], v[120:135]
  v_exp_f32 v68, v68
  v_exp_f32 v69, v69
  v_perm_b32 v93, v67, v66, s66
  v_exp_f32 v70, v70
  v_exp_f32 v71, v71
  s_waitcnt vmcnt(9)
  v_pk_add_f32 v[192:193], v[192:193], v[224:225]
  v_mfma_f32_16x16x32_bf16 v[140:143], v[144:147], v[100:103], v[140:143]
  v_perm_b32 v94, v69, v68, s66
  v_perm_b32 v95, v71, v70, s66
  s_barrier
  s_setprio 3
  s_waitcnt lgkmcnt(1)
  v_mfma_f32_32x32x16_bf16 v[56:71], v[32:35], v[8:11], 0
  v_exp_f32 v72, v72
  v_exp_f32 v73, v73
  v_exp_f32 v74, v74
  v_exp_f32 v75, v75
  v_perm_b32 v96, v73, v72, s66
  v_pk_add_f32 v[194:195], v[194:195], v[226:227]
  v_mfma_f32_32x32x16_bf16 v[104:119], v[40:43], v[88:91], v[104:119]
  v_exp_f32 v76, v76
  v_exp_f32 v77, v77
  v_perm_b32 v97, v75, v74, s66
  v_exp_f32 v78, v78
  v_exp_f32 v79, v79
  s_add_u32 m0, s53, 32768
  s_add_u32 s54, s52, 163840
  buffer_load_dwordx4 v3, s[48:51], s54 offen lds
  v_pk_add_f32 v[164:165], v[164:165], v[180:181]
  s_waitcnt lgkmcnt(0)
  v_mfma_f32_32x32x16_bf16 v[56:71], v[36:39], v[12:15], v[56:71]
  v_perm_b32 v98, v77, v76, s66
  v_exp_f32 v80, v80
  v_exp_f32 v81, v81
  v_perm_b32 v99, v79, v78, s66
  v_exp_f32 v82, v82
  ds_read_b128 v[48:51], v5 offset:22528
  v_pk_add_f32 v[166:167], v[166:167], v[182:183]
  v_mfma_f32_16x16x32_bf16 v[136:139], v[144:147], v[88:91], v[136:139]
  v_exp_f32 v83, v83
  v_perm_b32 v100, v81, v80, s66
  ds_read_b128 v[52:55], v5 offset:23552
  v_pk_add_f32 v[168:169], v[168:169], v[184:185]
  v_mfma_f32_32x32x16_bf16 v[104:119], v[44:47], v[92:95], v[104:119]
  v_exp_f32 v84, v84
  v_exp_f32 v85, v85
  v_perm_b32 v101, v83, v82, s66
  v_exp_f32 v86, v86
  v_exp_f32 v87, v87
  ds_read_b128 v[24:27], v5 offset:32768
  v_pk_add_f32 v[170:171], v[170:171], v[186:187]
  v_mfma_f32_16x16x32_bf16 v[136:139], v[144:147], v[92:95], v[136:139]
  v_perm_b32 v102, v85, v84, s66
  v_perm_b32 v103, v87, v86, s66
  ds_read_b128 v[28:31], v5 offset:33792
  v_mfma_f32_32x32x16_bf16 v[72:87], v[32:35], v[16:19], 0
  v_exp_f32 v56, v56
  v_exp_f32 v57, v57
  v_exp_f32 v58, v58
  v_exp_f32 v59, v59
  v_perm_b32 v88, v57, v56, s66
  v_pk_add_f32 v[172:173], v[172:173], v[188:189]
  v_mfma_f32_32x32x16_bf16 v[120:135], v[40:43], v[96:99], v[120:135]
  v_exp_f32 v60, v60
  v_exp_f32 v61, v61
  v_perm_b32 v89, v59, v58, s66
  v_exp_f32 v62, v62
  v_exp_f32 v63, v63
  s_add_u32 m0, s53, 33792
  s_add_u32 s54, s52, 164864
  buffer_load_dwordx4 v3, s[48:51], s54 offen lds
  v_pk_add_f32 v[174:175], v[174:175], v[190:191]
  v_mfma_f32_32x32x16_bf16 v[72:87], v[36:39], v[20:23], v[72:87]
  v_perm_b32 v90, v61, v60, s66
  v_exp_f32 v64, v64
  v_exp_f32 v65, v65
  v_perm_b32 v91, v63, v62, s66
  v_exp_f32 v66, v66
  v_pk_add_f32 v[176:177], v[176:177], v[192:193]
  v_mfma_f32_16x16x32_bf16 v[140:143], v[144:147], v[96:99], v[140:143]
  v_exp_f32 v67, v67
  v_perm_b32 v92, v65, v64, s66
  v_pk_add_f32 v[178:179], v[178:179], v[194:195]
  v_mfma_f32_32x32x16_bf16 v[120:135], v[44:47], v[100:103], v[120:135]
  v_exp_f32 v68, v68
  v_exp_f32 v69, v69
  v_perm_b32 v93, v67, v66, s66
  v_exp_f32 v70, v70
  v_exp_f32 v71, v71
  v_pk_add_f32 v[164:165], v[164:165], v[172:173]
  v_mfma_f32_16x16x32_bf16 v[140:143], v[144:147], v[100:103], v[140:143]
  v_perm_b32 v94, v69, v68, s66
  v_perm_b32 v95, v71, v70, s66
  s_setprio 2
  s_waitcnt lgkmcnt(1)
  v_mfma_f32_32x32x16_bf16 v[56:71], v[24:27], v[8:11], 0
  v_exp_f32 v72, v72
  v_exp_f32 v73, v73
  v_exp_f32 v74, v74
  v_exp_f32 v75, v75
  v_perm_b32 v96, v73, v72, s66
  v_pk_add_f32 v[166:167], v[166:167], v[174:175]
  v_mfma_f32_32x32x16_bf16 v[104:119], v[48:51], v[88:91], v[104:119]
  v_exp_f32 v76, v76
  v_exp_f32 v77, v77
  v_perm_b32 v97, v75, v74, s66
  v_exp_f32 v78, v78
  v_exp_f32 v79, v79
  v_pk_add_f32 v[168:169], v[168:169], v[176:177]
  s_waitcnt lgkmcnt(0)
  v_mfma_f32_32x32x16_bf16 v[56:71], v[28:31], v[12:15], v[56:71]
  v_perm_b32 v98, v77, v76, s66
  v_exp_f32 v80, v80
  v_exp_f32 v81, v81
  v_perm_b32 v99, v79, v78, s66
  v_exp_f32 v82, v82
  ds_read_b128 v[40:43], v5 offset:49152
  v_pk_add_f32 v[170:171], v[170:171], v[178:179]
  v_mfma_f32_16x16x32_bf16 v[136:139], v[144:147], v[88:91], v[136:139]
  v_exp_f32 v83, v83
  v_perm_b32 v100, v81, v80, s66
  ds_read_b128 v[44:47], v5 offset:50176
  v_pk_add_f32 v[164:165], v[164:165], v[168:169]
  v_mfma_f32_32x32x16_bf16 v[104:119], v[52:55], v[92:95], v[104:119]
  v_exp_f32 v84, v84
  v_exp_f32 v85, v85
  v_perm_b32 v101, v83, v82, s66
  v_exp_f32 v86, v86
  v_exp_f32 v87, v87
  ds_read_b128 v[32:35], v5 offset:34816
  v_pk_add_f32 v[166:167], v[166:167], v[170:171]
  v_mfma_f32_16x16x32_bf16 v[136:139], v[144:147], v[92:95], v[136:139]
  v_perm_b32 v102, v85, v84, s66
  v_perm_b32 v103, v87, v86, s66
  ds_read_b128 v[36:39], v5 offset:35840
  v_mfma_f32_32x32x16_bf16 v[72:87], v[24:27], v[16:19], 0
  v_exp_f32 v56, v56
  v_exp_f32 v57, v57
  v_exp_f32 v58, v58
  v_exp_f32 v59, v59
  v_perm_b32 v88, v57, v56, s66
  v_cvt_pk_bf16_f32 v168, v164, v165
  v_cvt_pk_bf16_f32 v169, v166, v167
  v_mfma_f32_32x32x16_bf16 v[120:135], v[48:51], v[96:99], v[120:135]
  v_exp_f32 v60, v60
  v_exp_f32 v61, v61
  v_perm_b32 v89, v59, v58, s66
  v_exp_f32 v62, v62
  v_exp_f32 v63, v63
  s_add_u32 m0, s53, 34816
  s_add_u32 s54, s52, 165888
  buffer_load_dwordx4 v3, s[48:51], s54 offen lds
  s_waitcnt vmcnt(11)
  v_permlane16_swap_b32 v228, v229
  v_mfma_f32_32x32x16_bf16 v[72:87], v[28:31], v[20:23], v[72:87]
  v_perm_b32 v90, v61, v60, s66
  v_exp_f32 v64, v64
  v_exp_f32 v65, v65
  v_perm_b32 v91, v63, v62, s66
  v_exp_f32 v66, v66
  ds_write_b64 v252, v[168:169]
  v_mfma_f32_16x16x32_bf16 v[140:143], v[144:147], v[96:99], v[140:143]
  v_exp_f32 v67, v67
  v_perm_b32 v92, v65, v64, s66
  v_add_f32 v228, v228, v229
  v_mfma_f32_32x32x16_bf16 v[120:135], v[52:55], v[100:103], v[120:135]
  v_exp_f32 v68, v68
  v_exp_f32 v69, v69
  v_perm_b32 v93, v67, v66, s66
  v_exp_f32 v70, v70
  v_exp_f32 v71, v71
  v_mfma_f32_16x16x32_bf16 v[140:143], v[144:147], v[100:103], v[140:143]
  v_perm_b32 v94, v69, v68, s66
  v_perm_b32 v95, v71, v70, s66
  v_add_f32_dpp v228, v228, v228 row_shr:4 row_mask:0xf bank_mask:0xf
  s_setprio 1
  s_waitcnt lgkmcnt(2)
  v_mfma_f32_32x32x16_bf16 v[56:71], v[32:35], v[8:11], 0
  v_exp_f32 v72, v72
  v_exp_f32 v73, v73
  v_exp_f32 v74, v74
  v_exp_f32 v75, v75
  v_perm_b32 v96, v73, v72, s66
  v_mfma_f32_32x32x16_bf16 v[104:119], v[40:43], v[88:91], v[104:119]
  v_exp_f32 v76, v76
  v_exp_f32 v77, v77
  v_perm_b32 v97, v75, v74, s66
  v_exp_f32 v78, v78
  v_exp_f32 v79, v79
  v_add_f32_dpp v228, v228, v228 row_shr:8 row_mask:0xf bank_mask:0xf
  s_waitcnt lgkmcnt(1)
  v_mfma_f32_32x32x16_bf16 v[56:71], v[36:39], v[12:15], v[56:71]
  v_perm_b32 v98, v77, v76, s66
  v_exp_f32 v80, v80
  v_exp_f32 v81, v81
  v_perm_b32 v99, v79, v78, s66
  v_exp_f32 v82, v82
  ds_read_b128 v[48:51], v5 offset:51200
  v_mfma_f32_16x16x32_bf16 v[136:139], v[144:147], v[88:91], v[136:139]
  v_exp_f32 v83, v83
  v_perm_b32 v100, v81, v80, s66
  ds_read_b128 v[52:55], v5 offset:52224
  v_mov_b32 v229, v228
  v_mfma_f32_32x32x16_bf16 v[104:119], v[44:47], v[92:95], v[104:119]
  v_exp_f32 v84, v84
  v_exp_f32 v85, v85
  v_perm_b32 v101, v83, v82, s66
  v_exp_f32 v86, v86
  v_exp_f32 v87, v87
  ds_read_b128 v[24:27], v5 offset:36864
  v_mfma_f32_16x16x32_bf16 v[136:139], v[144:147], v[92:95], v[136:139]
  v_perm_b32 v102, v85, v84, s66
  v_perm_b32 v103, v87, v86, s66
  ds_read_b128 v[28:31], v5 offset:37888
  v_permlane32_swap_b32 v228, v229
  v_mfma_f32_32x32x16_bf16 v[72:87], v[32:35], v[16:19], 0
  v_exp_f32 v56, v56
  v_exp_f32 v57, v57
  v_exp_f32 v58, v58
  v_exp_f32 v59, v59
  v_perm_b32 v88, v57, v56, s66
  v_mfma_f32_32x32x16_bf16 v[120:135], v[40:43], v[96:99], v[120:135]
  v_exp_f32 v60, v60
  v_exp_f32 v61, v61
  v_perm_b32 v89, v59, v58, s66
  v_exp_f32 v62, v62
  v_exp_f32 v63, v63
  s_add_u32 m0, s53, 35840
  s_add_u32 s54, s52, 166912
  buffer_load_dwordx4 v3, s[48:51], s54 offen lds
  v_add_f32 v228, v228, v229
  v_mfma_f32_32x32x16_bf16 v[72:87], v[36:39], v[20:23], v[72:87]
  v_perm_b32 v90, v61, v60, s66
  v_exp_f32 v64, v64
  v_exp_f32 v65, v65
  v_perm_b32 v91, v63, v62, s66
  v_exp_f32 v66, v66
  v_mfma_f32_16x16x32_bf16 v[140:143], v[144:147], v[96:99], v[140:143]
  v_exp_f32 v67, v67
  v_perm_b32 v92, v65, v64, s66
  v_cvt_pk_bf16_f32 v228, v228, v228
  v_mfma_f32_32x32x16_bf16 v[120:135], v[44:47], v[100:103], v[120:135]
  v_exp_f32 v68, v68
  v_exp_f32 v69, v69
  v_perm_b32 v93, v67, v66, s66
  v_exp_f32 v70, v70
  v_exp_f32 v71, v71
  v_mfma_f32_16x16x32_bf16 v[140:143], v[144:147], v[100:103], v[140:143]
  v_perm_b32 v94, v69, v68, s66
  v_perm_b32 v95, v71, v70, s66
  s_mov_b32 exec_lo, 0xf000f000
  s_mov_b32 exec_hi, 0
  ds_write_b16 v253, v228
  s_mov_b64 exec, -1
  s_setprio 0
  s_waitcnt lgkmcnt(2)
  v_mfma_f32_32x32x16_bf16 v[56:71], v[24:27], v[8:11], 0
  v_exp_f32 v72, v72
  v_exp_f32 v73, v73
  v_exp_f32 v74, v74
  v_exp_f32 v75, v75
  v_perm_b32 v96, v73, v72, s66
  v_mfma_f32_32x32x16_bf16 v[104:119], v[48:51], v[88:91], v[104:119]
  v_exp_f32 v76, v76
  v_exp_f32 v77, v77
  v_perm_b32 v97, v75, v74, s66
  v_exp_f32 v78, v78
  v_exp_f32 v79, v79
  s_waitcnt lgkmcnt(1)
  v_mfma_f32_32x32x16_bf16 v[56:71], v[28:31], v[12:15], v[56:71]
  v_perm_b32 v98, v77, v76, s66
  v_exp_f32 v80, v80
  v_exp_f32 v81, v81
  v_perm_b32 v99, v79, v78, s66
  v_exp_f32 v82, v82
  ds_read_b128 v[40:43], v5 offset:53248
  v_mfma_f32_16x16x32_bf16 v[136:139], v[144:147], v[88:91], v[136:139]
  v_exp_f32 v83, v83
  v_perm_b32 v100, v81, v80, s66
  ds_read_b128 v[44:47], v5 offset:54272
  v_mfma_f32_32x32x16_bf16 v[104:119], v[52:55], v[92:95], v[104:119]
  v_exp_f32 v84, v84
  v_exp_f32 v85, v85
  v_perm_b32 v101, v83, v82, s66
  v_exp_f32 v86, v86
  v_exp_f32 v87, v87
  ds_read_b128 v[32:35], v5 offset:38912
  v_mfma_f32_16x16x32_bf16 v[136:139], v[144:147], v[92:95], v[136:139]
  v_perm_b32 v102, v85, v84, s66
  v_perm_b32 v103, v87, v86, s66
  ds_read_b128 v[36:39], v5 offset:39936
  v_mfma_f32_32x32x16_bf16 v[72:87], v[24:27], v[16:19], 0
  v_exp_f32 v56, v56
  v_exp_f32 v57, v57
  v_exp_f32 v58, v58
  v_exp_f32 v59, v59
  v_perm_b32 v88, v57, v56, s66
  v_and_b32 v164, 31, v2
  v_lshlrev_b32 v164, 2, v164
  v_mfma_f32_32x32x16_bf16 v[120:135], v[48:51], v[96:99], v[120:135]
  v_exp_f32 v60, v60
  v_exp_f32 v61, v61
  v_perm_b32 v89, v59, v58, s66
  v_exp_f32 v62, v62
  v_exp_f32 v63, v63
  v_mfma_f32_32x32x16_bf16 v[72:87], v[28:31], v[20:23], v[72:87]
  v_perm_b32 v90, v61, v60, s66
  v_exp_f32 v64, v64
  v_exp_f32 v65, v65
  v_perm_b32 v91, v63, v62, s66
  v_exp_f32 v66, v66
  v_mov_b32 v166, 1
  v_mov_b32 v167, 0
  v_mov_b32 v165, 0
  v_mfma_f32_16x16x32_bf16 v[140:143], v[144:147], v[96:99], v[140:143]
  v_exp_f32 v67, v67
  v_perm_b32 v92, v65, v64, s66
  v_mfma_f32_32x32x16_bf16 v[120:135], v[52:55], v[100:103], v[120:135]
  v_exp_f32 v68, v68
  v_exp_f32 v69, v69
  v_perm_b32 v93, v67, v66, s66
  v_exp_f32 v70, v70
  v_exp_f32 v71, v71
  s_waitcnt lgkmcnt(4)
  v_mfma_f32_16x16x32_bf16 v[140:143], v[144:147], v[100:103], v[140:143]
  v_perm_b32 v94, v69, v68, s66
  v_perm_b32 v95, v71, v70, s66
  v_add_u32 v6, 131072, v3
  s_waitcnt vmcnt(4)
  s_barrier
  s_setprio 3
  s_waitcnt lgkmcnt(1)
  v_mfma_f32_32x32x16_bf16 v[56:71], v[32:35], v[8:11], 0
  v_exp_f32 v72, v72
  v_exp_f32 v73, v73
  v_exp_f32 v74, v74
  v_exp_f32 v75, v75
  v_perm_b32 v96, v73, v72, s66
  ds_read_b128 v[172:175], v6 offset:0
  v_mfma_f32_32x32x16_bf16 v[104:119], v[40:43], v[88:91], v[104:119]
  v_exp_f32 v76, v76
  v_exp_f32 v77, v77
  v_perm_b32 v97, v75, v74, s66
  v_exp_f32 v78, v78
  v_exp_f32 v79, v79
  s_add_u32 m0, s53, 65536
  s_add_u32 s54, s52, 196608
  buffer_load_dwordx4 v3, s[48:51], s54 offen lds
  ds_read_b128 v[176:179], v6 offset:1024
  s_waitcnt lgkmcnt(2)
  v_mfma_f32_32x32x16_bf16 v[56:71], v[36:39], v[12:15], v[56:71]
  v_perm_b32 v98, v77, v76, s66
  v_exp_f32 v80, v80
  v_exp_f32 v81, v81
  v_perm_b32 v99, v79, v78, s66
  v_exp_f32 v82, v82
  ds_read_b128 v[48:51], v5 offset:55296
  v_mfma_f32_16x16x32_bf16 v[136:139], v[144:147], v[88:91], v[136:139]
  v_exp_f32 v83, v83
  v_perm_b32 v100, v81, v80, s66
  ds_read_b128 v[52:55], v5 offset:56320
  v_mfma_f32_32x32x16_bf16 v[104:119], v[44:47], v[92:95], v[104:119]
  v_exp_f32 v84, v84
  v_exp_f32 v85, v85
  v_perm_b32 v101, v83, v82, s66
  v_exp_f32 v86, v86
  v_exp_f32 v87, v87
  ds_read_b128 v[24:27], v4 offset:0
  v_mfma_f32_16x16x32_bf16 v[136:139], v[144:147], v[92:95], v[136:139]
  v_perm_b32 v102, v85, v84, s66
  v_perm_b32 v103, v87, v86, s66
  ds_read_b128 v[28:31], v4 offset:1024
  v_mfma_f32_32x32x16_bf16 v[72:87], v[32:35], v[16:19], 0
  v_exp_f32 v56, v56
  v_exp_f32 v57, v57
  v_exp_f32 v58, v58
  v_exp_f32 v59, v59
  v_perm_b32 v88, v57, v56, s66
  ds_read_b128 v[180:183], v6 offset:2048
  v_lshlrev_b32 v168, 6, v2
  s_lshr_b32 s3, s2, 3
  s_lshl_b32 s3, s3, 3
  s_add_u32 s3, s3, s5
  s_lshl_b32 s4, s3, 13
  s_add_u32 s8, s4, 4096
  v_mfma_f32_32x32x16_bf16 v[120:135], v[40:43], v[96:99], v[120:135]
  v_exp_f32 v60, v60
  v_exp_f32 v61, v61
  v_perm_b32 v89, v59, v58, s66
  v_exp_f32 v62, v62
  v_exp_f32 v63, v63
  s_add_u32 m0, s53, 66560
  s_add_u32 s54, s52, 197632
  buffer_load_dwordx4 v3, s[48:51], s54 offen lds
  ds_read_b128 v[184:187], v6 offset:3072
  v_mfma_f32_32x32x16_bf16 v[72:87], v[36:39], v[20:23], v[72:87]
  v_perm_b32 v90, v61, v60, s66
  v_exp_f32 v64, v64
  v_exp_f32 v65, v65
  v_perm_b32 v91, v63, v62, s66
  v_exp_f32 v66, v66
  ds_read_b128 v[188:191], v254 offset:0
  buffer_load_dword v169, v168, s[28:31], s4 offen
  v_mfma_f32_16x16x32_bf16 v[140:143], v[144:147], v[96:99], v[140:143]
  v_exp_f32 v67, v67
  v_perm_b32 v92, v65, v64, s66
  ds_read_b128 v[192:195], v254 offset:32
  v_mfma_f32_32x32x16_bf16 v[120:135], v[44:47], v[100:103], v[120:135]
  v_exp_f32 v68, v68
  v_exp_f32 v69, v69
  v_perm_b32 v93, v67, v66, s66
  v_exp_f32 v70, v70
  v_exp_f32 v71, v71
  ds_read_b128 v[196:199], v254 offset:64
  v_mfma_f32_16x16x32_bf16 v[140:143], v[144:147], v[100:103], v[140:143]
  v_perm_b32 v94, v69, v68, s66
  v_perm_b32 v95, v71, v70, s66
  ds_read_b128 v[200:203], v254 offset:96
  s_setprio 2
  s_waitcnt lgkmcnt(7)
  v_mfma_f32_32x32x16_bf16 v[56:71], v[24:27], v[8:11], 0
  v_exp_f32 v72, v72
  v_exp_f32 v73, v73
  v_exp_f32 v74, v74
  v_exp_f32 v75, v75
  v_perm_b32 v96, v73, v72, s66
  v_mfma_f32_32x32x16_bf16 v[104:119], v[48:51], v[88:91], v[104:119]
  v_exp_f32 v76, v76
  v_exp_f32 v77, v77
  v_perm_b32 v97, v75, v74, s66
  v_exp_f32 v78, v78
  v_exp_f32 v79, v79
  s_waitcnt lgkmcnt(6)
  v_mfma_f32_32x32x16_bf16 v[56:71], v[28:31], v[12:15], v[56:71]
  v_perm_b32 v98, v77, v76, s66
  v_exp_f32 v80, v80
  v_exp_f32 v81, v81
  v_perm_b32 v99, v79, v78, s66
  v_exp_f32 v82, v82
  ds_read_b128 v[40:43], v4 offset:16384
  v_mfma_f32_16x16x32_bf16 v[136:139], v[144:147], v[88:91], v[136:139]
  v_exp_f32 v83, v83
  v_perm_b32 v100, v81, v80, s66
  ds_read_b128 v[44:47], v4 offset:17408
  v_mfma_f32_32x32x16_bf16 v[204:219], v[172:175], v[148:151], 0
  v_mfma_f32_32x32x16_bf16 v[104:119], v[52:55], v[92:95], v[104:119]
  v_exp_f32 v84, v84
  v_exp_f32 v85, v85
  v_perm_b32 v101, v83, v82, s66
  v_exp_f32 v86, v86
  v_exp_f32 v87, v87
  ds_read_b128 v[32:35], v4 offset:2048
  v_mfma_f32_16x16x32_bf16 v[136:139], v[144:147], v[92:95], v[136:139]
  v_perm_b32 v102, v85, v84, s66
  v_perm_b32 v103, v87, v86, s66
  ds_read_b128 v[36:39], v4 offset:3072
  v_mfma_f32_32x32x16_bf16 v[72:87], v[24:27], v[16:19], 0
  v_exp_f32 v56, v56
  v_exp_f32 v57, v57
  v_exp_f32 v58, v58
  v_exp_f32 v59, v59
  v_perm_b32 v88, v57, v56, s66
  v_mfma_f32_32x32x16_bf16 v[120:135], v[48:51], v[96:99], v[120:135]
  v_exp_f32 v60, v60
  v_exp_f32 v61, v61
  v_perm_b32 v89, v59, v58, s66
  v_exp_f32 v62, v62
  v_exp_f32 v63, v63
  s_add_u32 m0, s53, 67584
  s_add_u32 s54, s52, 198656
  buffer_load_dwordx4 v3, s[48:51], s54 offen lds
  v_mfma_f32_32x32x16_bf16 v[72:87], v[28:31], v[20:23], v[72:87]
  v_perm_b32 v90, v61, v60, s66
  v_exp_f32 v64, v64
  v_exp_f32 v65, v65
  v_perm_b32 v91, v63, v62, s66
  v_exp_f32 v66, v66
  buffer_load_dword v169, v168, s[28:31], s8 offen
  v_mfma_f32_16x16x32_bf16 v[140:143], v[144:147], v[96:99], v[140:143]
  v_exp_f32 v67, v67
  v_perm_b32 v92, v65, v64, s66
  s_waitcnt lgkmcnt(7)
  v_mfma_f32_32x32x16_bf16 v[232:247], v[188:191], v[148:151], 0
  v_mfma_f32_32x32x16_bf16 v[120:135], v[52:55], v[100:103], v[120:135]
  v_exp_f32 v68, v68
  v_exp_f32 v69, v69
  v_perm_b32 v93, v67, v66, s66
  v_exp_f32 v70, v70
  v_exp_f32 v71, v71
  v_mfma_f32_16x16x32_bf16 v[140:143], v[144:147], v[100:103], v[140:143]
  v_perm_b32 v94, v69, v68, s66
  v_perm_b32 v95, v71, v70, s66
  s_setprio 1
  s_waitcnt lgkmcnt(1)
  v_mfma_f32_32x32x16_bf16 v[56:71], v[32:35], v[8:11], 0
  v_exp_f32 v72, v72
  v_exp_f32 v73, v73
  v_exp_f32 v74, v74
  v_exp_f32 v75, v75
  v_perm_b32 v96, v73, v72, s66
  v_mfma_f32_32x32x16_bf16 v[104:119], v[40:43], v[88:91], v[104:119]
  v_exp_f32 v76, v76
  v_exp_f32 v77, v77
  v_perm_b32 v97, v75, v74, s66
  v_exp_f32 v78, v78
  v_exp_f32 v79, v79
  s_waitcnt lgkmcnt(0)
  v_mfma_f32_32x32x16_bf16 v[56:71], v[36:39], v[12:15], v[56:71]
  v_perm_b32 v98, v77, v76, s66
  v_exp_f32 v80, v80
  v_exp_f32 v81, v81
  v_perm_b32 v99, v79, v78, s66
  v_exp_f32 v82, v82
  ds_read_b128 v[48:51], v4 offset:18432
  v_mfma_f32_16x16x32_bf16 v[136:139], v[144:147], v[88:91], v[136:139]
  v_exp_f32 v83, v83
  v_perm_b32 v100, v81, v80, s66
  ds_read_b128 v[52:55], v4 offset:19456
  v_mfma_f32_32x32x16_bf16 v[204:219], v[176:179], v[152:155], v[204:219]
  v_mfma_f32_32x32x16_bf16 v[104:119], v[44:47], v[92:95], v[104:119]
  v_exp_f32 v84, v84
  v_exp_f32 v85, v85
  v_perm_b32 v101, v83, v82, s66
  v_exp_f32 v86, v86
  v_exp_f32 v87, v87
  ds_read_b128 v[24:27], v4 offset:4096
  v_mfma_f32_16x16x32_bf16 v[136:139], v[144:147], v[92:95], v[136:139]
  v_perm_b32 v102, v85, v84, s66
  v_perm_b32 v103, v87, v86, s66
  ds_read_b128 v[28:31], v4 offset:5120
  v_mfma_f32_32x32x16_bf16 v[72:87], v[32:35], v[16:19], 0
  v_exp_f32 v56, v56
  v_exp_f32 v57, v57
  v_exp_f32 v58, v58
  v_exp_f32 v59, v59
  v_perm_b32 v88, v57, v56, s66
  v_lshrrev_b32 v170, 4, v2
  v_and_b32 v171, 15, v2
  v_lshlrev_b32 v170, 11, v170
  s_and_b32 s9, s2, 1
  s_lshl_b32 s9, s9, 10
  s_add_u32 s4, s4, s9
  v_mfma_f32_32x32x16_bf16 v[120:135], v[40:43], v[96:99], v[120:135]
  v_exp_f32 v60, v60
  v_exp_f32 v61, v61
  v_perm_b32 v89, v59, v58, s66
  v_exp_f32 v62, v62
  v_exp_f32 v63, v63
  s_add_u32 m0, s53, 68608
  s_add_u32 s54, s52, 199680
  buffer_load_dwordx4 v3, s[48:51], s54 offen lds
  v_mfma_f32_32x32x16_bf16 v[72:87], v[36:39], v[20:23], v[72:87]
  v_perm_b32 v90, v61, v60, s66
  v_exp_f32 v64, v64
  v_exp_f32 v65, v65
  v_perm_b32 v91, v63, v62, s66
  v_exp_f32 v66, v66
  v_lshl_add_u32 v170, v171, 6, v170
  v_mfma_f32_16x16x32_bf16 v[140:143], v[144:147], v[96:99], v[140:143]
  v_exp_f32 v67, v67
  v_perm_b32 v92, v65, v64, s66
  v_mfma_f32_32x32x16_bf16 v[232:247], v[192:195], v[152:155], v[232:247]
  v_mfma_f32_32x32x16_bf16 v[120:135], v[44:47], v[100:103], v[120:135]
  v_exp_f32 v68, v68
  v_exp_f32 v69, v69
  v_perm_b32 v93, v67, v66, s66
  v_exp_f32 v70, v70
  v_exp_f32 v71, v71
  buffer_load_dword v169, v170, s[24:27], s4 offen
  v_mfma_f32_16x16x32_bf16 v[140:143], v[144:147], v[100:103], v[140:143]
  v_perm_b32 v94, v69, v68, s66
  v_perm_b32 v95, v71, v70, s66
  s_setprio 0
  s_waitcnt lgkmcnt(1)
  v_mfma_f32_32x32x16_bf16 v[56:71], v[24:27], v[8:11], 0
  v_exp_f32 v72, v72
  v_exp_f32 v73, v73
  v_exp_f32 v74, v74
  v_exp_f32 v75, v75
  v_perm_b32 v96, v73, v72, s66
  v_mfma_f32_32x32x16_bf16 v[104:119], v[48:51], v[88:91], v[104:119]
  v_exp_f32 v76, v76
  v_exp_f32 v77, v77
  v_perm_b32 v97, v75, v74, s66
  v_exp_f32 v78, v78
  v_exp_f32 v79, v79
  s_waitcnt lgkmcnt(0)
  v_mfma_f32_32x32x16_bf16 v[56:71], v[28:31], v[12:15], v[56:71]
  v_perm_b32 v98, v77, v76, s66
  v_exp_f32 v80, v80
  v_exp_f32 v81, v81
  v_perm_b32 v99, v79, v78, s66
  v_exp_f32 v82, v82
  ds_read_b128 v[40:43], v4 offset:20480
  v_mfma_f32_16x16x32_bf16 v[136:139], v[144:147], v[88:91], v[136:139]
  v_exp_f32 v83, v83
  v_perm_b32 v100, v81, v80, s66
  ds_read_b128 v[44:47], v4 offset:21504
  v_mfma_f32_32x32x16_bf16 v[204:219], v[180:183], v[156:159], v[204:219]
  v_mfma_f32_32x32x16_bf16 v[104:119], v[52:55], v[92:95], v[104:119]
  v_exp_f32 v84, v84
  v_exp_f32 v85, v85
  v_perm_b32 v101, v83, v82, s66
  v_exp_f32 v86, v86
  v_exp_f32 v87, v87
  ds_read_b128 v[32:35], v4 offset:6144
  v_mfma_f32_16x16x32_bf16 v[136:139], v[144:147], v[92:95], v[136:139]
  v_perm_b32 v102, v85, v84, s66
  v_perm_b32 v103, v87, v86, s66
  ds_read_b128 v[36:39], v4 offset:7168
  v_mfma_f32_32x32x16_bf16 v[72:87], v[24:27], v[16:19], 0
  v_exp_f32 v56, v56
  v_exp_f32 v57, v57
  v_exp_f32 v58, v58
  v_exp_f32 v59, v59
  v_perm_b32 v88, v57, v56, s66
  v_mfma_f32_32x32x16_bf16 v[120:135], v[48:51], v[96:99], v[120:135]
  v_exp_f32 v60, v60
  v_exp_f32 v61, v61
  v_perm_b32 v89, v59, v58, s66
  v_exp_f32 v62, v62
  v_exp_f32 v63, v63
  v_mfma_f32_32x32x16_bf16 v[72:87], v[28:31], v[20:23], v[72:87]
  v_perm_b32 v90, v61, v60, s66
  v_exp_f32 v64, v64
  v_exp_f32 v65, v65
  v_perm_b32 v91, v63, v62, s66
  v_exp_f32 v66, v66
  v_mfma_f32_16x16x32_bf16 v[140:143], v[144:147], v[96:99], v[140:143]
  v_exp_f32 v67, v67
  v_perm_b32 v92, v65, v64, s66
  v_mfma_f32_32x32x16_bf16 v[232:247], v[196:199], v[156:159], v[232:247]
  v_mfma_f32_32x32x16_bf16 v[120:135], v[52:55], v[100:103], v[120:135]
  v_exp_f32 v68, v68
  v_exp_f32 v69, v69
  v_perm_b32 v93, v67, v66, s66
  v_exp_f32 v70, v70
  v_exp_f32 v71, v71
  v_mfma_f32_16x16x32_bf16 v[140:143], v[144:147], v[100:103], v[140:143]
  v_perm_b32 v94, v69, v68, s66
  v_perm_b32 v95, v71, v70, s66
  s_waitcnt vmcnt(7)
  s_barrier
  s_setprio 3
  s_waitcnt lgkmcnt(1)
  v_mfma_f32_32x32x16_bf16 v[56:71], v[32:35], v[8:11], 0
  v_exp_f32 v72, v72
  v_exp_f32 v73, v73
  v_exp_f32 v74, v74
  v_exp_f32 v75, v75
  v_perm_b32 v96, v73, v72, s66
  v_mfma_f32_32x32x16_bf16 v[104:119], v[40:43], v[88:91], v[104:119]
  v_exp_f32 v76, v76
  v_exp_f32 v77, v77
  v_perm_b32 v97, v75, v74, s66
  v_exp_f32 v78, v78
  v_exp_f32 v79, v79
  s_add_u32 m0, s53, 98304
  s_add_u32 s54, s52, 229376
  buffer_load_dwordx4 v3, s[48:51], s54 offen lds
  s_waitcnt lgkmcnt(0)
  v_mfma_f32_32x32x16_bf16 v[56:71], v[36:39], v[12:15], v[56:71]
  v_perm_b32 v98, v77, v76, s66
  v_exp_f32 v80, v80
  v_exp_f32 v81, v81
  v_perm_b32 v99, v79, v78, s66
  v_exp_f32 v82, v82
  ds_read_b128 v[48:51], v4 offset:22528
  v_mfma_f32_16x16x32_bf16 v[136:139], v[144:147], v[88:91], v[136:139]
  v_exp_f32 v83, v83
  v_perm_b32 v100, v81, v80, s66
  ds_read_b128 v[52:55], v4 offset:23552
  v_mfma_f32_32x32x16_bf16 v[204:219], v[184:187], v[160:163], v[204:219]
  v_mfma_f32_32x32x16_bf16 v[104:119], v[44:47], v[92:95], v[104:119]
  v_exp_f32 v84, v84
  v_exp_f32 v85, v85
  v_perm_b32 v101, v83, v82, s66
  v_exp_f32 v86, v86
  v_exp_f32 v87, v87
  ds_read_b128 v[24:27], v4 offset:32768
  v_mfma_f32_16x16x32_bf16 v[136:139], v[144:147], v[92:95], v[136:139]
  v_perm_b32 v102, v85, v84, s66
  v_perm_b32 v103, v87, v86, s66
  ds_read_b128 v[28:31], v4 offset:33792
  v_mfma_f32_32x32x16_bf16 v[72:87], v[32:35], v[16:19], 0
  v_exp_f32 v56, v56
  v_exp_f32 v57, v57
  v_exp_f32 v58, v58
  v_exp_f32 v59, v59
  v_perm_b32 v88, v57, v56, s66
  v_mfma_f32_32x32x16_bf16 v[120:135], v[40:43], v[96:99], v[120:135]
  v_exp_f32 v60, v60
  v_exp_f32 v61, v61
  v_perm_b32 v89, v59, v58, s66
  v_exp_f32 v62, v62
  v_exp_f32 v63, v63
  s_add_u32 m0, s53, 99328
  s_add_u32 s54, s52, 230400
  buffer_load_dwordx4 v3, s[48:51], s54 offen lds
  v_mfma_f32_32x32x16_bf16 v[72:87], v[36:39], v[20:23], v[72:87]
  v_perm_b32 v90, v61, v60, s66
  v_exp_f32 v64, v64
  v_exp_f32 v65, v65
  v_perm_b32 v91, v63, v62, s66
  v_exp_f32 v66, v66
  v_mfma_f32_16x16x32_bf16 v[140:143], v[144:147], v[96:99], v[140:143]
  v_exp_f32 v67, v67
  v_perm_b32 v92, v65, v64, s66
  v_mfma_f32_32x32x16_bf16 v[232:247], v[200:203], v[160:163], v[232:247]
  v_mfma_f32_32x32x16_bf16 v[120:135], v[44:47], v[100:103], v[120:135]
  v_exp_f32 v68, v68
  v_exp_f32 v69, v69
  v_perm_b32 v93, v67, v66, s66
  v_exp_f32 v70, v70
  v_exp_f32 v71, v71
  v_mfma_f32_16x16x32_bf16 v[140:143], v[144:147], v[100:103], v[140:143]
  v_perm_b32 v94, v69, v68, s66
  v_perm_b32 v95, v71, v70, s66
  s_setprio 2
  s_waitcnt lgkmcnt(1)
  v_mfma_f32_32x32x16_bf16 v[56:71], v[24:27], v[8:11], 0
  v_exp_f32 v72, v72
  v_exp_f32 v73, v73
  v_exp_f32 v74, v74
  v_exp_f32 v75, v75
  v_perm_b32 v96, v73, v72, s66
  v_mfma_f32_32x32x16_bf16 v[104:119], v[48:51], v[88:91], v[104:119]
  v_exp_f32 v76, v76
  v_exp_f32 v77, v77
  v_perm_b32 v97, v75, v74, s66
  v_exp_f32 v78, v78
  v_exp_f32 v79, v79
  s_waitcnt lgkmcnt(0)
  v_mfma_f32_32x32x16_bf16 v[56:71], v[28:31], v[12:15], v[56:71]
  v_perm_b32 v98, v77, v76, s66
  v_exp_f32 v80, v80
  v_exp_f32 v81, v81
  v_perm_b32 v99, v79, v78, s66
  v_exp_f32 v82, v82
  ds_read_b128 v[40:43], v4 offset:49152
  v_mfma_f32_16x16x32_bf16 v[136:139], v[144:147], v[88:91], v[136:139]
  v_exp_f32 v83, v83
  v_perm_b32 v100, v81, v80, s66
  ds_read_b128 v[44:47], v4 offset:50176
  v_mfma_f32_32x32x16_bf16 v[104:119], v[52:55], v[92:95], v[104:119]
  v_exp_f32 v84, v84
  v_exp_f32 v85, v85
  v_perm_b32 v101, v83, v82, s66
  v_exp_f32 v86, v86
  v_exp_f32 v87, v87
  ds_read_b128 v[32:35], v4 offset:34816
  v_mfma_f32_16x16x32_bf16 v[136:139], v[144:147], v[92:95], v[136:139]
  v_perm_b32 v102, v85, v84, s66
  v_perm_b32 v103, v87, v86, s66
  ds_read_b128 v[36:39], v4 offset:35840
  v_mfma_f32_32x32x16_bf16 v[72:87], v[24:27], v[16:19], 0
  v_exp_f32 v56, v56
  v_exp_f32 v57, v57
  v_exp_f32 v58, v58
  v_exp_f32 v59, v59
  v_perm_b32 v88, v57, v56, s66
  v_add_f32 v232, 897988541, v232
  v_mfma_f32_32x32x16_bf16 v[120:135], v[48:51], v[96:99], v[120:135]
  v_exp_f32 v60, v60
  v_exp_f32 v61, v61
  v_perm_b32 v89, v59, v58, s66
  v_exp_f32 v62, v62
  v_exp_f32 v63, v63
  s_add_u32 m0, s53, 100352
  s_add_u32 s54, s52, 231424
  buffer_load_dwordx4 v3, s[48:51], s54 offen lds
  v_rcp_f32 v232, v232
  v_mfma_f32_32x32x16_bf16 v[72:87], v[28:31], v[20:23], v[72:87]
  v_perm_b32 v90, v61, v60, s66
  v_exp_f32 v64, v64
  v_exp_f32 v65, v65
  v_perm_b32 v91, v63, v62, s66
  v_exp_f32 v66, v66
  v_pk_mul_f32 v[204:205], v[204:205], v[232:233] op_sel_hi:[1,0]
  v_mfma_f32_16x16x32_bf16 v[140:143], v[144:147], v[96:99], v[140:143]
  v_exp_f32 v67, v67
  v_perm_b32 v92, v65, v64, s66
  v_pk_mul_f32 v[206:207], v[206:207], v[232:233] op_sel_hi:[1,0]
  v_mfma_f32_32x32x16_bf16 v[120:135], v[52:55], v[100:103], v[120:135]
  v_exp_f32 v68, v68
  v_exp_f32 v69, v69
  v_perm_b32 v93, v67, v66, s66
  v_exp_f32 v70, v70
  v_exp_f32 v71, v71
  v_pk_mul_f32 v[208:209], v[208:209], v[232:233] op_sel_hi:[1,0]
  v_mfma_f32_16x16x32_bf16 v[140:143], v[144:147], v[100:103], v[140:143]
  v_perm_b32 v94, v69, v68, s66
  v_perm_b32 v95, v71, v70, s66
  v_pk_mul_f32 v[210:211], v[210:211], v[232:233] op_sel_hi:[1,0]
  s_setprio 1
  s_waitcnt lgkmcnt(1)
  v_mfma_f32_32x32x16_bf16 v[56:71], v[32:35], v[8:11], 0
  v_exp_f32 v72, v72
  v_exp_f32 v73, v73
  v_exp_f32 v74, v74
  v_exp_f32 v75, v75
  v_perm_b32 v96, v73, v72, s66
  v_mfma_f32_32x32x16_bf16 v[104:119], v[40:43], v[88:91], v[104:119]
  v_exp_f32 v76, v76
  v_exp_f32 v77, v77
  v_perm_b32 v97, v75, v74, s66
  v_exp_f32 v78, v78
  v_exp_f32 v79, v79
  s_waitcnt lgkmcnt(0)
  v_mfma_f32_32x32x16_bf16 v[56:71], v[36:39], v[12:15], v[56:71]
  v_perm_b32 v98, v77, v76, s66
  v_exp_f32 v80, v80
  v_exp_f32 v81, v81
  v_perm_b32 v99, v79, v78, s66
  v_exp_f32 v82, v82
  ds_read_b128 v[48:51], v4 offset:51200
  v_pk_mul_f32 v[212:213], v[212:213], v[232:233] op_sel_hi:[1,0]
  v_mfma_f32_16x16x32_bf16 v[136:139], v[144:147], v[88:91], v[136:139]
  v_exp_f32 v83, v83
  v_perm_b32 v100, v81, v80, s66
  ds_read_b128 v[52:55], v4 offset:52224
  v_pk_mul_f32 v[214:215], v[214:215], v[232:233] op_sel_hi:[1,0]
  v_mfma_f32_32x32x16_bf16 v[104:119], v[44:47], v[92:95], v[104:119]
  v_exp_f32 v84, v84
  v_exp_f32 v85, v85
  v_perm_b32 v101, v83, v82, s66
  v_exp_f32 v86, v86
  v_exp_f32 v87, v87
  ds_read_b128 v[24:27], v4 offset:36864
  v_pk_mul_f32 v[216:217], v[216:217], v[232:233] op_sel_hi:[1,0]
  v_mfma_f32_16x16x32_bf16 v[136:139], v[144:147], v[92:95], v[136:139]
  v_perm_b32 v102, v85, v84, s66
  v_perm_b32 v103, v87, v86, s66
  ds_read_b128 v[28:31], v4 offset:37888
  v_pk_mul_f32 v[218:219], v[218:219], v[232:233] op_sel_hi:[1,0]
  v_mfma_f32_32x32x16_bf16 v[72:87], v[32:35], v[16:19], 0
  v_exp_f32 v56, v56
  v_exp_f32 v57, v57
  v_exp_f32 v58, v58
  v_exp_f32 v59, v59
  v_perm_b32 v88, v57, v56, s66
  v_cvt_pk_bf16_f32 v220, v204, v205
  v_mfma_f32_32x32x16_bf16 v[120:135], v[40:43], v[96:99], v[120:135]
  v_exp_f32 v60, v60
  v_exp_f32 v61, v61
  v_perm_b32 v89, v59, v58, s66
  v_exp_f32 v62, v62
  v_exp_f32 v63, v63
  s_add_u32 m0, s53, 101376
  s_add_u32 s54, s52, 232448
  buffer_load_dwordx4 v3, s[48:51], s54 offen lds
  v_cvt_pk_bf16_f32 v221, v206, v207
  v_mfma_f32_32x32x16_bf16 v[72:87], v[36:39], v[20:23], v[72:87]
  v_perm_b32 v90, v61, v60, s66
  v_exp_f32 v64, v64
  v_exp_f32 v65, v65
  v_perm_b32 v91, v63, v62, s66
  v_exp_f32 v66, v66
  v_cvt_pk_bf16_f32 v222, v208, v209
  v_mfma_f32_16x16x32_bf16 v[140:143], v[144:147], v[96:99], v[140:143]
  v_exp_f32 v67, v67
  v_perm_b32 v92, v65, v64, s66
  v_cvt_pk_bf16_f32 v223, v210, v211
  v_mfma_f32_32x32x16_bf16 v[120:135], v[44:47], v[100:103], v[120:135]
  v_exp_f32 v68, v68
  v_exp_f32 v69, v69
  v_perm_b32 v93, v67, v66, s66
  v_exp_f32 v70, v70
  v_exp_f32 v71, v71
  v_mfma_f32_16x16x32_bf16 v[140:143], v[144:147], v[100:103], v[140:143]
  v_perm_b32 v94, v69, v68, s66
  v_perm_b32 v95, v71, v70, s66
  buffer_store_dwordx4 v[220:223], v3, s[48:51], s59 offen offset:0 sc0 sc1
  s_setprio 0
  s_waitcnt lgkmcnt(1)
  v_mfma_f32_32x32x16_bf16 v[56:71], v[24:27], v[8:11], 0
  v_exp_f32 v72, v72
  v_exp_f32 v73, v73
  v_exp_f32 v74, v74
  v_exp_f32 v75, v75
  v_perm_b32 v96, v73, v72, s66
  v_cvt_pk_bf16_f32 v224, v212, v213
  v_mfma_f32_32x32x16_bf16 v[104:119], v[48:51], v[88:91], v[104:119]
  v_exp_f32 v76, v76
  v_exp_f32 v77, v77
  v_perm_b32 v97, v75, v74, s66
  v_exp_f32 v78, v78
  v_exp_f32 v79, v79
  v_cvt_pk_bf16_f32 v225, v214, v215
  s_waitcnt lgkmcnt(0)
  v_mfma_f32_32x32x16_bf16 v[56:71], v[28:31], v[12:15], v[56:71]
  v_perm_b32 v98, v77, v76, s66
  v_exp_f32 v80, v80
  v_exp_f32 v81, v81
  v_perm_b32 v99, v79, v78, s66
  v_exp_f32 v82, v82
  ds_read_b128 v[40:43], v4 offset:53248
  v_cvt_pk_bf16_f32 v226, v216, v217
  v_mfma_f32_16x16x32_bf16 v[136:139], v[144:147], v[88:91], v[136:139]
  v_exp_f32 v83, v83
  v_perm_b32 v100, v81, v80, s66
  ds_read_b128 v[44:47], v4 offset:54272
  v_cvt_pk_bf16_f32 v227, v218, v219
  v_mfma_f32_32x32x16_bf16 v[104:119], v[52:55], v[92:95], v[104:119]
  v_exp_f32 v84, v84
  v_exp_f32 v85, v85
  v_perm_b32 v101, v83, v82, s66
  v_exp_f32 v86, v86
  v_exp_f32 v87, v87
  ds_read_b128 v[32:35], v4 offset:38912
  v_mfma_f32_16x16x32_bf16 v[136:139], v[144:147], v[92:95], v[136:139]
  v_perm_b32 v102, v85, v84, s66
  v_perm_b32 v103, v87, v86, s66
  ds_read_b128 v[36:39], v4 offset:39936
  buffer_store_dwordx4 v[224:227], v3, s[48:51], s59 offen offset:1024 sc0 sc1
  v_mfma_f32_32x32x16_bf16 v[72:87], v[24:27], v[16:19], 0
  v_exp_f32 v56, v56
  v_exp_f32 v57, v57
  v_exp_f32 v58, v58
  v_exp_f32 v59, v59
  v_perm_b32 v88, v57, v56, s66
  v_mfma_f32_32x32x16_bf16 v[120:135], v[48:51], v[96:99], v[120:135]
  v_exp_f32 v60, v60
  v_exp_f32 v61, v61
  v_perm_b32 v89, v59, v58, s66
  v_exp_f32 v62, v62
  v_exp_f32 v63, v63
  v_mfma_f32_32x32x16_bf16 v[72:87], v[28:31], v[20:23], v[72:87]
  v_perm_b32 v90, v61, v60, s66
  v_exp_f32 v64, v64
  v_exp_f32 v65, v65
  v_perm_b32 v91, v63, v62, s66
  v_exp_f32 v66, v66
  v_mfma_f32_16x16x32_bf16 v[140:143], v[144:147], v[96:99], v[140:143]
  v_exp_f32 v67, v67
  v_perm_b32 v92, v65, v64, s66
  v_mfma_f32_32x32x16_bf16 v[120:135], v[52:55], v[100:103], v[120:135]
  v_exp_f32 v68, v68
  v_exp_f32 v69, v69
  v_perm_b32 v93, v67, v66, s66
  v_exp_f32 v70, v70
  v_exp_f32 v71, v71
  v_mfma_f32_16x16x32_bf16 v[140:143], v[144:147], v[100:103], v[140:143]
  v_perm_b32 v94, v69, v68, s66
  v_perm_b32 v95, v71, v70, s66
  s_waitcnt vmcnt(7)
  s_barrier
  s_setprio 3
  s_waitcnt lgkmcnt(1)
  v_mfma_f32_32x32x16_bf16 v[56:71], v[32:35], v[8:11], 0
  v_exp_f32 v72, v72
  v_exp_f32 v73, v73
  v_exp_f32 v74, v74
  v_exp_f32 v75, v75
  v_perm_b32 v96, v73, v72, s66
  v_mfma_f32_32x32x16_bf16 v[104:119], v[40:43], v[88:91], v[104:119]
  v_exp_f32 v76, v76
  v_exp_f32 v77, v77
  v_perm_b32 v97, v75, v74, s66
  v_exp_f32 v78, v78
  v_exp_f32 v79, v79
  s_waitcnt lgkmcnt(0)
  v_mfma_f32_32x32x16_bf16 v[56:71], v[36:39], v[12:15], v[56:71]
  v_perm_b32 v98, v77, v76, s66
  v_exp_f32 v80, v80
  v_exp_f32 v81, v81
  v_perm_b32 v99, v79, v78, s66
  v_exp_f32 v82, v82
  ds_read_b128 v[48:51], v4 offset:55296
  v_mfma_f32_16x16x32_bf16 v[136:139], v[144:147], v[88:91], v[136:139]
  v_exp_f32 v83, v83
  v_perm_b32 v100, v81, v80, s66
  ds_read_b128 v[52:55], v4 offset:56320
  v_mfma_f32_32x32x16_bf16 v[104:119], v[44:47], v[92:95], v[104:119]
  v_exp_f32 v84, v84
  v_exp_f32 v85, v85
  v_perm_b32 v101, v83, v82, s66
  v_exp_f32 v86, v86
  v_exp_f32 v87, v87
  ds_read_b128 v[24:27], v5 offset:0
  v_mfma_f32_16x16x32_bf16 v[136:139], v[144:147], v[92:95], v[136:139]
  v_perm_b32 v102, v85, v84, s66
  v_perm_b32 v103, v87, v86, s66
  ds_read_b128 v[28:31], v5 offset:1024
  v_mfma_f32_32x32x16_bf16 v[72:87], v[32:35], v[16:19], 0
  v_exp_f32 v56, v56
  v_exp_f32 v57, v57
  v_exp_f32 v58, v58
  v_exp_f32 v59, v59
  v_perm_b32 v88, v57, v56, s66
  v_mfma_f32_32x32x16_bf16 v[120:135], v[40:43], v[96:99], v[120:135]
  v_exp_f32 v60, v60
  v_exp_f32 v61, v61
  v_perm_b32 v89, v59, v58, s66
  v_exp_f32 v62, v62
  v_exp_f32 v63, v63
  v_mfma_f32_32x32x16_bf16 v[72:87], v[36:39], v[20:23], v[72:87]
  v_perm_b32 v90, v61, v60, s66
  v_exp_f32 v64, v64
  v_exp_f32 v65, v65
  v_perm_b32 v91, v63, v62, s66
  v_exp_f32 v66, v66
  v_mfma_f32_16x16x32_bf16 v[140:143], v[144:147], v[96:99], v[140:143]
  v_exp_f32 v67, v67
  v_perm_b32 v92, v65, v64, s66
  v_mfma_f32_32x32x16_bf16 v[120:135], v[44:47], v[100:103], v[120:135]
  v_exp_f32 v68, v68
  v_exp_f32 v69, v69
  v_perm_b32 v93, v67, v66, s66
  v_exp_f32 v70, v70
  v_exp_f32 v71, v71
  v_mfma_f32_16x16x32_bf16 v[140:143], v[144:147], v[100:103], v[140:143]
  v_perm_b32 v94, v69, v68, s66
  v_perm_b32 v95, v71, v70, s66
  s_setprio 2
  s_waitcnt lgkmcnt(1)
  v_mfma_f32_32x32x16_bf16 v[56:71], v[24:27], v[8:11], 0
  v_exp_f32 v72, v72
  v_exp_f32 v73, v73
  v_exp_f32 v74, v74
  v_exp_f32 v75, v75
  v_perm_b32 v96, v73, v72, s66
  s_waitcnt vmcnt(0)
  s_mov_b64 exec, 1
  buffer_store_dword v166, v167, s[48:51], s64 offen sc0 sc1
  s_mov_b64 exec, -1
  v_mfma_f32_32x32x16_bf16 v[104:119], v[48:51], v[88:91], v[104:119]
  v_exp_f32 v76, v76
  v_exp_f32 v77, v77
  v_perm_b32 v97, v75, v74, s66
  v_exp_f32 v78, v78
  v_exp_f32 v79, v79
  s_waitcnt lgkmcnt(0)
  v_mfma_f32_32x32x16_bf16 v[56:71], v[28:31], v[12:15], v[56:71]
  v_perm_b32 v98, v77, v76, s66
  v_exp_f32 v80, v80
  v_exp_f32 v81, v81
  v_perm_b32 v99, v79, v78, s66
  v_exp_f32 v82, v82
  ds_read_b128 v[40:43], v5 offset:16384
  v_mfma_f32_16x16x32_bf16 v[136:139], v[144:147], v[88:91], v[136:139]
  v_exp_f32 v83, v83
  v_perm_b32 v100, v81, v80, s66
  ds_read_b128 v[44:47], v5 offset:17408
  v_mfma_f32_32x32x16_bf16 v[104:119], v[52:55], v[92:95], v[104:119]
  v_exp_f32 v84, v84
  v_exp_f32 v85, v85
  v_perm_b32 v101, v83, v82, s66
  v_exp_f32 v86, v86
  v_exp_f32 v87, v87
  ds_read_b128 v[32:35], v5 offset:2048
  v_mfma_f32_16x16x32_bf16 v[136:139], v[144:147], v[92:95], v[136:139]
  v_perm_b32 v102, v85, v84, s66
  v_perm_b32 v103, v87, v86, s66
  ds_read_b128 v[36:39], v5 offset:3072
  v_mfma_f32_32x32x16_bf16 v[72:87], v[24:27], v[16:19], 0
  v_exp_f32 v56, v56
  v_exp_f32 v57, v57
  v_exp_f32 v58, v58
  v_exp_f32 v59, v59
  v_perm_b32 v88, v57, v56, s66
  v_mfma_f32_32x32x16_bf16 v[120:135], v[48:51], v[96:99], v[120:135]
  v_exp_f32 v60, v60
  v_exp_f32 v61, v61
  v_perm_b32 v89, v59, v58, s66
  v_exp_f32 v62, v62
  v_exp_f32 v63, v63
  v_mfma_f32_32x32x16_bf16 v[72:87], v[28:31], v[20:23], v[72:87]
  v_perm_b32 v90, v61, v60, s66
  v_exp_f32 v64, v64
  v_exp_f32 v65, v65
  v_perm_b32 v91, v63, v62, s66
  v_exp_f32 v66, v66
  v_mfma_f32_16x16x32_bf16 v[140:143], v[144:147], v[96:99], v[140:143]
  v_exp_f32 v67, v67
  v_perm_b32 v92, v65, v64, s66
  v_mfma_f32_32x32x16_bf16 v[120:135], v[52:55], v[100:103], v[120:135]
  v_exp_f32 v68, v68
  v_exp_f32 v69, v69
  v_perm_b32 v93, v67, v66, s66
  v_exp_f32 v70, v70
  v_exp_f32 v71, v71
  v_mfma_f32_16x16x32_bf16 v[140:143], v[144:147], v[100:103], v[140:143]
  v_perm_b32 v94, v69, v68, s66
  v_perm_b32 v95, v71, v70, s66
  s_setprio 1
  s_waitcnt lgkmcnt(1)
  v_mfma_f32_32x32x16_bf16 v[56:71], v[32:35], v[8:11], 0
  v_exp_f32 v72, v72
  v_exp_f32 v73, v73
  v_exp_f32 v74, v74
  v_exp_f32 v75, v75
  v_perm_b32 v96, v73, v72, s66
  buffer_load_dword v165, v164, s[48:51], s68 offen sc0 sc1
  v_mfma_f32_32x32x16_bf16 v[104:119], v[40:43], v[88:91], v[104:119]
  v_exp_f32 v76, v76
  v_exp_f32 v77, v77
  v_perm_b32 v97, v75, v74, s66
  v_exp_f32 v78, v78
  v_exp_f32 v79, v79
  s_waitcnt lgkmcnt(0)
  v_mfma_f32_32x32x16_bf16 v[56:71], v[36:39], v[12:15], v[56:71]
  v_perm_b32 v98, v77, v76, s66
  v_exp_f32 v80, v80
  v_exp_f32 v81, v81
  v_perm_b32 v99, v79, v78, s66
  v_exp_f32 v82, v82
  ds_read_b128 v[48:51], v5 offset:18432
  v_mfma_f32_16x16x32_bf16 v[136:139], v[144:147], v[88:91], v[136:139]
  v_exp_f32 v83, v83
  v_perm_b32 v100, v81, v80, s66
  ds_read_b128 v[52:55], v5 offset:19456
  v_mfma_f32_32x32x16_bf16 v[104:119], v[44:47], v[92:95], v[104:119]
  v_exp_f32 v84, v84
  v_exp_f32 v85, v85
  v_perm_b32 v101, v83, v82, s66
  v_exp_f32 v86, v86
  v_exp_f32 v87, v87
  ds_read_b128 v[24:27], v5 offset:4096
  v_mfma_f32_16x16x32_bf16 v[136:139], v[144:147], v[92:95], v[136:139]
  v_perm_b32 v102, v85, v84, s66
  v_perm_b32 v103, v87, v86, s66
  ds_read_b128 v[28:31], v5 offset:5120
  v_mfma_f32_32x32x16_bf16 v[72:87], v[32:35], v[16:19], 0
  v_exp_f32 v56, v56
  v_exp_f32 v57, v57
  v_exp_f32 v58, v58
  v_exp_f32 v59, v59
  v_perm_b32 v88, v57, v56, s66
  v_mfma_f32_32x32x16_bf16 v[120:135], v[40:43], v[96:99], v[120:135]
  v_exp_f32 v60, v60
  v_exp_f32 v61, v61
  v_perm_b32 v89, v59, v58, s66
  v_exp_f32 v62, v62
  v_exp_f32 v63, v63
  v_mfma_f32_32x32x16_bf16 v[72:87], v[36:39], v[20:23], v[72:87]
  v_perm_b32 v90, v61, v60, s66
  v_exp_f32 v64, v64
  v_exp_f32 v65, v65
  v_perm_b32 v91, v63, v62, s66
  v_exp_f32 v66, v66
  v_mfma_f32_16x16x32_bf16 v[140:143], v[144:147], v[96:99], v[140:143]
  v_exp_f32 v67, v67
  v_perm_b32 v92, v65, v64, s66
  v_mfma_f32_32x32x16_bf16 v[120:135], v[44:47], v[100:103], v[120:135]
  v_exp_f32 v68, v68
  v_exp_f32 v69, v69
  v_perm_b32 v93, v67, v66, s66
  v_exp_f32 v70, v70
  v_exp_f32 v71, v71
  v_mfma_f32_16x16x32_bf16 v[140:143], v[144:147], v[100:103], v[140:143]
  v_perm_b32 v94, v69, v68, s66
  v_perm_b32 v95, v71, v70, s66
  s_setprio 0
  s_waitcnt lgkmcnt(1)
  v_mfma_f32_32x32x16_bf16 v[56:71], v[24:27], v[8:11], 0
  v_exp_f32 v72, v72
  v_exp_f32 v73, v73
  v_exp_f32 v74, v74
  v_exp_f32 v75, v75
  v_perm_b32 v96, v73, v72, s66
  s_waitcnt vmcnt(0)
  v_cmp_ne_u32 vcc, s69, v165
  s_cmp_eq_u64 vcc, 0
  s_cselect_b32 s69, 1, 0
  v_mfma_f32_32x32x16_bf16 v[104:119], v[48:51], v[88:91], v[104:119]
  v_exp_f32 v76, v76
  v_exp_f32 v77, v77
  v_perm_b32 v97, v75, v74, s66
  v_exp_f32 v78, v78
  v_exp_f32 v79, v79
  s_waitcnt lgkmcnt(0)
  v_mfma_f32_32x32x16_bf16 v[56:71], v[28:31], v[12:15], v[56:71]
  v_perm_b32 v98, v77, v76, s66
  v_exp_f32 v80, v80
  v_exp_f32 v81, v81
  v_perm_b32 v99, v79, v78, s66
  v_exp_f32 v82, v82
  ds_read_b128 v[40:43], v5 offset:20480
  v_mfma_f32_16x16x32_bf16 v[136:139], v[144:147], v[88:91], v[136:139]
  v_exp_f32 v83, v83
  v_perm_b32 v100, v81, v80, s66
  ds_read_b128 v[44:47], v5 offset:21504
  v_mfma_f32_32x32x16_bf16 v[104:119], v[52:55], v[92:95], v[104:119]
  v_exp_f32 v84, v84
  v_exp_f32 v85, v85
  v_perm_b32 v101, v83, v82, s66
  v_exp_f32 v86, v86
  v_exp_f32 v87, v87
  ds_read_b128 v[32:35], v5 offset:6144
  v_mfma_f32_16x16x32_bf16 v[136:139], v[144:147], v[92:95], v[136:139]
  v_perm_b32 v102, v85, v84, s66
  v_perm_b32 v103, v87, v86, s66
  ds_read_b128 v[36:39], v5 offset:7168
  v_mfma_f32_32x32x16_bf16 v[72:87], v[24:27], v[16:19], 0
  v_exp_f32 v56, v56
  v_exp_f32 v57, v57
  v_exp_f32 v58, v58
  v_exp_f32 v59, v59
  v_perm_b32 v88, v57, v56, s66
  s_and_b32 s3, s5, 3
  v_lshrrev_b32 v176, 4, v2
  s_and_b32 s9, s5, 1
  s_lshl_b32 s9, s9, 2
  v_mfma_f32_32x32x16_bf16 v[120:135], v[48:51], v[96:99], v[120:135]
  v_exp_f32 v60, v60
  v_exp_f32 v61, v61
  v_perm_b32 v89, v59, v58, s66
  v_exp_f32 v62, v62
  v_exp_f32 v63, v63
  v_bfe_u32 v175, v2, 1, 3
  v_xor_b32 v175, v175, v176
  v_mfma_f32_32x32x16_bf16 v[72:87], v[28:31], v[20:23], v[72:87]
  v_perm_b32 v90, v61, v60, s66
  v_exp_f32 v64, v64
  v_exp_f32 v65, v65
  v_perm_b32 v91, v63, v62, s66
  v_exp_f32 v66, v66
  s_mov_b32 exec_hi, 0
  buffer_load_dword v169, v168, s[48:51], s60 offen
  s_mov_b32 exec_hi, -1
  v_mfma_f32_16x16x32_bf16 v[140:143], v[144:147], v[96:99], v[140:143]
  v_exp_f32 v67, v67
  v_perm_b32 v92, v65, v64, s66
  v_xor_b32 v175, s9, v175
  s_lshl_b32 s9, s3, 4
  v_add_u32 v176, s9, v176
  v_mfma_f32_32x32x16_bf16 v[120:135], v[52:55], v[100:103], v[120:135]
  v_exp_f32 v68, v68
  v_exp_f32 v69, v69
  v_perm_b32 v93, v67, v66, s66
  v_exp_f32 v70, v70
  v_exp_f32 v71, v71
  v_mfma_f32_16x16x32_bf16 v[140:143], v[144:147], v[100:103], v[140:143]
  v_perm_b32 v94, v69, v68, s66
  v_perm_b32 v95, v71, v70, s66
  v_lshlrev_b32 v172, 11, v176
  v_lshl_add_u32 v172, v175, 5, v172
  s_barrier
  s_setprio 3
  s_waitcnt lgkmcnt(1)
  v_mfma_f32_32x32x16_bf16 v[56:71], v[32:35], v[8:11], 0
  v_exp_f32 v72, v72
  v_exp_f32 v73, v73
  v_exp_f32 v74, v74
  v_exp_f32 v75, v75
  v_perm_b32 v96, v73, v72, s66
  v_and_b32 v177, 1, v2
  v_lshl_add_u32 v172, v177, 4, v172
  s_lshl_b32 s9, s3, 16
  v_mfma_f32_32x32x16_bf16 v[104:119], v[40:43], v[88:91], v[104:119]
  v_exp_f32 v76, v76
  v_exp_f32 v77, v77
  v_perm_b32 v97, v75, v74, s66
  v_exp_f32 v78, v78
  v_exp_f32 v79, v79
  v_add_u32 v173, s9, v3
  s_and_b32 s4, s2, 7
  s_mul_i32 s94, s4, 6
  s_and_b32 s4, s61, 3
  s_mul_i32 s4, s4, 8
  s_add_u32 s94, s94, s4
  s_mul_i32 s4, s62, 2
  s_add_u32 s94, s94, s4
  s_waitcnt lgkmcnt(0)
  v_mfma_f32_32x32x16_bf16 v[56:71], v[36:39], v[12:15], v[56:71]
  v_perm_b32 v98, v77, v76, s66
  v_exp_f32 v80, v80
  v_exp_f32 v81, v81
  v_perm_b32 v99, v79, v78, s66
  v_exp_f32 v82, v82
  ds_read_b128 v[48:51], v5 offset:22528
  v_mfma_f32_16x16x32_bf16 v[136:139], v[144:147], v[88:91], v[136:139]
  v_exp_f32 v83, v83
  v_perm_b32 v100, v81, v80, s66
  ds_read_b128 v[52:55], v5 offset:23552
  s_lshl_b32 s9, s3, 12
  s_add_u32 s31, s9, 16384
  s_lshl_b32 s3, s62, 8
  s_cmp_ge_u32 s5, 4
  s_cselect_b64 vcc, -1, 0
  s_cselect_b32 s31, s9, s31
  s_cselect_b32 s30, 17, 12
  s_cselect_b32 s20, s3, 0
  s_cselect_b32 s28, 13, 10
  s_cselect_b32 s95, 1, 0
  s_cselect_b32 s21, s63, 0
  s_lshl_b32 s28, 1, s28
  v_mfma_f32_32x32x16_bf16 v[104:119], v[44:47], v[92:95], v[104:119]
  v_exp_f32 v84, v84
  v_exp_f32 v85, v85
  v_perm_b32 v101, v83, v82, s66
  v_exp_f32 v86, v86
  v_exp_f32 v87, v87
  ds_read_b128 v[24:27], v5 offset:32768
  v_mfma_f32_16x16x32_bf16 v[136:139], v[144:147], v[92:95], v[136:139]
  v_perm_b32 v102, v85, v84, s66
  v_perm_b32 v103, v87, v86, s66
  ds_read_b128 v[28:31], v5 offset:33792
  v_cndmask_b32 v174, v173, v172, vcc
  s_cmp_ge_u32 s5, 4
  s_cselect_b32 s24, s40, s36
  s_cselect_b32 s25, s41, s37
  s_cselect_b32 s26, s42, s38
  s_mov_b32 s27, 0x00020000
  v_mfma_f32_32x32x16_bf16 v[72:87], v[32:35], v[16:19], 0
  v_exp_f32 v56, v56
  v_exp_f32 v57, v57
  v_exp_f32 v58, v58
  v_exp_f32 v59, v59
  v_perm_b32 v88, v57, v56, s66
  v_mfma_f32_32x32x16_bf16 v[120:135], v[40:43], v[96:99], v[120:135]
  v_exp_f32 v60, v60
  v_exp_f32 v61, v61
  v_perm_b32 v89, v59, v58, s66
  v_exp_f32 v62, v62
  v_exp_f32 v63, v63
  s_cmp_eq_u32 s21, 0
  s_cbranch_scc1 K2_np2
  s_add_u32 s29, s94, 2
  s_and_b32 s29, s29, 15
  s_lshl_b32 s29, s29, s30
  s_add_u32 s29, s29, s20
  s_add_u32 m0, s31, 32768
  s_nop 0
  buffer_load_dwordx4 v174, s[24:27], s29 offen lds
  s_add_u32 s29, s29, s28
  s_add_u32 m0, s31, 33792
  s_nop 0
  buffer_load_dwordx4 v174, s[24:27], s29 offen lds
  s_add_u32 s29, s29, s28
  s_add_u32 m0, s31, 34816
  s_nop 0
  buffer_load_dwordx4 v174, s[24:27], s29 offen lds
  s_add_u32 s29, s29, s28
  s_add_u32 m0, s31, 35840
  s_nop 0
  buffer_load_dwordx4 v174, s[24:27], s29 offen lds
K2_np2:
  v_mfma_f32_32x32x16_bf16 v[72:87], v[36:39], v[20:23], v[72:87]
  v_perm_b32 v90, v61, v60, s66
  v_exp_f32 v64, v64
  v_exp_f32 v65, v65
  v_perm_b32 v91, v63, v62, s66
  v_exp_f32 v66, v66
  v_mfma_f32_16x16x32_bf16 v[140:143], v[144:147], v[96:99], v[140:143]
  v_exp_f32 v67, v67
  v_perm_b32 v92, v65, v64, s66
  v_mfma_f32_32x32x16_bf16 v[120:135], v[44:47], v[100:103], v[120:135]
  v_exp_f32 v68, v68
  v_exp_f32 v69, v69
  v_perm_b32 v93, v67, v66, s66
  v_exp_f32 v70, v70
  v_exp_f32 v71, v71
  s_cmp_eq_u32 s21, 0
  s_cbranch_scc1 K2_np3
  s_add_u32 s29, s94, 3
  s_and_b32 s29, s29, 15
  s_lshl_b32 s29, s29, s30
  s_add_u32 s29, s29, s20
  s_add_u32 m0, s31, 65536
  s_nop 0
  buffer_load_dwordx4 v174, s[24:27], s29 offen lds
  s_add_u32 s29, s29, s28
  s_add_u32 m0, s31, 66560
  s_nop 0
  buffer_load_dwordx4 v174, s[24:27], s29 offen lds
  s_add_u32 s29, s29, s28
  s_add_u32 m0, s31, 67584
  s_nop 0
  buffer_load_dwordx4 v174, s[24:27], s29 offen lds
  s_add_u32 s29, s29, s28
  s_add_u32 m0, s31, 68608
  s_nop 0
  buffer_load_dwordx4 v174, s[24:27], s29 offen lds
K2_np3:
  v_mfma_f32_16x16x32_bf16 v[140:143], v[144:147], v[100:103], v[140:143]
  v_perm_b32 v94, v69, v68, s66
  v_perm_b32 v95, v71, v70, s66
  s_waitcnt lgkmcnt(1)
  v_mfma_f32_32x32x16_bf16 v[56:71], v[24:27], v[8:11], 0
  v_exp_f32 v72, v72
  v_exp_f32 v73, v73
  v_exp_f32 v74, v74
  v_exp_f32 v75, v75
  v_perm_b32 v96, v73, v72, s66
  buffer_load_dword v165, v164, s[48:51], s34 offen sc0 sc1
  v_mfma_f32_32x32x16_bf16 v[104:119], v[48:51], v[88:91], v[104:119]
  v_exp_f32 v76, v76
  v_exp_f32 v77, v77
  v_perm_b32 v97, v75, v74, s66
  v_exp_f32 v78, v78
  v_exp_f32 v79, v79
  s_waitcnt lgkmcnt(0)
  v_mfma_f32_32x32x16_bf16 v[56:71], v[28:31], v[12:15], v[56:71]
  v_perm_b32 v98, v77, v76, s66
  v_exp_f32 v80, v80
  v_exp_f32 v81, v81
  v_perm_b32 v99, v79, v78, s66
  v_exp_f32 v82, v82
  ds_read_b128 v[40:43], v5 offset:49152
  v_mfma_f32_16x16x32_bf16 v[136:139], v[144:147], v[88:91], v[136:139]
  v_exp_f32 v83, v83
  v_perm_b32 v100, v81, v80, s66
  ds_read_b128 v[44:47], v5 offset:50176
  v_mfma_f32_32x32x16_bf16 v[104:119], v[52:55], v[92:95], v[104:119]
  v_exp_f32 v84, v84
  v_exp_f32 v85, v85
  v_perm_b32 v101, v83, v82, s66
  v_exp_f32 v86, v86
  v_exp_f32 v87, v87
  ds_read_b128 v[32:35], v5 offset:34816
  v_mfma_f32_16x16x32_bf16 v[136:139], v[144:147], v[92:95], v[136:139]
  v_perm_b32 v102, v85, v84, s66
  v_perm_b32 v103, v87, v86, s66
  ds_read_b128 v[36:39], v5 offset:35840
  s_setprio 2
  v_mfma_f32_32x32x16_bf16 v[72:87], v[24:27], v[16:19], 0
  v_exp_f32 v56, v56
  v_exp_f32 v57, v57
  v_exp_f32 v58, v58
  v_exp_f32 v59, v59
  v_perm_b32 v88, v57, v56, s66
  v_mfma_f32_32x32x16_bf16 v[120:135], v[48:51], v[96:99], v[120:135]
  v_exp_f32 v60, v60
  v_exp_f32 v61, v61
  v_perm_b32 v89, v59, v58, s66
  v_exp_f32 v62, v62
  v_exp_f32 v63, v63
  v_mfma_f32_32x32x16_bf16 v[72:87], v[28:31], v[20:23], v[72:87]
  v_perm_b32 v90, v61, v60, s66
  v_exp_f32 v64, v64
  v_exp_f32 v65, v65
  v_perm_b32 v91, v63, v62, s66
  v_exp_f32 v66, v66
  v_mfma_f32_16x16x32_bf16 v[140:143], v[144:147], v[96:99], v[140:143]
  v_exp_f32 v67, v67
  v_perm_b32 v92, v65, v64, s66
  v_mfma_f32_32x32x16_bf16 v[120:135], v[52:55], v[100:103], v[120:135]
  v_exp_f32 v68, v68
  v_exp_f32 v69, v69
  v_perm_b32 v93, v67, v66, s66
  v_exp_f32 v70, v70
  v_exp_f32 v71, v71
  v_mfma_f32_16x16x32_bf16 v[140:143], v[144:147], v[100:103], v[140:143]
  v_perm_b32 v94, v69, v68, s66
  v_perm_b32 v95, v71, v70, s66
  s_waitcnt lgkmcnt(1)
  v_mfma_f32_32x32x16_bf16 v[56:71], v[32:35], v[8:11], 0
  v_exp_f32 v72, v72
  v_exp_f32 v73, v73
  v_exp_f32 v74, v74
  v_exp_f32 v75, v75
  v_perm_b32 v96, v73, v72, s66
  s_waitcnt vmcnt(0)
  v_cmp_ne_u32 vcc, 1, v165
  s_cmp_eq_u64 vcc, 0
  s_cselect_b32 s95, 1, s95
  v_mfma_f32_32x32x16_bf16 v[104:119], v[40:43], v[88:91], v[104:119]
  v_exp_f32 v76, v76
  v_exp_f32 v77, v77
  v_perm_b32 v97, v75, v74, s66
  v_exp_f32 v78, v78
  v_exp_f32 v79, v79
  s_waitcnt lgkmcnt(0)
  v_mfma_f32_32x32x16_bf16 v[56:71], v[36:39], v[12:15], v[56:71]
  v_perm_b32 v98, v77, v76, s66
  v_exp_f32 v80, v80
  v_exp_f32 v81, v81
  v_perm_b32 v99, v79, v78, s66
  v_exp_f32 v82, v82
  ds_read_b128 v[48:51], v5 offset:51200
  v_mfma_f32_16x16x32_bf16 v[136:139], v[144:147], v[88:91], v[136:139]
  v_exp_f32 v83, v83
  v_perm_b32 v100, v81, v80, s66
  ds_read_b128 v[52:55], v5 offset:52224
  v_mfma_f32_32x32x16_bf16 v[104:119], v[44:47], v[92:95], v[104:119]
  v_exp_f32 v84, v84
  v_exp_f32 v85, v85
  v_perm_b32 v101, v83, v82, s66
  v_exp_f32 v86, v86
  v_exp_f32 v87, v87
  ds_read_b128 v[24:27], v5 offset:36864
  v_mfma_f32_16x16x32_bf16 v[136:139], v[144:147], v[92:95], v[136:139]
  v_perm_b32 v102, v85, v84, s66
  v_perm_b32 v103, v87, v86, s66
  ds_read_b128 v[28:31], v5 offset:37888
  v_mfma_f32_32x32x16_bf16 v[72:87], v[32:35], v[16:19], 0
  v_exp_f32 v56, v56
  v_exp_f32 v57, v57
  v_exp_f32 v58, v58
  v_exp_f32 v59, v59
  v_perm_b32 v88, v57, v56, s66
  v_mfma_f32_32x32x16_bf16 v[120:135], v[40:43], v[96:99], v[120:135]
  v_exp_f32 v60, v60
  v_exp_f32 v61, v61
  v_perm_b32 v89, v59, v58, s66
  v_exp_f32 v62, v62
  v_exp_f32 v63, v63
  s_cmp_eq_u32 s95, 0
  s_cbranch_scc1 K2_np0
  s_add_u32 s29, s94, 0
  s_and_b32 s29, s29, 15
  s_lshl_b32 s29, s29, s30
  s_add_u32 s29, s29, s20
  s_add_u32 m0, s31, 131072
  s_nop 0
  buffer_load_dwordx4 v174, s[24:27], s29 offen lds
  s_add_u32 s29, s29, s28
  s_add_u32 m0, s31, 132096
  s_nop 0
  buffer_load_dwordx4 v174, s[24:27], s29 offen lds
  s_add_u32 s29, s29, s28
  s_add_u32 m0, s31, 133120
  s_nop 0
  buffer_load_dwordx4 v174, s[24:27], s29 offen lds
  s_add_u32 s29, s29, s28
  s_add_u32 m0, s31, 134144
  s_nop 0
  buffer_load_dwordx4 v174, s[24:27], s29 offen lds
K2_np0:
  v_mfma_f32_32x32x16_bf16 v[72:87], v[36:39], v[20:23], v[72:87]
  v_perm_b32 v90, v61, v60, s66
  v_exp_f32 v64, v64
  v_exp_f32 v65, v65
  v_perm_b32 v91, v63, v62, s66
  v_exp_f32 v66, v66
  v_mfma_f32_16x16x32_bf16 v[140:143], v[144:147], v[96:99], v[140:143]
  v_exp_f32 v67, v67
  v_perm_b32 v92, v65, v64, s66
  v_mfma_f32_32x32x16_bf16 v[120:135], v[44:47], v[100:103], v[120:135]
  v_exp_f32 v68, v68
  v_exp_f32 v69, v69
  v_perm_b32 v93, v67, v66, s66
  v_exp_f32 v70, v70
  v_exp_f32 v71, v71
  v_mfma_f32_16x16x32_bf16 v[140:143], v[144:147], v[100:103], v[140:143]
  v_perm_b32 v94, v69, v68, s66
  v_perm_b32 v95, v71, v70, s66
  s_setprio 1
  s_waitcnt lgkmcnt(1)
  v_mfma_f32_32x32x16_bf16 v[56:71], v[24:27], v[8:11], 0
  v_exp_f32 v72, v72
  v_exp_f32 v73, v73
  v_exp_f32 v74, v74
  v_exp_f32 v75, v75
  v_perm_b32 v96, v73, v72, s66
  v_mfma_f32_32x32x16_bf16 v[104:119], v[48:51], v[88:91], v[104:119]
  v_exp_f32 v76, v76
  v_exp_f32 v77, v77
  v_perm_b32 v97, v75, v74, s66
  v_exp_f32 v78, v78
  v_exp_f32 v79, v79
  s_waitcnt lgkmcnt(0)
  v_mfma_f32_32x32x16_bf16 v[56:71], v[28:31], v[12:15], v[56:71]
  v_perm_b32 v98, v77, v76, s66
  v_exp_f32 v80, v80
  v_exp_f32 v81, v81
  v_perm_b32 v99, v79, v78, s66
  v_exp_f32 v82, v82
  ds_read_b128 v[40:43], v5 offset:53248
  v_mfma_f32_16x16x32_bf16 v[136:139], v[144:147], v[88:91], v[136:139]
  v_exp_f32 v83, v83
  v_perm_b32 v100, v81, v80, s66
  ds_read_b128 v[44:47], v5 offset:54272
  v_mfma_f32_32x32x16_bf16 v[104:119], v[52:55], v[92:95], v[104:119]
  v_exp_f32 v84, v84
  v_exp_f32 v85, v85
  v_perm_b32 v101, v83, v82, s66
  v_exp_f32 v86, v86
  v_exp_f32 v87, v87
  ds_read_b128 v[32:35], v5 offset:38912
  v_mfma_f32_16x16x32_bf16 v[136:139], v[144:147], v[92:95], v[136:139]
  v_perm_b32 v102, v85, v84, s66
  v_perm_b32 v103, v87, v86, s66
  ds_read_b128 v[36:39], v5 offset:39936
  v_mfma_f32_32x32x16_bf16 v[72:87], v[24:27], v[16:19], 0
  v_exp_f32 v56, v56
  v_exp_f32 v57, v57
  v_exp_f32 v58, v58
  v_exp_f32 v59, v59
  v_perm_b32 v88, v57, v56, s66
  v_mfma_f32_32x32x16_bf16 v[120:135], v[48:51], v[96:99], v[120:135]
  v_exp_f32 v60, v60
  v_exp_f32 v61, v61
  v_perm_b32 v89, v59, v58, s66
  v_exp_f32 v62, v62
  v_exp_f32 v63, v63
  s_cmp_eq_u32 s95, 0
  s_cbranch_scc1 K2_np1
  s_add_u32 s29, s94, 1
  s_and_b32 s29, s29, 15
  s_lshl_b32 s29, s29, s30
  s_add_u32 s29, s29, s20
  s_add_u32 m0, s31, 0
  s_nop 0
  buffer_load_dwordx4 v174, s[24:27], s29 offen lds
  s_add_u32 s29, s29, s28
  s_add_u32 m0, s31, 1024
  s_nop 0
  buffer_load_dwordx4 v174, s[24:27], s29 offen lds
  s_add_u32 s29, s29, s28
  s_add_u32 m0, s31, 2048
  s_nop 0
  buffer_load_dwordx4 v174, s[24:27], s29 offen lds
  s_add_u32 s29, s29, s28
  s_add_u32 m0, s31, 3072
  s_nop 0
  buffer_load_dwordx4 v174, s[24:27], s29 offen lds
K2_np1:
  v_mfma_f32_32x32x16_bf16 v[72:87], v[28:31], v[20:23], v[72:87]
  v_perm_b32 v90, v61, v60, s66
  v_exp_f32 v64, v64
  v_exp_f32 v65, v65
  v_perm_b32 v91, v63, v62, s66
  v_exp_f32 v66, v66
  v_mfma_f32_16x16x32_bf16 v[140:143], v[144:147], v[96:99], v[140:143]
  v_exp_f32 v67, v67
  v_perm_b32 v92, v65, v64, s66
  v_mfma_f32_32x32x16_bf16 v[120:135], v[52:55], v[100:103], v[120:135]
  v_exp_f32 v68, v68
  v_exp_f32 v69, v69
  v_perm_b32 v93, v67, v66, s66
  v_exp_f32 v70, v70
  v_exp_f32 v71, v71
  v_mfma_f32_16x16x32_bf16 v[140:143], v[144:147], v[100:103], v[140:143]
  v_perm_b32 v94, v69, v68, s66
  v_perm_b32 v95, v71, v70, s66
  s_waitcnt lgkmcnt(1)
  v_mfma_f32_32x32x16_bf16 v[56:71], v[32:35], v[8:11], 0
  v_exp_f32 v72, v72
  v_exp_f32 v73, v73
  v_exp_f32 v74, v74
  v_exp_f32 v75, v75
  v_perm_b32 v96, v73, v72, s66
  v_mfma_f32_32x32x16_bf16 v[104:119], v[40:43], v[88:91], v[104:119]
  v_exp_f32 v76, v76
  v_exp_f32 v77, v77
  v_perm_b32 v97, v75, v74, s66
  v_exp_f32 v78, v78
  v_exp_f32 v79, v79
  s_waitcnt lgkmcnt(0)
  v_mfma_f32_32x32x16_bf16 v[56:71], v[36:39], v[12:15], v[56:71]
  v_perm_b32 v98, v77, v76, s66
  v_exp_f32 v80, v80
  v_exp_f32 v81, v81
  v_perm_b32 v99, v79, v78, s66
  v_exp_f32 v82, v82
  ds_read_b128 v[48:51], v5 offset:55296
  v_mfma_f32_16x16x32_bf16 v[136:139], v[144:147], v[88:91], v[136:139]
  v_exp_f32 v83, v83
  v_perm_b32 v100, v81, v80, s66
  ds_read_b128 v[52:55], v5 offset:56320
  v_mfma_f32_32x32x16_bf16 v[104:119], v[44:47], v[92:95], v[104:119]
  v_exp_f32 v84, v84
  v_exp_f32 v85, v85
  v_perm_b32 v101, v83, v82, s66
  v_exp_f32 v86, v86
  v_exp_f32 v87, v87
  v_mfma_f32_16x16x32_bf16 v[136:139], v[144:147], v[92:95], v[136:139]
  v_perm_b32 v102, v85, v84, s66
  v_perm_b32 v103, v87, v86, s66
  s_setprio 0
  v_mfma_f32_32x32x16_bf16 v[72:87], v[32:35], v[16:19], 0
  v_exp_f32 v56, v56
  v_exp_f32 v57, v57
  v_exp_f32 v58, v58
  v_exp_f32 v59, v59
  v_perm_b32 v88, v57, v56, s66
  v_mfma_f32_32x32x16_bf16 v[120:135], v[40:43], v[96:99], v[120:135]
  v_exp_f32 v60, v60
  v_exp_f32 v61, v61
  v_perm_b32 v89, v59, v58, s66
  v_exp_f32 v62, v62
  v_exp_f32 v63, v63
  v_mfma_f32_32x32x16_bf16 v[72:87], v[36:39], v[20:23], v[72:87]
  v_perm_b32 v90, v61, v60, s66
  v_exp_f32 v64, v64
  v_exp_f32 v65, v65
  v_perm_b32 v91, v63, v62, s66
  v_exp_f32 v66, v66
  v_mfma_f32_16x16x32_bf16 v[140:143], v[144:147], v[96:99], v[140:143]
  v_exp_f32 v67, v67
  v_perm_b32 v92, v65, v64, s66
  v_mfma_f32_32x32x16_bf16 v[120:135], v[44:47], v[100:103], v[120:135]
  v_exp_f32 v68, v68
  v_exp_f32 v69, v69
  v_perm_b32 v93, v67, v66, s66
  v_exp_f32 v70, v70
  v_exp_f32 v71, v71
  v_mfma_f32_16x16x32_bf16 v[140:143], v[144:147], v[100:103], v[140:143]
  v_perm_b32 v94, v69, v68, s66
  v_perm_b32 v95, v71, v70, s66
  v_exp_f32 v72, v72
  v_exp_f32 v73, v73
  v_exp_f32 v74, v74
  v_exp_f32 v75, v75
  v_perm_b32 v96, v73, v72, s66
  s_waitcnt lgkmcnt(1)
  v_mfma_f32_32x32x16_bf16 v[104:119], v[48:51], v[88:91], v[104:119]
  v_exp_f32 v76, v76
  v_exp_f32 v77, v77
  v_perm_b32 v97, v75, v74, s66
  v_exp_f32 v78, v78
  v_exp_f32 v79, v79
  v_perm_b32 v98, v77, v76, s66
  v_exp_f32 v80, v80
  v_exp_f32 v81, v81
  v_perm_b32 v99, v79, v78, s66
  v_exp_f32 v82, v82
  v_mfma_f32_16x16x32_bf16 v[136:139], v[144:147], v[88:91], v[136:139]
  v_exp_f32 v83, v83
  v_perm_b32 v100, v81, v80, s66
  s_waitcnt lgkmcnt(0)
  v_mfma_f32_32x32x16_bf16 v[104:119], v[52:55], v[92:95], v[104:119]
  v_exp_f32 v84, v84
  v_exp_f32 v85, v85
  v_perm_b32 v101, v83, v82, s66
  v_exp_f32 v86, v86
  v_exp_f32 v87, v87
  v_mfma_f32_16x16x32_bf16 v[136:139], v[144:147], v[92:95], v[136:139]
  v_perm_b32 v102, v85, v84, s66
  v_perm_b32 v103, v87, v86, s66
  v_mfma_f32_32x32x16_bf16 v[120:135], v[48:51], v[96:99], v[120:135]
  v_mfma_f32_16x16x32_bf16 v[140:143], v[144:147], v[96:99], v[140:143]
  v_mfma_f32_32x32x16_bf16 v[120:135], v[52:55], v[100:103], v[120:135]
  v_mfma_f32_16x16x32_bf16 v[140:143], v[144:147], v[100:103], v[140:143]
  s_cmp_lg_u32 s67, 0
  s_cbranch_scc1 K2_fallback
K2_tail:
  ds_write_b128 v248, v[104:107] offset:0
  ds_write_b128 v248, v[108:111] offset:1024
  ds_write_b128 v248, v[112:115] offset:2048
  ds_write_b128 v248, v[116:119] offset:3072
  ds_write_b32 v250, v136 offset:0
  s_waitcnt lgkmcnt(0)
  s_barrier
  ds_read_b32 v40, v251 offset:0
  ds_read_b128 v[56:59], v249 offset:0
  ds_read_b128 v[60:63], v249 offset:1024
  ds_read_b128 v[64:67], v249 offset:2048
  ds_read_b128 v[68:71], v249 offset:3072
  s_waitcnt lgkmcnt(4)
  v_add_f32 v140, v140, v40
  v_rcp_f32 v140, v140
  s_waitcnt lgkmcnt(3)
  v_pk_add_f32 v[120:121], v[120:121], v[56:57]
  v_pk_add_f32 v[122:123], v[122:123], v[58:59]
  s_waitcnt lgkmcnt(2)
  v_pk_add_f32 v[124:125], v[124:125], v[60:61]
  v_pk_add_f32 v[126:127], v[126:127], v[62:63]
  v_pk_mul_f32 v[120:121], v[120:121], v[140:141] op_sel_hi:[1,0]
  v_pk_mul_f32 v[122:123], v[122:123], v[140:141] op_sel_hi:[1,0]
  v_pk_mul_f32 v[124:125], v[124:125], v[140:141] op_sel_hi:[1,0]
  v_pk_mul_f32 v[126:127], v[126:127], v[140:141] op_sel_hi:[1,0]
  v_cvt_pk_bf16_f32 v176, v120, v121
  v_cvt_pk_bf16_f32 v177, v122, v123
  v_cvt_pk_bf16_f32 v178, v124, v125
  v_cvt_pk_bf16_f32 v179, v126, v127
  s_waitcnt lgkmcnt(1)
  v_pk_add_f32 v[128:129], v[128:129], v[64:65]
  v_pk_add_f32 v[130:131], v[130:131], v[66:67]
  s_waitcnt lgkmcnt(0)
  v_pk_add_f32 v[132:133], v[132:133], v[68:69]
  v_pk_add_f32 v[134:135], v[134:135], v[70:71]
  v_pk_mul_f32 v[128:129], v[128:129], v[140:141] op_sel_hi:[1,0]
  v_pk_mul_f32 v[130:131], v[130:131], v[140:141] op_sel_hi:[1,0]
  v_pk_mul_f32 v[132:133], v[132:133], v[140:141] op_sel_hi:[1,0]
  v_pk_mul_f32 v[134:135], v[134:135], v[140:141] op_sel_hi:[1,0]
  v_cvt_pk_bf16_f32 v180, v128, v129
  v_cvt_pk_bf16_f32 v181, v130, v131
  v_cvt_pk_bf16_f32 v182, v132, v133
  v_cvt_pk_bf16_f32 v183, v134, v135
  s_cmp_eq_u32 s69, 0
  s_cbranch_scc1 K2_slow
  buffer_store_dwordx4 v[176:179], v3, s[48:51], s60 offen offset:0
  buffer_store_dwordx4 v[180:183], v3, s[48:51], s60 offen offset:1024
K2_stored:
  s_cmp_ge_u32 s5, 4
  s_cbranch_scc1 K3_loader
  s_bfe_u32 s12, s5, 0x10001
  s_and_b32 s13, s5, 1
  v_and_b32 v20, 15, v2
  v_lshrrev_b32 v21, 4, v2
  s_lshl_b32 s9, s12, 13
  s_add_u32 s9, s9, 147456
  v_lshlrev_b32 v16, 4, v20
  v_add_u32 v16, s9, v16
  v_and_b32 v17, 1, v21
  v_lshl_add_u32 v16, v17, 10, v16
  v_lshrrev_b32 v17, 1, v21
  v_lshl_add_u32 v4, v17, 9, v16
  v_add_u32 v5, 2048, v4
  v_bfe_u32 v16, v2, 2, 2
  v_and_b32 v18, 1, v21
  v_lshl_add_u32 v17, v18, 4, v16
  v_lshrrev_b32 v19, 1, v21
  v_lshl_add_u32 v17, v19, 2, v17
  v_lshl_add_u32 v16, v18, 2, v16
  v_and_b32 v19, 3, v2
  v_lshlrev_b32 v19, 3, v19
  v_lshl_add_u32 v17, v17, 8, v19
  v_add_u32 v17, 131072, v17
  s_lshl_b32 s9, s13, 2
  v_xor_b32 v16, s9, v16
  v_xor_b32 v18, 0, v16
  v_lshl_add_u32 v6, v18, 5, v17
  v_xor_b32 v18, 1, v16
  v_lshl_add_u32 v7, v18, 5, v17
  v_xor_b32 v18, 2, v16
  v_lshl_add_u32 v8, v18, 5, v17
  v_xor_b32 v18, 3, v16
  v_lshl_add_u32 v9, v18, 5, v17
  v_lshlrev_b32 v10, 12, v20
  v_and_b32 v18, 1, v21
  v_lshl_add_u32 v10, v18, 5, v10
  v_lshrrev_b32 v18, 1, v21
  v_lshl_add_u32 v10, v18, 4, v10
  s_lshl_b32 s14, s61, 19
  s_lshl_b32 s9, s12, 18
  s_add_u32 s14, s14, s9
  s_lshl_b32 s9, s63, 11
  s_add_u32 s14, s14, s9
  s_lshl_b32 s9, s62, 8
  s_add_u32 s14, s14, s9
  s_lshl_b32 s9, s13, 7
  s_add_u32 s14, s14, s9
  v_mov_b32 v80, 0
  v_mov_b32 v81, 0
  v_mov_b32 v82, 0
  v_mov_b32 v83, 0
  v_mov_b32 v84, 0
  v_mov_b32 v85, 0
  v_mov_b32 v86, 0
  v_mov_b32 v87, 0
  v_mov_b32 v88, 0
  v_mov_b32 v89, 0
  v_mov_b32 v90, 0
  v_mov_b32 v91, 0
  v_mov_b32 v92, 0
  v_mov_b32 v93, 0
  v_mov_b32 v94, 0
  v_mov_b32 v95, 0
  v_mov_b32 v96, 0
  v_mov_b32 v97, 0
  v_mov_b32 v98, 0
  v_mov_b32 v99, 0
  v_mov_b32 v100, 0
  v_mov_b32 v101, 0
  v_mov_b32 v102, 0
  v_mov_b32 v103, 0
  v_mov_b32 v104, 0
  v_mov_b32 v105, 0
  v_mov_b32 v106, 0
  v_mov_b32 v107, 0
  v_mov_b32 v108, 0
  v_mov_b32 v109, 0
  v_mov_b32 v110, 0
  v_mov_b32 v111, 0
  v_mov_b32 v112, 0
  v_mov_b32 v113, 0
  v_mov_b32 v114, 0
  v_mov_b32 v115, 0
  v_mov_b32 v116, 0
  v_mov_b32 v117, 0
  v_mov_b32 v118, 0
  v_mov_b32 v119, 0
  v_mov_b32 v120, 0
  v_mov_b32 v121, 0
  v_mov_b32 v122, 0
  v_mov_b32 v123, 0
  v_mov_b32 v124, 0
  v_mov_b32 v125, 0
  v_mov_b32 v126, 0
  v_mov_b32 v127, 0
  v_mov_b32 v128, 0
  v_mov_b32 v129, 0
  v_mov_b32 v130, 0
  v_mov_b32 v131, 0
  v_mov_b32 v132, 0
  v_mov_b32 v133, 0
  v_mov_b32 v134, 0
  v_mov_b32 v135, 0
  v_mov_b32 v136, 0
  v_mov_b32 v137, 0
  v_mov_b32 v138, 0
  v_mov_b32 v139, 0
  v_mov_b32 v140, 0
  v_mov_b32 v141, 0
  v_mov_b32 v142, 0
  v_mov_b32 v143, 0
  s_mov_b32 s57, 4
  s_mov_b32 s15, 4294836224
  s_waitcnt vmcnt(0)
  s_mov_b32 exec_lo, s69
  s_mov_b32 exec_hi, 0
  buffer_store_dword v166, v167, s[48:51], s65 offen
  s_xor_b32 exec_lo, s69, 1
  buffer_store_dword v166, v167, s[48:51], s65 offen sc0 sc1
  s_mov_b64 exec, -1
  s_barrier
  s_cmp_lg_u32 s95, 0
  s_cbranch_scc1 K3_have
  s_mov_b32 s11, 20000
K3_poll:
  buffer_load_dword v165, v164, s[48:51], s34 offen sc0 sc1
  s_sub_u32 s11, s11, 1
  s_cmp_eq_u32 s11, 0
  s_cbranch_scc1 K3_ready
  s_waitcnt vmcnt(0)
  v_cmp_ne_u32 vcc, 1, v165
  s_cmp_lg_u64 vcc, 0
  s_cbranch_scc1 K3_poll
K3_ready:
  s_add_u32 s29, s94, 0
  s_and_b32 s29, s29, 15
  s_lshl_b32 s29, s29, s30
  s_add_u32 s29, s29, s20
  s_add_u32 m0, s31, 131072
  s_nop 0
  buffer_load_dwordx4 v174, s[24:27], s29 offen lds
  s_add_u32 s29, s29, s28
  s_add_u32 m0, s31, 132096
  s_nop 0
  buffer_load_dwordx4 v174, s[24:27], s29 offen lds
  s_add_u32 s29, s29, s28
  s_add_u32 m0, s31, 133120
  s_nop 0
  buffer_load_dwordx4 v174, s[24:27], s29 offen lds
  s_add_u32 s29, s29, s28
  s_add_u32 m0, s31, 134144
  s_nop 0
  buffer_load_dwordx4 v174, s[24:27], s29 offen lds
  s_add_u32 s29, s94, 1
  s_and_b32 s29, s29, 15
  s_lshl_b32 s29, s29, s30
  s_add_u32 s29, s29, s20
  s_add_u32 m0, s31, 0
  s_nop 0
  buffer_load_dwordx4 v174, s[24:27], s29 offen lds
  s_add_u32 s29, s29, s28
  s_add_u32 m0, s31, 1024
  s_nop 0
  buffer_load_dwordx4 v174, s[24:27], s29 offen lds
  s_add_u32 s29, s29, s28
  s_add_u32 m0, s31, 2048
  s_nop 0
  buffer_load_dwordx4 v174, s[24:27], s29 offen lds
  s_add_u32 s29, s29, s28
  s_add_u32 m0, s31, 3072
  s_nop 0
  buffer_load_dwordx4 v174, s[24:27], s29 offen lds
  s_waitcnt vmcnt(0)
K3_have:
  s_barrier
  ds_read_b64_tr_b16 v[48:49], v6 offset:0
  ds_read_b64_tr_b16 v[50:51], v6 offset:2048
  ds_read_b128 v[16:19], v4 offset:0
  ds_read_b64_tr_b16 v[52:53], v7 offset:0
  ds_read_b64_tr_b16 v[54:55], v7 offset:2048
  ds_read_b64_tr_b16 v[56:57], v8 offset:0
  ds_read_b64_tr_b16 v[58:59], v8 offset:2048
  ds_read_b64_tr_b16 v[60:61], v9 offset:0
  ds_read_b64_tr_b16 v[62:63], v9 offset:2048
  ds_read_b128 v[20:23], v4 offset:256
  ds_read_b128 v[24:27], v4 offset:4096
  ds_read_b128 v[28:31], v4 offset:4352
  s_mov_b32 s11, 16
.p2align 6
K3C_1:
  s_waitcnt lgkmcnt(9)
  v_mfma_f32_16x16x32_bf16 v[80:83], v[48:51], v[16:19], v[80:83]
  ds_read_b64_tr_b16 v[64:65], v6 offset:8192
  s_waitcnt lgkmcnt(8)
  v_mfma_f32_16x16x32_bf16 v[84:87], v[52:55], v[16:19], v[84:87]
  ds_read_b64_tr_b16 v[66:67], v6 offset:10240
  s_waitcnt lgkmcnt(7)
  v_mfma_f32_16x16x32_bf16 v[88:91], v[56:59], v[16:19], v[88:91]
  ds_read_b128 v[32:35], v5 offset:0
  s_waitcnt lgkmcnt(6)
  v_mfma_f32_16x16x32_bf16 v[92:95], v[60:63], v[16:19], v[92:95]
  ds_read_b64_tr_b16 v[68:69], v7 offset:8192
  s_waitcnt lgkmcnt(6)
  v_mfma_f32_16x16x32_bf16 v[96:99], v[48:51], v[20:23], v[96:99]
  ds_read_b64_tr_b16 v[70:71], v7 offset:10240
  v_mfma_f32_16x16x32_bf16 v[100:103], v[52:55], v[20:23], v[100:103]
  ds_read_b64_tr_b16 v[72:73], v8 offset:8192
  v_mfma_f32_16x16x32_bf16 v[104:107], v[56:59], v[20:23], v[104:107]
  ds_read_b64_tr_b16 v[74:75], v8 offset:10240
  v_mfma_f32_16x16x32_bf16 v[108:111], v[60:63], v[20:23], v[108:111]
  ds_read_b64_tr_b16 v[76:77], v9 offset:8192
  s_waitcnt lgkmcnt(9)
  v_mfma_f32_16x16x32_bf16 v[112:115], v[48:51], v[24:27], v[112:115]
  ds_read_b64_tr_b16 v[78:79], v9 offset:10240
  v_mfma_f32_16x16x32_bf16 v[116:119], v[52:55], v[24:27], v[116:119]
  ds_read_b128 v[36:39], v5 offset:256
  v_mfma_f32_16x16x32_bf16 v[120:123], v[56:59], v[24:27], v[120:123]
  ds_read_b128 v[40:43], v5 offset:4096
  v_mfma_f32_16x16x32_bf16 v[124:127], v[60:63], v[24:27], v[124:127]
  ds_read_b128 v[44:47], v5 offset:4352
  s_waitcnt lgkmcnt(12)
  v_mfma_f32_16x16x32_bf16 v[128:131], v[48:51], v[28:31], v[128:131]
  v_mfma_f32_16x16x32_bf16 v[132:135], v[52:55], v[28:31], v[132:135]
  v_mfma_f32_16x16x32_bf16 v[136:139], v[56:59], v[28:31], v[136:139]
  v_mfma_f32_16x16x32_bf16 v[140:143], v[60:63], v[28:31], v[140:143]
  s_add_u32 s57, s57, 1
  s_cmp_eq_u32 s57, 5
  s_cselect_b32 s56, s15, 32768
  s_cselect_b32 s57, 0, s57
  s_waitcnt lgkmcnt(9)
  v_mfma_f32_16x16x32_bf16 v[80:83], v[64:67], v[32:35], v[80:83]
  v_add_u32 v4, s56, v4
  v_add_u32 v5, s56, v5
  s_waitcnt lgkmcnt(7)
  v_mfma_f32_16x16x32_bf16 v[84:87], v[68:71], v[32:35], v[84:87]
  v_add_u32 v6, s56, v6
  v_add_u32 v7, s56, v7
  s_waitcnt lgkmcnt(5)
  v_mfma_f32_16x16x32_bf16 v[88:91], v[72:75], v[32:35], v[88:91]
  v_add_u32 v8, s56, v8
  v_add_u32 v9, s56, v9
  s_waitcnt lgkmcnt(0)
  s_barrier
  v_mfma_f32_16x16x32_bf16 v[92:95], v[76:79], v[32:35], v[92:95]
  ds_read_b64_tr_b16 v[48:49], v6 offset:0
  v_mfma_f32_16x16x32_bf16 v[96:99], v[64:67], v[36:39], v[96:99]
  ds_read_b64_tr_b16 v[50:51], v6 offset:2048
  v_mfma_f32_16x16x32_bf16 v[100:103], v[68:71], v[36:39], v[100:103]
  ds_read_b128 v[16:19], v4 offset:0
  v_mfma_f32_16x16x32_bf16 v[104:107], v[72:75], v[36:39], v[104:107]
  ds_read_b64_tr_b16 v[52:53], v7 offset:0
  v_mfma_f32_16x16x32_bf16 v[108:111], v[76:79], v[36:39], v[108:111]
  ds_read_b64_tr_b16 v[54:55], v7 offset:2048
  v_mfma_f32_16x16x32_bf16 v[112:115], v[64:67], v[40:43], v[112:115]
  ds_read_b64_tr_b16 v[56:57], v8 offset:0
  v_mfma_f32_16x16x32_bf16 v[116:119], v[68:71], v[40:43], v[116:119]
  ds_read_b64_tr_b16 v[58:59], v8 offset:2048
  v_mfma_f32_16x16x32_bf16 v[120:123], v[72:75], v[40:43], v[120:123]
  ds_read_b64_tr_b16 v[60:61], v9 offset:0
  v_mfma_f32_16x16x32_bf16 v[124:127], v[76:79], v[40:43], v[124:127]
  ds_read_b64_tr_b16 v[62:63], v9 offset:2048
  v_mfma_f32_16x16x32_bf16 v[128:131], v[64:67], v[44:47], v[128:131]
  ds_read_b128 v[20:23], v4 offset:256
  v_mfma_f32_16x16x32_bf16 v[132:135], v[68:71], v[44:47], v[132:135]
  ds_read_b128 v[24:27], v4 offset:4096
  v_mfma_f32_16x16x32_bf16 v[136:139], v[72:75], v[44:47], v[136:139]
  ds_read_b128 v[28:31], v4 offset:4352
  v_mfma_f32_16x16x32_bf16 v[140:143], v[76:79], v[44:47], v[140:143]
  s_sub_u32 s11, s11, 1
  s_cmp_lg_u32 s11, 0
  s_cbranch_scc1 K3C_1
  s_waitcnt lgkmcnt(0)
  v_cvt_pk_bf16_f32 v16, v80, v81
  v_cvt_pk_bf16_f32 v18, v84, v85
  v_cvt_pk_bf16_f32 v17, v82, v83
  v_cvt_pk_bf16_f32 v19, v86, v87
  v_permlane16_swap_b32 v16, v18
  s_nop 0
  v_permlane16_swap_b32 v17, v19
  buffer_store_dwordx4 v[16:19], v10, s[44:47], s14 offen offset:0 sc0 sc1
  v_cvt_pk_bf16_f32 v20, v88, v89
  v_cvt_pk_bf16_f32 v22, v92, v93
  v_cvt_pk_bf16_f32 v21, v90, v91
  v_cvt_pk_bf16_f32 v23, v94, v95
  v_permlane16_swap_b32 v20, v22
  s_nop 0
  v_permlane16_swap_b32 v21, v23
  buffer_store_dwordx4 v[20:23], v10, s[44:47], s14 offen offset:64 sc0 sc1
  s_add_u32 s14, s14, 65536
  v_cvt_pk_bf16_f32 v24, v96, v97
  v_cvt_pk_bf16_f32 v26, v100, v101
  v_cvt_pk_bf16_f32 v25, v98, v99
  v_cvt_pk_bf16_f32 v27, v102, v103
  v_permlane16_swap_b32 v24, v26
  s_nop 0
  v_permlane16_swap_b32 v25, v27
  buffer_store_dwordx4 v[24:27], v10, s[44:47], s14 offen offset:0 sc0 sc1
  v_cvt_pk_bf16_f32 v28, v104, v105
  v_cvt_pk_bf16_f32 v30, v108, v109
  v_cvt_pk_bf16_f32 v29, v106, v107
  v_cvt_pk_bf16_f32 v31, v110, v111
  v_permlane16_swap_b32 v28, v30
  s_nop 0
  v_permlane16_swap_b32 v29, v31
  buffer_store_dwordx4 v[28:31], v10, s[44:47], s14 offen offset:64 sc0 sc1
  s_add_u32 s14, s14, 65536
  v_cvt_pk_bf16_f32 v32, v112, v113
  v_cvt_pk_bf16_f32 v34, v116, v117
  v_cvt_pk_bf16_f32 v33, v114, v115
  v_cvt_pk_bf16_f32 v35, v118, v119
  v_permlane16_swap_b32 v32, v34
  s_nop 0
  v_permlane16_swap_b32 v33, v35
  buffer_store_dwordx4 v[32:35], v10, s[44:47], s14 offen offset:0 sc0 sc1
  v_cvt_pk_bf16_f32 v36, v120, v121
  v_cvt_pk_bf16_f32 v38, v124, v125
  v_cvt_pk_bf16_f32 v37, v122, v123
  v_cvt_pk_bf16_f32 v39, v126, v127
  v_permlane16_swap_b32 v36, v38
  s_nop 0
  v_permlane16_swap_b32 v37, v39
  buffer_store_dwordx4 v[36:39], v10, s[44:47], s14 offen offset:64 sc0 sc1
  s_add_u32 s14, s14, 65536
  v_cvt_pk_bf16_f32 v40, v128, v129
  v_cvt_pk_bf16_f32 v42, v132, v133
  v_cvt_pk_bf16_f32 v41, v130, v131
  v_cvt_pk_bf16_f32 v43, v134, v135
  v_permlane16_swap_b32 v40, v42
  s_nop 0
  v_permlane16_swap_b32 v41, v43
  buffer_store_dwordx4 v[40:43], v10, s[44:47], s14 offen offset:0 sc0 sc1
  v_cvt_pk_bf16_f32 v44, v136, v137
  v_cvt_pk_bf16_f32 v46, v140, v141
  v_cvt_pk_bf16_f32 v45, v138, v139
  v_cvt_pk_bf16_f32 v47, v142, v143
  v_permlane16_swap_b32 v44, v46
  s_nop 0
  v_permlane16_swap_b32 v45, v47
  buffer_store_dwordx4 v[44:47], v10, s[44:47], s14 offen offset:64 sc0 sc1
  s_endpgm
K3_loader:
  s_sub_u32 s5, s5, 4
  s_lshl_b32 s52, s5, 12
  s_lshl_b32 s58, s62, 8
  s_add_u32 s16, s94, 2
  s_and_b32 s16, s16, 15
  s_add_u32 s17, s94, 3
  s_and_b32 s17, s17, 15
  s_add_u32 s18, s94, 4
  s_and_b32 s18, s18, 15
  s_add_u32 s57, s94, 5
  s_waitcnt vmcnt(0)
  s_mov_b32 exec_lo, s69
  s_mov_b32 exec_hi, 0
  buffer_store_dword v166, v167, s[48:51], s65 offen
  s_xor_b32 exec_lo, s69, 1
  buffer_store_dword v166, v167, s[48:51], s65 offen sc0 sc1
  s_mov_b64 exec, -1
  s_barrier
  s_cmp_eq_u32 s63, 0
  s_cbranch_scc1 K3_ldA
  s_lshl_b32 s54, s18, 17
  s_add_u32 s54, s54, s58
  s_add_u32 m0, s52, 98304
  s_add_u32 s55, s54, 0
  buffer_load_dwordx4 v172, s[40:43], s55 offen lds
  s_add_u32 m0, s52, 99328
  s_add_u32 s55, s54, 8192
  buffer_load_dwordx4 v172, s[40:43], s55 offen lds
  s_add_u32 m0, s52, 100352
  s_add_u32 s55, s54, 16384
  buffer_load_dwordx4 v172, s[40:43], s55 offen lds
  s_add_u32 m0, s52, 101376
  s_add_u32 s55, s54, 24576
  buffer_load_dwordx4 v172, s[40:43], s55 offen lds
  s_barrier
  s_lshl_b32 s53, s16, 12
  s_add_u32 m0, s52, 49152
  s_add_u32 s55, s53, 0
  buffer_load_dwordx4 v173, s[36:39], s55 offen lds
  s_add_u32 m0, s52, 50176
  s_add_u32 s55, s53, 1024
  buffer_load_dwordx4 v173, s[36:39], s55 offen lds
  s_add_u32 m0, s52, 51200
  s_add_u32 s55, s53, 2048
  buffer_load_dwordx4 v173, s[36:39], s55 offen lds
  s_add_u32 m0, s52, 52224
  s_add_u32 s55, s53, 3072
  buffer_load_dwordx4 v173, s[36:39], s55 offen lds
  s_lshl_b32 s53, s17, 12
  s_add_u32 m0, s52, 81920
  s_add_u32 s55, s53, 0
  buffer_load_dwordx4 v173, s[36:39], s55 offen lds
  s_add_u32 m0, s52, 82944
  s_add_u32 s55, s53, 1024
  buffer_load_dwordx4 v173, s[36:39], s55 offen lds
  s_add_u32 m0, s52, 83968
  s_add_u32 s55, s53, 2048
  buffer_load_dwordx4 v173, s[36:39], s55 offen lds
  s_add_u32 m0, s52, 84992
  s_add_u32 s55, s53, 3072
  buffer_load_dwordx4 v173, s[36:39], s55 offen lds
  s_lshl_b32 s53, s18, 12
  s_add_u32 m0, s52, 114688
  s_add_u32 s55, s53, 0
  buffer_load_dwordx4 v173, s[36:39], s55 offen lds
  s_add_u32 m0, s52, 115712
  s_add_u32 s55, s53, 1024
  buffer_load_dwordx4 v173, s[36:39], s55 offen lds
  s_add_u32 m0, s52, 116736
  s_add_u32 s55, s53, 2048
  buffer_load_dwordx4 v173, s[36:39], s55 offen lds
  s_add_u32 m0, s52, 117760
  s_add_u32 s55, s53, 3072
  buffer_load_dwordx4 v173, s[36:39], s55 offen lds
  s_add_u32 s52, s52, 131072
  s_barrier
  s_and_b32 s57, s57, 15
  s_lshl_b32 s53, s57, 12
  s_lshl_b32 s54, s57, 17
  s_add_u32 s54, s54, s58
  s_add_u32 m0, s52, 0
  s_add_u32 s55, s54, 0
  buffer_load_dwordx4 v172, s[40:43], s55 offen lds
  s_add_u32 m0, s52, 16384
  s_add_u32 s55, s53, 0
  buffer_load_dwordx4 v173, s[36:39], s55 offen lds
  s_add_u32 m0, s52, 1024
  s_add_u32 s55, s54, 8192
  buffer_load_dwordx4 v172, s[40:43], s55 offen lds
  s_add_u32 m0, s52, 17408
  s_add_u32 s55, s53, 1024
  buffer_load_dwordx4 v173, s[36:39], s55 offen lds
  s_add_u32 m0, s52, 2048
  s_add_u32 s55, s54, 16384
  buffer_load_dwordx4 v172, s[40:43], s55 offen lds
  s_add_u32 m0, s52, 18432
  s_add_u32 s55, s53, 2048
  buffer_load_dwordx4 v173, s[36:39], s55 offen lds
  s_add_u32 m0, s52, 3072
  s_add_u32 s55, s54, 24576
  buffer_load_dwordx4 v172, s[40:43], s55 offen lds
  s_add_u32 m0, s52, 19456
  s_add_u32 s55, s53, 3072
  buffer_load_dwordx4 v173, s[36:39], s55 offen lds
  s_add_u32 s57, s57, 1
  s_add_u32 s52, s52, 32768
  s_cmp_ge_u32 s52, 163840
  s_cselect_b32 s55, 163840, 0
  s_sub_u32 s52, s52, s55
  s_waitcnt vmcnt(16)
  s_barrier
  s_and_b32 s57, s57, 15
  s_lshl_b32 s53, s57, 12
  s_lshl_b32 s54, s57, 17
  s_add_u32 s54, s54, s58
  s_add_u32 m0, s52, 0
  s_add_u32 s55, s54, 0
  buffer_load_dwordx4 v172, s[40:43], s55 offen lds
  s_add_u32 m0, s52, 16384
  s_add_u32 s55, s53, 0
  buffer_load_dwordx4 v173, s[36:39], s55 offen lds
  s_add_u32 m0, s52, 1024
  s_add_u32 s55, s54, 8192
  buffer_load_dwordx4 v172, s[40:43], s55 offen lds
  s_add_u32 m0, s52, 17408
  s_add_u32 s55, s53, 1024
  buffer_load_dwordx4 v173, s[36:39], s55 offen lds
  s_add_u32 m0, s52, 2048
  s_add_u32 s55, s54, 16384
  buffer_load_dwordx4 v172, s[40:43], s55 offen lds
  s_add_u32 m0, s52, 18432
  s_add_u32 s55, s53, 2048
  buffer_load_dwordx4 v173, s[36:39], s55 offen lds
  s_add_u32 m0, s52, 3072
  s_add_u32 s55, s54, 24576
  buffer_load_dwordx4 v172, s[40:43], s55 offen lds
  s_add_u32 m0, s52, 19456
  s_add_u32 s55, s53, 3072
  buffer_load_dwordx4 v173, s[36:39], s55 offen lds
  s_add_u32 s57, s57, 1
  s_add_u32 s52, s52, 32768
  s_cmp_ge_u32 s52, 163840
  s_cselect_b32 s55, 163840, 0
  s_sub_u32 s52, s52, s55
  s_waitcnt vmcnt(20)
  s_barrier
  s_and_b32 s57, s57, 15
  s_lshl_b32 s53, s57, 12
  s_lshl_b32 s54, s57, 17
  s_add_u32 s54, s54, s58
  s_add_u32 m0, s52, 0
  s_add_u32 s55, s54, 0
  buffer_load_dwordx4 v172, s[40:43], s55 offen lds
  s_add_u32 m0, s52, 16384
  s_add_u32 s55, s53, 0
  buffer_load_dwordx4 v173, s[36:39], s55 offen lds
  s_add_u32 m0, s52, 1024
  s_add_u32 s55, s54, 8192
  buffer_load_dwordx4 v172, s[40:43], s55 offen lds
  s_add_u32 m0, s52, 17408
  s_add_u32 s55, s53, 1024
  buffer_load_dwordx4 v173, s[36:39], s55 offen lds
  s_add_u32 m0, s52, 2048
  s_add_u32 s55, s54, 16384
  buffer_load_dwordx4 v172, s[40:43], s55 offen lds
  s_add_u32 m0, s52, 18432
  s_add_u32 s55, s53, 2048
  buffer_load_dwordx4 v173, s[36:39], s55 offen lds
  s_add_u32 m0, s52, 3072
  s_add_u32 s55, s54, 24576
  buffer_load_dwordx4 v172, s[40:43], s55 offen lds
  s_add_u32 m0, s52, 19456
  s_add_u32 s55, s53, 3072
  buffer_load_dwordx4 v173, s[36:39], s55 offen lds
  s_add_u32 s57, s57, 1
  s_add_u32 s52, s52, 32768
  s_cmp_ge_u32 s52, 163840
  s_cselect_b32 s55, 163840, 0
  s_sub_u32 s52, s52, s55
K3_ldJ:
  s_mov_b32 s11, 8
K3LD_2:
  s_waitcnt vmcnt(24)
  s_barrier
  s_and_b32 s57, s57, 15
  s_lshl_b32 s53, s57, 12
  s_lshl_b32 s54, s57, 17
  s_add_u32 s54, s54, s58
  s_add_u32 m0, s52, 0
  s_add_u32 s55, s54, 0
  buffer_load_dwordx4 v172, s[40:43], s55 offen lds
  s_add_u32 m0, s52, 16384
  s_add_u32 s55, s53, 0
  buffer_load_dwordx4 v173, s[36:39], s55 offen lds
  s_add_u32 m0, s52, 1024
  s_add_u32 s55, s54, 8192
  buffer_load_dwordx4 v172, s[40:43], s55 offen lds
  s_add_u32 m0, s52, 17408
  s_add_u32 s55, s53, 1024
  buffer_load_dwordx4 v173, s[36:39], s55 offen lds
  s_add_u32 m0, s52, 2048
  s_add_u32 s55, s54, 16384
  buffer_load_dwordx4 v172, s[40:43], s55 offen lds
  s_add_u32 m0, s52, 18432
  s_add_u32 s55, s53, 2048
  buffer_load_dwordx4 v173, s[36:39], s55 offen lds
  s_add_u32 m0, s52, 3072
  s_add_u32 s55, s54, 24576
  buffer_load_dwordx4 v172, s[40:43], s55 offen lds
  s_add_u32 m0, s52, 19456
  s_add_u32 s55, s53, 3072
  buffer_load_dwordx4 v173, s[36:39], s55 offen lds
  s_add_u32 s57, s57, 1
  s_add_u32 s52, s52, 32768
  s_cmp_ge_u32 s52, 163840
  s_cselect_b32 s55, 163840, 0
  s_sub_u32 s52, s52, s55
  s_sub_u32 s11, s11, 1
  s_cmp_lg_u32 s11, 0
  s_cbranch_scc1 K3LD_2
  s_waitcnt vmcnt(24)
  s_barrier
  s_waitcnt vmcnt(16)
  s_barrier
  s_waitcnt vmcnt(8)
  s_barrier
  s_waitcnt vmcnt(0)
  s_barrier
  s_barrier
  s_endpgm
K3_ldA:
  s_barrier
  s_sub_u32 s57, s57, 3
  s_add_u32 s52, s52, 32768
  s_and_b32 s57, s57, 15
  s_lshl_b32 s53, s57, 12
  s_lshl_b32 s54, s57, 17
  s_add_u32 s54, s54, s58
  s_add_u32 m0, s52, 0
  s_add_u32 s55, s54, 0
  buffer_load_dwordx4 v172, s[40:43], s55 offen lds
  s_add_u32 m0, s52, 16384
  s_add_u32 s55, s53, 0
  buffer_load_dwordx4 v173, s[36:39], s55 offen lds
  s_add_u32 m0, s52, 1024
  s_add_u32 s55, s54, 8192
  buffer_load_dwordx4 v172, s[40:43], s55 offen lds
  s_add_u32 m0, s52, 17408
  s_add_u32 s55, s53, 1024
  buffer_load_dwordx4 v173, s[36:39], s55 offen lds
  s_add_u32 m0, s52, 2048
  s_add_u32 s55, s54, 16384
  buffer_load_dwordx4 v172, s[40:43], s55 offen lds
  s_add_u32 m0, s52, 18432
  s_add_u32 s55, s53, 2048
  buffer_load_dwordx4 v173, s[36:39], s55 offen lds
  s_add_u32 m0, s52, 3072
  s_add_u32 s55, s54, 24576
  buffer_load_dwordx4 v172, s[40:43], s55 offen lds
  s_add_u32 m0, s52, 19456
  s_add_u32 s55, s53, 3072
  buffer_load_dwordx4 v173, s[36:39], s55 offen lds
  s_add_u32 s57, s57, 1
  s_add_u32 s52, s52, 32768
  s_cmp_ge_u32 s52, 163840
  s_cselect_b32 s55, 163840, 0
  s_sub_u32 s52, s52, s55
  s_and_b32 s57, s57, 15
  s_lshl_b32 s53, s57, 12
  s_lshl_b32 s54, s57, 17
  s_add_u32 s54, s54, s58
  s_add_u32 m0, s52, 0
  s_add_u32 s55, s54, 0
  buffer_load_dwordx4 v172, s[40:43], s55 offen lds
  s_add_u32 m0, s52, 16384
  s_add_u32 s55, s53, 0
  buffer_load_dwordx4 v173, s[36:39], s55 offen lds
  s_add_u32 m0, s52, 1024
  s_add_u32 s55, s54, 8192
  buffer_load_dwordx4 v172, s[40:43], s55 offen lds
  s_add_u32 m0, s52, 17408
  s_add_u32 s55, s53, 1024
  buffer_load_dwordx4 v173, s[36:39], s55 offen lds
  s_add_u32 m0, s52, 2048
  s_add_u32 s55, s54, 16384
  buffer_load_dwordx4 v172, s[40:43], s55 offen lds
  s_add_u32 m0, s52, 18432
  s_add_u32 s55, s53, 2048
  buffer_load_dwordx4 v173, s[36:39], s55 offen lds
  s_add_u32 m0, s52, 3072
  s_add_u32 s55, s54, 24576
  buffer_load_dwordx4 v172, s[40:43], s55 offen lds
  s_add_u32 m0, s52, 19456
  s_add_u32 s55, s53, 3072
  buffer_load_dwordx4 v173, s[36:39], s55 offen lds
  s_add_u32 s57, s57, 1
  s_add_u32 s52, s52, 32768
  s_cmp_ge_u32 s52, 163840
  s_cselect_b32 s55, 163840, 0
  s_sub_u32 s52, s52, s55
  s_barrier
  s_and_b32 s57, s57, 15
  s_lshl_b32 s53, s57, 12
  s_lshl_b32 s54, s57, 17
  s_add_u32 s54, s54, s58
  s_add_u32 m0, s52, 0
  s_add_u32 s55, s54, 0
  buffer_load_dwordx4 v172, s[40:43], s55 offen lds
  s_add_u32 m0, s52, 16384
  s_add_u32 s55, s53, 0
  buffer_load_dwordx4 v173, s[36:39], s55 offen lds
  s_add_u32 m0, s52, 1024
  s_add_u32 s55, s54, 8192
  buffer_load_dwordx4 v172, s[40:43], s55 offen lds
  s_add_u32 m0, s52, 17408
  s_add_u32 s55, s53, 1024
  buffer_load_dwordx4 v173, s[36:39], s55 offen lds
  s_add_u32 m0, s52, 2048
  s_add_u32 s55, s54, 16384
  buffer_load_dwordx4 v172, s[40:43], s55 offen lds
  s_add_u32 m0, s52, 18432
  s_add_u32 s55, s53, 2048
  buffer_load_dwordx4 v173, s[36:39], s55 offen lds
  s_add_u32 m0, s52, 3072
  s_add_u32 s55, s54, 24576
  buffer_load_dwordx4 v172, s[40:43], s55 offen lds
  s_add_u32 m0, s52, 19456
  s_add_u32 s55, s53, 3072
  buffer_load_dwordx4 v173, s[36:39], s55 offen lds
  s_add_u32 s57, s57, 1
  s_add_u32 s52, s52, 32768
  s_cmp_ge_u32 s52, 163840
  s_cselect_b32 s55, 163840, 0
  s_sub_u32 s52, s52, s55
  s_and_b32 s57, s57, 15
  s_lshl_b32 s53, s57, 12
  s_lshl_b32 s54, s57, 17
  s_add_u32 s54, s54, s58
  s_add_u32 m0, s52, 0
  s_add_u32 s55, s54, 0
  buffer_load_dwordx4 v172, s[40:43], s55 offen lds
  s_add_u32 m0, s52, 16384
  s_add_u32 s55, s53, 0
  buffer_load_dwordx4 v173, s[36:39], s55 offen lds
  s_add_u32 m0, s52, 1024
  s_add_u32 s55, s54, 8192
  buffer_load_dwordx4 v172, s[40:43], s55 offen lds
  s_add_u32 m0, s52, 17408
  s_add_u32 s55, s53, 1024
  buffer_load_dwordx4 v173, s[36:39], s55 offen lds
  s_add_u32 m0, s52, 2048
  s_add_u32 s55, s54, 16384
  buffer_load_dwordx4 v172, s[40:43], s55 offen lds
  s_add_u32 m0, s52, 18432
  s_add_u32 s55, s53, 2048
  buffer_load_dwordx4 v173, s[36:39], s55 offen lds
  s_add_u32 m0, s52, 3072
  s_add_u32 s55, s54, 24576
  buffer_load_dwordx4 v172, s[40:43], s55 offen lds
  s_add_u32 m0, s52, 19456
  s_add_u32 s55, s53, 3072
  buffer_load_dwordx4 v173, s[36:39], s55 offen lds
  s_add_u32 s57, s57, 1
  s_add_u32 s52, s52, 32768
  s_cmp_ge_u32 s52, 163840
  s_cselect_b32 s55, 163840, 0
  s_sub_u32 s52, s52, s55
  s_waitcnt vmcnt(24)
  s_barrier
  s_and_b32 s57, s57, 15
  s_lshl_b32 s53, s57, 12
  s_lshl_b32 s54, s57, 17
  s_add_u32 s54, s54, s58
  s_add_u32 m0, s52, 0
  s_add_u32 s55, s54, 0
  buffer_load_dwordx4 v172, s[40:43], s55 offen lds
  s_add_u32 m0, s52, 16384
  s_add_u32 s55, s53, 0
  buffer_load_dwordx4 v173, s[36:39], s55 offen lds
  s_add_u32 m0, s52, 1024
  s_add_u32 s55, s54, 8192
  buffer_load_dwordx4 v172, s[40:43], s55 offen lds
  s_add_u32 m0, s52, 17408
  s_add_u32 s55, s53, 1024
  buffer_load_dwordx4 v173, s[36:39], s55 offen lds
  s_add_u32 m0, s52, 2048
  s_add_u32 s55, s54, 16384
  buffer_load_dwordx4 v172, s[40:43], s55 offen lds
  s_add_u32 m0, s52, 18432
  s_add_u32 s55, s53, 2048
  buffer_load_dwordx4 v173, s[36:39], s55 offen lds
  s_add_u32 m0, s52, 3072
  s_add_u32 s55, s54, 24576
  buffer_load_dwordx4 v172, s[40:43], s55 offen lds
  s_add_u32 m0, s52, 19456
  s_add_u32 s55, s53, 3072
  buffer_load_dwordx4 v173, s[36:39], s55 offen lds
  s_add_u32 s57, s57, 1
  s_add_u32 s52, s52, 32768
  s_cmp_ge_u32 s52, 163840
  s_cselect_b32 s55, 163840, 0
  s_sub_u32 s52, s52, s55
  s_waitcnt vmcnt(24)
  s_barrier
  s_and_b32 s57, s57, 15
  s_lshl_b32 s53, s57, 12
  s_lshl_b32 s54, s57, 17
  s_add_u32 s54, s54, s58
  s_add_u32 m0, s52, 0
  s_add_u32 s55, s54, 0
  buffer_load_dwordx4 v172, s[40:43], s55 offen lds
  s_add_u32 m0, s52, 16384
  s_add_u32 s55, s53, 0
  buffer_load_dwordx4 v173, s[36:39], s55 offen lds
  s_add_u32 m0, s52, 1024
  s_add_u32 s55, s54, 8192
  buffer_load_dwordx4 v172, s[40:43], s55 offen lds
  s_add_u32 m0, s52, 17408
  s_add_u32 s55, s53, 1024
  buffer_load_dwordx4 v173, s[36:39], s55 offen lds
  s_add_u32 m0, s52, 2048
  s_add_u32 s55, s54, 16384
  buffer_load_dwordx4 v172, s[40:43], s55 offen lds
  s_add_u32 m0, s52, 18432
  s_add_u32 s55, s53, 2048
  buffer_load_dwordx4 v173, s[36:39], s55 offen lds
  s_add_u32 m0, s52, 3072
  s_add_u32 s55, s54, 24576
  buffer_load_dwordx4 v172, s[40:43], s55 offen lds
  s_add_u32 m0, s52, 19456
  s_add_u32 s55, s53, 3072
  buffer_load_dwordx4 v173, s[36:39], s55 offen lds
  s_add_u32 s57, s57, 1
  s_add_u32 s52, s52, 32768
  s_cmp_ge_u32 s52, 163840
  s_cselect_b32 s55, 163840, 0
  s_sub_u32 s52, s52, s55
  s_branch K3_ldJ
K2_slow:
  buffer_store_dwordx4 v[176:179], v3, s[48:51], s60 offen offset:0 sc0 sc1
  buffer_store_dwordx4 v[180:183], v3, s[48:51], s60 offen offset:1024 sc0 sc1
  s_branch K2_stored
K2_fallback:
  s_waitcnt vmcnt(0) lgkmcnt(0)
  s_nop 15
  v_mov_b32 v230, 0xff800000
  v_mov_b32 v231, 0xff800000
  s_mov_b32 s11, 0
K2F_3:
  s_lshr_b32 s3, s11, 3
  s_lshl_b32 s3, s3, 15
  s_and_b32 s4, s11, 7
  s_lshl_b32 s4, s4, 11
  s_add_u32 s3, s3, s4
  s_add_u32 s3, s3, 8388608
  buffer_load_dwordx4 v[24:27], v3, s[48:51], s3 offen offset:0
  buffer_load_dwordx4 v[28:31], v3, s[48:51], s3 offen offset:1024
  s_waitcnt vmcnt(1)
  v_mfma_f32_32x32x16_bf16 v[56:71], v[24:27], v[8:11], 0
  s_waitcnt vmcnt(0)
  v_mfma_f32_32x32x16_bf16 v[56:71], v[28:31], v[12:15], v[56:71]
  v_mfma_f32_32x32x16_bf16 v[72:87], v[24:27], v[16:19], 0
  v_mfma_f32_32x32x16_bf16 v[72:87], v[28:31], v[20:23], v[72:87]
  s_nop 9
  v_max3_f32 v230, v230, v56, v57
  v_max3_f32 v230, v230, v58, v59
  v_max3_f32 v230, v230, v60, v61
  v_max3_f32 v230, v230, v62, v63
  v_max3_f32 v230, v230, v64, v65
  v_max3_f32 v230, v230, v66, v67
  v_max3_f32 v230, v230, v68, v69
  v_max3_f32 v230, v230, v70, v71
  v_max3_f32 v231, v231, v72, v73
  v_max3_f32 v231, v231, v74, v75
  v_max3_f32 v231, v231, v76, v77
  v_max3_f32 v231, v231, v78, v79
  v_max3_f32 v231, v231, v80, v81
  v_max3_f32 v231, v231, v82, v83
  v_max3_f32 v231, v231, v84, v85
  v_max3_f32 v231, v231, v86, v87
  s_add_u32 s11, s11, 1
  s_cmp_lg_u32 s11, 64
  s_cbranch_scc1 K2F_3
  v_mov_b32 v6, v230
  s_nop 1
  v_permlane32_swap_b32 v230, v6
  v_max_f32 v230, v230, v6
  v_add_f32 v230, 1093664768, v230
  v_mov_b32 v6, v231
  s_nop 1
  v_permlane32_swap_b32 v231, v6
  v_max_f32 v231, v231, v6
  v_add_f32 v231, 1093664768, v231
  v_mov_b32 v104, 0
  v_mov_b32 v105, 0
  v_mov_b32 v106, 0
  v_mov_b32 v107, 0
  v_mov_b32 v108, 0
  v_mov_b32 v109, 0
  v_mov_b32 v110, 0
  v_mov_b32 v111, 0
  v_mov_b32 v112, 0
  v_mov_b32 v113, 0
  v_mov_b32 v114, 0
  v_mov_b32 v115, 0
  v_mov_b32 v116, 0
  v_mov_b32 v117, 0
  v_mov_b32 v118, 0
  v_mov_b32 v119, 0
  v_mov_b32 v120, 0
  v_mov_b32 v121, 0
  v_mov_b32 v122, 0
  v_mov_b32 v123, 0
  v_mov_b32 v124, 0
  v_mov_b32 v125, 0
  v_mov_b32 v126, 0
  v_mov_b32 v127, 0
  v_mov_b32 v128, 0
  v_mov_b32 v129, 0
  v_mov_b32 v130, 0
  v_mov_b32 v131, 0
  v_mov_b32 v132, 0
  v_mov_b32 v133, 0
  v_mov_b32 v134, 0
  v_mov_b32 v135, 0
  v_mov_b32 v136, 0
  v_mov_b32 v137, 0
  v_mov_b32 v138, 0
  v_mov_b32 v139, 0
  v_mov_b32 v140, 0
  v_mov_b32 v141, 0
  v_mov_b32 v142, 0
  v_mov_b32 v143, 0
  s_mov_b32 s11, 0
  s_and_b32 s12, s5, 1
  s_lshl_b32 s12, s12, 13
  s_add_u32 s12, s12, 8388608
K2G_4:
  s_lshr_b32 s3, s11, 2
  s_lshl_b32 s3, s3, 15
  s_and_b32 s4, s11, 3
  s_lshl_b32 s4, s4, 11
  s_add_u32 s3, s3, s4
  s_add_u32 s3, s3, s12
  s_add_u32 s4, s3, 16384
  buffer_load_dwordx4 v[24:27], v3, s[48:51], s3 offen offset:0
  buffer_load_dwordx4 v[28:31], v3, s[48:51], s3 offen offset:1024
  buffer_load_dwordx4 v[40:43], v3, s[48:51], s4 offen offset:0
  buffer_load_dwordx4 v[44:47], v3, s[48:51], s4 offen offset:1024
  s_waitcnt vmcnt(3)
  v_mfma_f32_32x32x16_bf16 v[56:71], v[24:27], v[8:11], 0
  s_waitcnt vmcnt(2)
  v_mfma_f32_32x32x16_bf16 v[56:71], v[28:31], v[12:15], v[56:71]
  v_mfma_f32_32x32x16_bf16 v[72:87], v[24:27], v[16:19], 0
  v_mfma_f32_32x32x16_bf16 v[72:87], v[28:31], v[20:23], v[72:87]
  s_nop 9
  v_sub_f32 v56, v56, v230
  v_sub_f32 v57, v57, v230
  v_sub_f32 v58, v58, v230
  v_sub_f32 v59, v59, v230
  v_sub_f32 v60, v60, v230
  v_sub_f32 v61, v61, v230
  v_sub_f32 v62, v62, v230
  v_sub_f32 v63, v63, v230
  v_sub_f32 v64, v64, v230
  v_sub_f32 v65, v65, v230
  v_sub_f32 v66, v66, v230
  v_sub_f32 v67, v67, v230
  v_sub_f32 v68, v68, v230
  v_sub_f32 v69, v69, v230
  v_sub_f32 v70, v70, v230
  v_sub_f32 v71, v71, v230
  v_exp_f32 v56, v56
  v_exp_f32 v57, v57
  v_exp_f32 v58, v58
  v_exp_f32 v59, v59
  v_perm_b32 v88, v57, v56, s66
  v_exp_f32 v60, v60
  v_exp_f32 v61, v61
  v_perm_b32 v89, v59, v58, s66
  v_exp_f32 v62, v62
  v_exp_f32 v63, v63
  v_perm_b32 v90, v61, v60, s66
  v_exp_f32 v64, v64
  v_exp_f32 v65, v65
  v_perm_b32 v91, v63, v62, s66
  v_exp_f32 v66, v66
  v_exp_f32 v67, v67
  v_perm_b32 v92, v65, v64, s66
  v_exp_f32 v68, v68
  v_exp_f32 v69, v69
  v_perm_b32 v93, v67, v66, s66
  v_exp_f32 v70, v70
  v_exp_f32 v71, v71
  v_perm_b32 v94, v69, v68, s66
  v_perm_b32 v95, v71, v70, s66
  v_sub_f32 v72, v72, v231
  v_sub_f32 v73, v73, v231
  v_sub_f32 v74, v74, v231
  v_sub_f32 v75, v75, v231
  v_sub_f32 v76, v76, v231
  v_sub_f32 v77, v77, v231
  v_sub_f32 v78, v78, v231
  v_sub_f32 v79, v79, v231
  v_sub_f32 v80, v80, v231
  v_sub_f32 v81, v81, v231
  v_sub_f32 v82, v82, v231
  v_sub_f32 v83, v83, v231
  v_sub_f32 v84, v84, v231
  v_sub_f32 v85, v85, v231
  v_sub_f32 v86, v86, v231
  v_sub_f32 v87, v87, v231
  v_exp_f32 v72, v72
  v_exp_f32 v73, v73
  v_exp_f32 v74, v74
  v_exp_f32 v75, v75
  v_perm_b32 v96, v73, v72, s66
  v_exp_f32 v76, v76
  v_exp_f32 v77, v77
  v_perm_b32 v97, v75, v74, s66
  v_exp_f32 v78, v78
  v_exp_f32 v79, v79
  v_perm_b32 v98, v77, v76, s66
  v_exp_f32 v80, v80
  v_exp_f32 v81, v81
  v_perm_b32 v99, v79, v78, s66
  v_exp_f32 v82, v82
  v_exp_f32 v83, v83
  v_perm_b32 v100, v81, v80, s66
  v_exp_f32 v84, v84
  v_exp_f32 v85, v85
  v_perm_b32 v101, v83, v82, s66
  v_exp_f32 v86, v86
  v_exp_f32 v87, v87
  v_perm_b32 v102, v85, v84, s66
  v_perm_b32 v103, v87, v86, s66
  s_waitcnt vmcnt(1)
  v_mfma_f32_32x32x16_bf16 v[104:119], v[40:43], v[88:91], v[104:119]
  s_waitcnt vmcnt(0)
  v_mfma_f32_32x32x16_bf16 v[104:119], v[44:47], v[92:95], v[104:119]
  v_mfma_f32_16x16x32_bf16 v[136:139], v[144:147], v[88:91], v[136:139]
  v_mfma_f32_16x16x32_bf16 v[136:139], v[144:147], v[92:95], v[136:139]
  v_mfma_f32_32x32x16_bf16 v[120:135], v[40:43], v[96:99], v[120:135]
  v_mfma_f32_32x32x16_bf16 v[120:135], v[44:47], v[100:103], v[120:135]
  v_mfma_f32_16x16x32_bf16 v[140:143], v[144:147], v[96:99], v[140:143]
  v_mfma_f32_16x16x32_bf16 v[140:143], v[144:147], v[100:103], v[140:143]
  s_add_u32 s11, s11, 1
  s_cmp_lg_u32 s11, 32
  s_cbranch_scc1 K2G_4
  s_nop 15
  s_branch K2_tail
.section .rodata,"a"
.p2align 6
.amdhsa_kernel k2_kernel
  .amdhsa_next_free_vgpr 256
  .amdhsa_next_free_sgpr 96
  .amdhsa_accum_offset 256
  .amdhsa_group_segment_fixed_size 0
  .amdhsa_kernarg_size 96
  .amdhsa_user_sgpr_count 2
  .amdhsa_user_sgpr_kernarg_segment_ptr 1
  .amdhsa_system_sgpr_workgroup_id_x 1
.end_amdhsa_kernel
```
